```python
import torch

def _softmax(x, axis=-1):
    return torch.softmax(x, dim=axis)
def _gelu(x):
    return torch.nn.functional.gelu(x, approximate="tanh")
def _silu(x):
    return torch.nn.functional.silu(x)
def _sigmoid(x):
    return torch.sigmoid(x)
def _layernorm(x, axis=-1, eps=1e-5):
    m = x.mean(dim=axis, keepdim=True)
    v = x.var(dim=axis, keepdim=True, unbiased=False)
    return (x - m) / torch.sqrt(v + eps)
def _scatter_add(tgt, idx, src, axis=0):
    return tgt.clone().index_add_(axis, idx, src)
def _segment_sum(src, seg, n):
    out = torch.zeros((n,) + src.shape[1:], dtype=src.dtype)
    return out.index_add_(0, seg, src)
def _pad(x, pw):
    flat = tuple(v for pair in reversed(pw) for v in pair)
    return torch.nn.functional.pad(x, flat)

kernel_name = 'standalone__linear_kernel_performer__prompt'

def setup_inputs():

    _w = (lambda a: (lambda t: t.to(torch.bfloat16) if t.is_floating_point() else t)(torch.as_tensor(a)))
    B, H, S, D = 1, 16, 2048, 256
    M = D
    return {
        "q": _w((lambda *s: torch.randn(*s, dtype=torch.bfloat16) * 0.05)(B, H, S, D)),
        "k": _w((lambda *s: torch.randn(*s, dtype=torch.bfloat16) * 0.4)(B, H, S, D)),
        "v": _w((lambda *s: torch.randn(*s, dtype=torch.bfloat16) * 0.4)(B, H, S, D)),
        "proj": _w((lambda *s: torch.randn(*s, dtype=torch.bfloat16) * 0.4)(M, D)),
    }

def reference(q, k, v, proj):
    B, H, S, D = q.shape
    M = proj.shape[0]
    scale = D ** -0.25
    qs = q * scale
    ks = k * scale
    qw = torch.einsum("bhsd,md->bhsm", qs, proj)
    kw = torch.einsum("bhsd,md->bhsm", ks, proj)
    qn = torch.einsum("bhsd,bhsd->bhs", qs, qs)[..., None] * 0.5
    kn = torch.einsum("bhsd,bhsd->bhs", ks, ks)[..., None] * 0.5
    inv_sqrt_m = M ** -0.5
    phi_q = torch.exp(qw - qn) * inv_sqrt_m
    phi_k = torch.exp(kw - kn) * inv_sqrt_m
    kv = torch.einsum("bhsm,bhsd->bhmd", phi_k, v)
    ksum = torch.einsum("bhsm->bhm", phi_k)
    num = torch.einsum("bhsm,bhmd->bhsd", phi_q, kv)
    den = torch.einsum("bhsm,bhm->bhs", phi_q, ksum)[..., None] + 1e-6
    return num / den
```

```asm
; @launch grid=(256,1,1) block=(512,1,1) lds=154880
.amdgcn_target "amdgcn-amd-amdhsa--gfx950"
.text
.globl standalone__linear_kernel_performer__prompt_kernel
.p2align 8
.type standalone__linear_kernel_performer__prompt_kernel,@function
standalone__linear_kernel_performer__prompt_kernel:
    s_cmp_ge_u32 s2, 256
    s_cbranch_scc1 L_end
    s_load_dwordx8 s[4:11], s[0:1], 0
    s_load_dwordx4 s[12:15], s[0:1], 32
    s_load_dwordx2 s[16:17], s[0:1], 48
    v_lshrrev_b32 v1, 6, v0
    v_and_b32 v0, 63, v0
    v_readfirstlane_b32 s3, v1
    s_and_b32 s32, s2, 7
    s_lshl_b32 s32, s32, 1
    s_bfe_u32 s33, s2, 0x10003
    s_or_b32 s40, s32, s33
    s_lshr_b32 s41, s2, 4
    s_lshr_b32 s42, s41, 1
    s_and_b32 s43, s41, 1
    s_and_b32 s44, s3, 3
    s_lshl_b32 s32, s40, 20
    s_lshl_b32 s33, s42, 17
    s_add_u32 s33, s33, s32
    s_lshl_b32 s34, s41, 16
    s_add_u32 s34, s34, s32
    s_mul_i32 s46, s44, 4224
    s_lshl_b32 s47, s44, 12
    v_lshrrev_b32 v9, 5, v0
    v_and_b32 v10, 31, v0
    v_xor_b32 v10, v10, v9
    v_lshlrev_b32 v10, 4, v10
    v_lshl_add_u32 v1, v9, 9, v10
    v_lshlrev_b32 v9, 2, v0
    v_add_u32 v9, 0x25800, v9
    v_mov_b32 v10, 0
    ds_write_b32 v9, v10
    s_mov_b32 s22, 0x20000
    s_mov_b32 s23, 0x20000
    s_mov_b32 s54, 0x10000
    s_mov_b32 s55, 0x20000
    s_mov_b32 s50, 0x20000
    s_mov_b32 s51, 0x20000
    s_mov_b32 s26, 0x20000
    s_mov_b32 s27, 0x20000
    s_mov_b32 s30, 0x10000
    s_mov_b32 s31, 0x20000
    s_mov_b32 s58, 0x100000
    s_mov_b32 s59, 0x20000
    s_mov_b32 s62, 0x300000
    s_mov_b32 s63, 0x20000
    s_mov_b32 s66, 0x100
    s_mov_b32 s67, 0x20000
    s_waitcnt lgkmcnt(0)
    s_mov_b32 s48, s10
    s_mov_b32 s49, s11
    s_add_u32 s28, s4, s34
    s_addc_u32 s29, s5, 0
    s_add_u32 s20, s6, s33
    s_addc_u32 s21, s7, 0
    s_add_u32 s52, s12, s34
    s_addc_u32 s53, s13, 0
    s_add_u32 s24, s8, s33
    s_addc_u32 s25, s9, 0
    s_add_u32 s56, s12, s32
    s_addc_u32 s57, s13, 0
    s_mov_b32 s60, s16
    s_mov_b32 s61, s17
    s_mov_b32 s64, s14
    s_mov_b32 s65, s15
    s_cmp_ge_u32 s3, 4
    s_cbranch_scc1 L_g2
    s_setprio 2
    s_lshl_b32 s33, s41, 2
    s_add_u32 s33, s33, s44
    s_lshl_b32 s33, s33, 11
    v_and_b32 v15, 15, v0
    v_lshlrev_b32 v15, 7, v15
    buffer_load_dword v12, v15, s[48:51], s33 offen
    s_mul_i32 s32, s44, 16896
    s_mov_b32 s10, s32
    s_lshl_b32 s33, s43, 2
    s_add_u32 s33, s33, s44
    s_lshl_b32 s11, s33, 14
    s_lshl_b32 s39, s40, 14
    s_add_u32 s39, s39, 0x280000
    s_mov_b32 s36, 0x3eb8aa3b
    s_mov_b32 s37, 0xbd38aa3b
    s_mov_b32 s38, 0xffff0000
    v_lshrrev_b32 v146, 4, v0
    v_and_b32 v145, 1, v0
    v_lshlrev_b32 v147, 9, v145
    v_xor_b32 v145, v145, v146
    v_lshl_add_u32 v147, v145, 4, v147
    v_bfe_u32 v144, v0, 1, 3
    v_mul_u32_u24 v144, 1056, v144
    v_add_u32 v2, v144, v147
    v_lshlrev_b32 v4, 4, v146
    v_add_u32 v4, 0x25200, v4
    v_lshlrev_b32 v5, 4, v0
    v_and_b32 v144, 3, v0
    v_lshlrev_b32 v144, 2, v144
    v_add_u32 v8, 0x25800, v144
    v_add_u32 v14, s32, v2
    v_add_u32 v14, 0x14a00, v14
    v_lshrrev_b32 v144, 2, v0
    v_lshlrev_b32 v147, 7, v144
    v_and_b32 v145, 3, v0
    v_lshl_add_u32 v147, v145, 3, v147
    v_bfe_u32 v144, v0, 3, 2
    v_lshl_add_u32 v3, v144, 5, v147
    v_lshrrev_b32 v144, 3, v0
    v_and_b32 v145, 7, v0
    v_lshlrev_b32 v145, 4, v145
    v_lshl_add_u32 v9, v144, 9, v145
    v_lshrrev_b32 v144, 4, v0
    v_bfe_u32 v145, v0, 2, 2
    v_lshlrev_b32 v146, 1, v144
    v_mov_b32 v147, 0x9c
    v_lshrrev_b32 v146, v146, v147
    v_and_b32 v146, 3, v146
    v_xor_b32 v146, v146, v145
    v_lshlrev_b32 v147, 1, v145
    v_sub_u32 v146, v146, v147
    v_mul_u32_u24 v147, 1056, v145
    v_bfe_u32 v148, v0, 1, 1
    v_lshl_add_u32 v147, v148, 9, v147
    v_and_b32 v148, 1, v0
    v_lshl_add_u32 v147, v148, 8, v147
    v_add_u32 v147, s46, v147
    v_add_u32 v148, 0, v0
    v_and_b32 v148, 3, v148
    v_lshl_add_u32 v148, v148, 2, v146
    v_and_b32 v148, 15, v148
    v_lshl_add_u32 v248, v148, 4, v147
    v_add_u32 v148, 1, v0
    v_and_b32 v148, 3, v148
    v_lshl_add_u32 v148, v148, 2, v146
    v_and_b32 v148, 15, v148
    v_lshl_add_u32 v249, v148, 4, v147
    v_add_u32 v148, 2, v0
    v_and_b32 v148, 3, v148
    v_lshl_add_u32 v148, v148, 2, v146
    v_and_b32 v148, 15, v148
    v_lshl_add_u32 v250, v148, 4, v147
    v_add_u32 v148, 3, v0
    v_and_b32 v148, 3, v148
    v_lshl_add_u32 v148, v148, 2, v146
    v_and_b32 v148, 15, v148
    v_lshl_add_u32 v251, v148, 4, v147
    v_bfe_u32 v147, v0, 1, 3
    s_lshl_b32 s34, s44, 3
    v_add_u32 v147, s34, v147
    v_lshlrev_b32 v147, 2, v147
    v_add_u32 v147, 0x25200, v147
    v_mov_b32 v148, 0x25900
    v_cmp_eq_u32 vcc, v145, v144
    v_and_b32 v145, 3, v0
    s_nop 0
    v_cndmask_b32 v6, v148, v147, vcc
    v_cmp_eq_u32 s[4:5], 1, v145
    v_cmp_eq_u32 s[6:7], 2, v145
    v_cmp_eq_u32 s[8:9], 3, v145
    v_mov_b32 v13, v1
    v_and_b32 v144, 1, v0
    v_lshlrev_b32 v144, 4, v144
    v_mov_b32 v145, 0x3f80
    v_lshlrev_b32 v145, v144, v145
    v_bfe_u32 v144, v0, 1, 3
    v_cmp_eq_u32 vcc, 0, v144
    s_nop 1
    v_cndmask_b32 v240, 0, v145, vcc
    v_cmp_eq_u32 vcc, 1, v144
    s_nop 1
    v_cndmask_b32 v241, 0, v145, vcc
    v_cmp_eq_u32 vcc, 2, v144
    s_nop 1
    v_cndmask_b32 v242, 0, v145, vcc
    v_cmp_eq_u32 vcc, 3, v144
    s_nop 1
    v_cndmask_b32 v243, 0, v145, vcc
    v_cmp_eq_u32 vcc, 4, v144
    s_nop 1
    v_cndmask_b32 v244, 0, v145, vcc
    v_cmp_eq_u32 vcc, 5, v144
    s_nop 1
    v_cndmask_b32 v245, 0, v145, vcc
    v_cmp_eq_u32 vcc, 6, v144
    s_nop 1
    v_cndmask_b32 v246, 0, v145, vcc
    v_cmp_eq_u32 vcc, 7, v144
    s_nop 1
    v_cndmask_b32 v247, 0, v145, vcc
    v_lshrrev_b32 v144, 4, v0
    v_lshlrev_b32 v145, 17, v144
    v_bfe_u32 v146, v0, 3, 1
    v_lshl_add_u32 v145, v146, 9, v145
    v_and_b32 v146, 7, v0
    v_lshl_add_u32 v7, v146, 4, v145
    v_and_b32 v145, 3, v0
    v_lshlrev_b32 v145, 10, v145
    v_lshrrev_b32 v146, 5, v0
    v_lshl_add_u32 v145, v146, 6, v145
    v_bfe_u32 v146, v0, 2, 2
    v_lshl_add_u32 v145, v146, 4, v145
    v_and_b32 v146, 1, v144
    v_lshl_add_u32 v10, v146, 3, v145
    s_lshr_b32 s34, s41, 3
    s_lshl_b32 s19, s34, 16
    s_and_b32 s34, s42, 3
    s_lshl_b32 s34, s34, 14
    s_add_u32 s19, s19, s34
    s_lshl_b32 s34, s43, 11
    s_add_u32 s19, s19, s34
    s_lshl_b32 s18, s40, 17
    s_lshl_b32 s34, s44, 15
    s_add_u32 s18, s18, s34
    s_mov_b32 s15, s18
    s_lshl_b32 s34, s42, 12
    s_add_u32 s18, s18, s34
    s_lshl_b32 s34, s43, 9
    s_add_u32 s18, s18, s34
    v_and_b32 v144, 7, v0
    s_lshl_b32 s34, s42, 10
    v_and_b32 v145, 15, v0
    s_lshl_b32 s34, s44, 7
    s_add_u32 s34, s34, 8192
    v_lshl_add_u32 v1, v145, 9, s34
    s_lshl_b32 s33, s41, 9
    s_add_u32 s101, s34, s33
    s_lshl_b32 s32, s43, 2
    s_add_u32 s32, s32, s44
    s_lshl_b32 s32, s32, 3
    s_add_u32 s32, s32, s42
    s_lshl_b32 s32, s32, 7
    v_lshl_add_u32 v11, v0, 2, s32
    s_sub_u32 s101, s101, s32
    s_add_u32 s101, s101, s39
    s_lshl_b32 s14, s40, 4
    s_add_u32 s14, s14, s41
    s_lshl_b32 s14, s14, 2
    s_add_u32 s14, s14, s44
    s_lshl_b32 s14, s14, 7
    s_add_u32 s14, s14, 0x1dae00
    s_lshl_b32 s33, s44, 2
    s_add_u32 s33, s33, 0x25800
    v_mov_b32 v0, s33
    s_waitcnt vmcnt(0)
    s_add_u32 m0, s10, 84480
    s_add_u32 s100, s11, 0
    buffer_load_dwordx4 v13, s[48:51], s100 offen offset:0 lds
    s_add_u32 m0, m0, 32
    s_nop 0
    buffer_load_dwordx4 v13, s[48:51], s100 offen offset:1024 lds
    s_add_u32 m0, m0, 32
    s_nop 0
    buffer_load_dwordx4 v13, s[48:51], s100 offen offset:2048 lds
    s_add_u32 m0, m0, 32
    s_nop 0
    buffer_load_dwordx4 v13, s[48:51], s100 offen offset:3072 lds
    s_add_u32 m0, s10, 88704
    s_add_u32 s100, s11, 4096
    buffer_load_dwordx4 v13, s[48:51], s100 offen offset:0 lds
    s_add_u32 m0, m0, 32
    s_nop 0
    buffer_load_dwordx4 v13, s[48:51], s100 offen offset:1024 lds
    s_add_u32 m0, m0, 32
    s_nop 0
    buffer_load_dwordx4 v13, s[48:51], s100 offen offset:2048 lds
    s_add_u32 m0, m0, 32
    s_nop 0
    buffer_load_dwordx4 v13, s[48:51], s100 offen offset:3072 lds
    s_add_u32 m0, s10, 92928
    s_add_u32 s100, s11, 8192
    buffer_load_dwordx4 v13, s[48:51], s100 offen offset:0 lds
    s_add_u32 m0, m0, 32
    s_nop 0
    buffer_load_dwordx4 v13, s[48:51], s100 offen offset:1024 lds
    s_add_u32 m0, m0, 32
    s_nop 0
    buffer_load_dwordx4 v13, s[48:51], s100 offen offset:2048 lds
    s_add_u32 m0, m0, 32
    s_nop 0
    buffer_load_dwordx4 v13, s[48:51], s100 offen offset:3072 lds
    s_add_u32 m0, s10, 97152
    s_add_u32 s100, s11, 12288
    buffer_load_dwordx4 v13, s[48:51], s100 offen offset:0 lds
    s_add_u32 m0, m0, 32
    s_nop 0
    buffer_load_dwordx4 v13, s[48:51], s100 offen offset:1024 lds
    s_add_u32 m0, m0, 32
    s_nop 0
    buffer_load_dwordx4 v13, s[48:51], s100 offen offset:2048 lds
    s_add_u32 m0, m0, 32
    s_nop 0
    buffer_load_dwordx4 v13, s[48:51], s100 offen offset:3072 lds
    s_barrier
    s_lshl_b32 s10, s44, 14
    s_add_u32 s11, s10, 4096
    s_add_u32 s12, s10, 8192
    s_add_u32 s13, s10, 12288
    s_waitcnt vmcnt(0)
    ds_read_b128 v[16:19], v14 offset:0
    ds_read_b128 v[20:23], v14 offset:8448
    ds_read_b128 v[24:27], v14 offset:64
    ds_read_b128 v[28:31], v14 offset:8512
    ds_read_b128 v[32:35], v14 offset:128
    ds_read_b128 v[36:39], v14 offset:8576
    ds_read_b128 v[40:43], v14 offset:192
    ds_read_b128 v[44:47], v14 offset:8640
    ds_read_b128 v[48:51], v14 offset:256
    ds_read_b128 v[52:55], v14 offset:8704
    ds_read_b128 v[56:59], v14 offset:320
    ds_read_b128 v[60:63], v14 offset:8768
    ds_read_b128 v[64:67], v14 offset:384
    ds_read_b128 v[68:71], v14 offset:8832
    ds_read_b128 v[72:75], v14 offset:448
    ds_read_b128 v[76:79], v14 offset:8896
    v_mov_b32 v254, 1
    ds_write_b32 v0, v254 offset:0
    v_mov_b32 v150, s36
    v_mov_b32 v151, s36
    s_waitcnt lgkmcnt(15)
    v_lshlrev_b32 v152, 16, v16
    v_and_b32 v153, s38, v16
    v_pk_mul_f32 v[152:153], v[152:153], v[150:151]
    v_cvt_pk_bf16_f32 v16, v152, v153
    v_lshlrev_b32 v154, 16, v17
    v_and_b32 v155, s38, v17
    v_pk_mul_f32 v[154:155], v[154:155], v[150:151]
    v_cvt_pk_bf16_f32 v17, v154, v155
    v_lshlrev_b32 v152, 16, v18
    v_and_b32 v153, s38, v18
    v_pk_mul_f32 v[152:153], v[152:153], v[150:151]
    v_cvt_pk_bf16_f32 v18, v152, v153
    v_lshlrev_b32 v154, 16, v19
    v_and_b32 v155, s38, v19
    v_pk_mul_f32 v[154:155], v[154:155], v[150:151]
    v_cvt_pk_bf16_f32 v19, v154, v155
    v_lshlrev_b32 v152, 16, v20
    v_and_b32 v153, s38, v20
    v_pk_mul_f32 v[152:153], v[152:153], v[150:151]
    v_cvt_pk_bf16_f32 v20, v152, v153
    v_lshlrev_b32 v154, 16, v21
    v_and_b32 v155, s38, v21
    v_pk_mul_f32 v[154:155], v[154:155], v[150:151]
    v_cvt_pk_bf16_f32 v21, v154, v155
    v_lshlrev_b32 v152, 16, v22
    v_and_b32 v153, s38, v22
    v_pk_mul_f32 v[152:153], v[152:153], v[150:151]
    v_cvt_pk_bf16_f32 v22, v152, v153
    v_lshlrev_b32 v154, 16, v23
    v_and_b32 v155, s38, v23
    v_pk_mul_f32 v[154:155], v[154:155], v[150:151]
    v_cvt_pk_bf16_f32 v23, v154, v155
    s_waitcnt lgkmcnt(13)
    v_lshlrev_b32 v152, 16, v24
    v_and_b32 v153, s38, v24
    v_pk_mul_f32 v[152:153], v[152:153], v[150:151]
    v_cvt_pk_bf16_f32 v24, v152, v153
    v_lshlrev_b32 v154, 16, v25
    v_and_b32 v155, s38, v25
    v_pk_mul_f32 v[154:155], v[154:155], v[150:151]
    v_cvt_pk_bf16_f32 v25, v154, v155
    v_lshlrev_b32 v152, 16, v26
    v_and_b32 v153, s38, v26
    v_pk_mul_f32 v[152:153], v[152:153], v[150:151]
    v_cvt_pk_bf16_f32 v26, v152, v153
    v_lshlrev_b32 v154, 16, v27
    v_and_b32 v155, s38, v27
    v_pk_mul_f32 v[154:155], v[154:155], v[150:151]
    v_cvt_pk_bf16_f32 v27, v154, v155
    v_lshlrev_b32 v152, 16, v28
    v_and_b32 v153, s38, v28
    v_pk_mul_f32 v[152:153], v[152:153], v[150:151]
    v_cvt_pk_bf16_f32 v28, v152, v153
    v_lshlrev_b32 v154, 16, v29
    v_and_b32 v155, s38, v29
    v_pk_mul_f32 v[154:155], v[154:155], v[150:151]
    v_cvt_pk_bf16_f32 v29, v154, v155
    v_lshlrev_b32 v152, 16, v30
    v_and_b32 v153, s38, v30
    v_pk_mul_f32 v[152:153], v[152:153], v[150:151]
    v_cvt_pk_bf16_f32 v30, v152, v153
    v_lshlrev_b32 v154, 16, v31
    v_and_b32 v155, s38, v31
    v_pk_mul_f32 v[154:155], v[154:155], v[150:151]
    v_cvt_pk_bf16_f32 v31, v154, v155
    s_waitcnt lgkmcnt(11)
    v_lshlrev_b32 v152, 16, v32
    v_and_b32 v153, s38, v32
    v_pk_mul_f32 v[152:153], v[152:153], v[150:151]
    v_cvt_pk_bf16_f32 v32, v152, v153
    v_lshlrev_b32 v154, 16, v33
    v_and_b32 v155, s38, v33
    v_pk_mul_f32 v[154:155], v[154:155], v[150:151]
    v_cvt_pk_bf16_f32 v33, v154, v155
    v_lshlrev_b32 v152, 16, v34
    v_and_b32 v153, s38, v34
    v_pk_mul_f32 v[152:153], v[152:153], v[150:151]
    v_cvt_pk_bf16_f32 v34, v152, v153
    v_lshlrev_b32 v154, 16, v35
    v_and_b32 v155, s38, v35
    v_pk_mul_f32 v[154:155], v[154:155], v[150:151]
    v_cvt_pk_bf16_f32 v35, v154, v155
    v_lshlrev_b32 v152, 16, v36
    v_and_b32 v153, s38, v36
    v_pk_mul_f32 v[152:153], v[152:153], v[150:151]
    v_cvt_pk_bf16_f32 v36, v152, v153
    v_lshlrev_b32 v154, 16, v37
    v_and_b32 v155, s38, v37
    v_pk_mul_f32 v[154:155], v[154:155], v[150:151]
    v_cvt_pk_bf16_f32 v37, v154, v155
    v_lshlrev_b32 v152, 16, v38
    v_and_b32 v153, s38, v38
    v_pk_mul_f32 v[152:153], v[152:153], v[150:151]
    v_cvt_pk_bf16_f32 v38, v152, v153
    v_lshlrev_b32 v154, 16, v39
    v_and_b32 v155, s38, v39
    v_pk_mul_f32 v[154:155], v[154:155], v[150:151]
    v_cvt_pk_bf16_f32 v39, v154, v155
    s_waitcnt lgkmcnt(9)
    v_lshlrev_b32 v152, 16, v40
    v_and_b32 v153, s38, v40
    v_pk_mul_f32 v[152:153], v[152:153], v[150:151]
    v_cvt_pk_bf16_f32 v40, v152, v153
    v_lshlrev_b32 v154, 16, v41
    v_and_b32 v155, s38, v41
    v_pk_mul_f32 v[154:155], v[154:155], v[150:151]
    v_cvt_pk_bf16_f32 v41, v154, v155
    v_lshlrev_b32 v152, 16, v42
    v_and_b32 v153, s38, v42
    v_pk_mul_f32 v[152:153], v[152:153], v[150:151]
    v_cvt_pk_bf16_f32 v42, v152, v153
    v_lshlrev_b32 v154, 16, v43
    v_and_b32 v155, s38, v43
    v_pk_mul_f32 v[154:155], v[154:155], v[150:151]
    v_cvt_pk_bf16_f32 v43, v154, v155
    v_lshlrev_b32 v152, 16, v44
    v_and_b32 v153, s38, v44
    v_pk_mul_f32 v[152:153], v[152:153], v[150:151]
    v_cvt_pk_bf16_f32 v44, v152, v153
    v_lshlrev_b32 v154, 16, v45
    v_and_b32 v155, s38, v45
    v_pk_mul_f32 v[154:155], v[154:155], v[150:151]
    v_cvt_pk_bf16_f32 v45, v154, v155
    v_lshlrev_b32 v152, 16, v46
    v_and_b32 v153, s38, v46
    v_pk_mul_f32 v[152:153], v[152:153], v[150:151]
    v_cvt_pk_bf16_f32 v46, v152, v153
    v_lshlrev_b32 v154, 16, v47
    v_and_b32 v155, s38, v47
    v_pk_mul_f32 v[154:155], v[154:155], v[150:151]
    v_cvt_pk_bf16_f32 v47, v154, v155
    s_waitcnt lgkmcnt(7)
    v_lshlrev_b32 v152, 16, v48
    v_and_b32 v153, s38, v48
    v_pk_mul_f32 v[152:153], v[152:153], v[150:151]
    v_cvt_pk_bf16_f32 v48, v152, v153
    v_lshlrev_b32 v154, 16, v49
    v_and_b32 v155, s38, v49
    v_pk_mul_f32 v[154:155], v[154:155], v[150:151]
    v_cvt_pk_bf16_f32 v49, v154, v155
    v_lshlrev_b32 v152, 16, v50
    v_and_b32 v153, s38, v50
    v_pk_mul_f32 v[152:153], v[152:153], v[150:151]
    v_cvt_pk_bf16_f32 v50, v152, v153
    v_lshlrev_b32 v154, 16, v51
    v_and_b32 v155, s38, v51
    v_pk_mul_f32 v[154:155], v[154:155], v[150:151]
    v_cvt_pk_bf16_f32 v51, v154, v155
    v_lshlrev_b32 v152, 16, v52
    v_and_b32 v153, s38, v52
    v_pk_mul_f32 v[152:153], v[152:153], v[150:151]
    v_cvt_pk_bf16_f32 v52, v152, v153
    v_lshlrev_b32 v154, 16, v53
    v_and_b32 v155, s38, v53
    v_pk_mul_f32 v[154:155], v[154:155], v[150:151]
    v_cvt_pk_bf16_f32 v53, v154, v155
    v_lshlrev_b32 v152, 16, v54
    v_and_b32 v153, s38, v54
    v_pk_mul_f32 v[152:153], v[152:153], v[150:151]
    v_cvt_pk_bf16_f32 v54, v152, v153
    v_lshlrev_b32 v154, 16, v55
    v_and_b32 v155, s38, v55
    v_pk_mul_f32 v[154:155], v[154:155], v[150:151]
    v_cvt_pk_bf16_f32 v55, v154, v155
    s_waitcnt lgkmcnt(5)
    v_lshlrev_b32 v152, 16, v56
    v_and_b32 v153, s38, v56
    v_pk_mul_f32 v[152:153], v[152:153], v[150:151]
    v_cvt_pk_bf16_f32 v56, v152, v153
    v_lshlrev_b32 v154, 16, v57
    v_and_b32 v155, s38, v57
    v_pk_mul_f32 v[154:155], v[154:155], v[150:151]
    v_cvt_pk_bf16_f32 v57, v154, v155
    v_lshlrev_b32 v152, 16, v58
    v_and_b32 v153, s38, v58
    v_pk_mul_f32 v[152:153], v[152:153], v[150:151]
    v_cvt_pk_bf16_f32 v58, v152, v153
    v_lshlrev_b32 v154, 16, v59
    v_and_b32 v155, s38, v59
    v_pk_mul_f32 v[154:155], v[154:155], v[150:151]
    v_cvt_pk_bf16_f32 v59, v154, v155
    v_lshlrev_b32 v152, 16, v60
    v_and_b32 v153, s38, v60
    v_pk_mul_f32 v[152:153], v[152:153], v[150:151]
    v_cvt_pk_bf16_f32 v60, v152, v153
    v_lshlrev_b32 v154, 16, v61
    v_and_b32 v155, s38, v61
    v_pk_mul_f32 v[154:155], v[154:155], v[150:151]
    v_cvt_pk_bf16_f32 v61, v154, v155
    v_lshlrev_b32 v152, 16, v62
    v_and_b32 v153, s38, v62
    v_pk_mul_f32 v[152:153], v[152:153], v[150:151]
    v_cvt_pk_bf16_f32 v62, v152, v153
    v_lshlrev_b32 v154, 16, v63
    v_and_b32 v155, s38, v63
    v_pk_mul_f32 v[154:155], v[154:155], v[150:151]
    v_cvt_pk_bf16_f32 v63, v154, v155
    s_waitcnt lgkmcnt(3)
    v_lshlrev_b32 v152, 16, v64
    v_and_b32 v153, s38, v64
    v_pk_mul_f32 v[152:153], v[152:153], v[150:151]
    v_cvt_pk_bf16_f32 v64, v152, v153
    v_lshlrev_b32 v154, 16, v65
    v_and_b32 v155, s38, v65
    v_pk_mul_f32 v[154:155], v[154:155], v[150:151]
    v_cvt_pk_bf16_f32 v65, v154, v155
    v_lshlrev_b32 v152, 16, v66
    v_and_b32 v153, s38, v66
    v_pk_mul_f32 v[152:153], v[152:153], v[150:151]
    v_cvt_pk_bf16_f32 v66, v152, v153
    v_lshlrev_b32 v154, 16, v67
    v_and_b32 v155, s38, v67
    v_pk_mul_f32 v[154:155], v[154:155], v[150:151]
    v_cvt_pk_bf16_f32 v67, v154, v155
    v_lshlrev_b32 v152, 16, v68
    v_and_b32 v153, s38, v68
    v_pk_mul_f32 v[152:153], v[152:153], v[150:151]
    v_cvt_pk_bf16_f32 v68, v152, v153
    v_lshlrev_b32 v154, 16, v69
    v_and_b32 v155, s38, v69
    v_pk_mul_f32 v[154:155], v[154:155], v[150:151]
    v_cvt_pk_bf16_f32 v69, v154, v155
    v_lshlrev_b32 v152, 16, v70
    v_and_b32 v153, s38, v70
    v_pk_mul_f32 v[152:153], v[152:153], v[150:151]
    v_cvt_pk_bf16_f32 v70, v152, v153
    v_lshlrev_b32 v154, 16, v71
    v_and_b32 v155, s38, v71
    v_pk_mul_f32 v[154:155], v[154:155], v[150:151]
    v_cvt_pk_bf16_f32 v71, v154, v155
    s_waitcnt lgkmcnt(1)
    v_lshlrev_b32 v152, 16, v72
    v_and_b32 v153, s38, v72
    v_pk_mul_f32 v[152:153], v[152:153], v[150:151]
    v_cvt_pk_bf16_f32 v72, v152, v153
    v_lshlrev_b32 v154, 16, v73
    v_and_b32 v155, s38, v73
    v_pk_mul_f32 v[154:155], v[154:155], v[150:151]
    v_cvt_pk_bf16_f32 v73, v154, v155
    v_lshlrev_b32 v152, 16, v74
    v_and_b32 v153, s38, v74
    v_pk_mul_f32 v[152:153], v[152:153], v[150:151]
    v_cvt_pk_bf16_f32 v74, v152, v153
    v_lshlrev_b32 v154, 16, v75
    v_and_b32 v155, s38, v75
    v_pk_mul_f32 v[154:155], v[154:155], v[150:151]
    v_cvt_pk_bf16_f32 v75, v154, v155
    v_lshlrev_b32 v152, 16, v76
    v_and_b32 v153, s38, v76
    v_pk_mul_f32 v[152:153], v[152:153], v[150:151]
    v_cvt_pk_bf16_f32 v76, v152, v153
    v_lshlrev_b32 v154, 16, v77
    v_and_b32 v155, s38, v77
    v_pk_mul_f32 v[154:155], v[154:155], v[150:151]
    v_cvt_pk_bf16_f32 v77, v154, v155
    v_lshlrev_b32 v152, 16, v78
    v_and_b32 v153, s38, v78
    v_pk_mul_f32 v[152:153], v[152:153], v[150:151]
    v_cvt_pk_bf16_f32 v78, v152, v153
    v_lshlrev_b32 v154, 16, v79
    v_and_b32 v155, s38, v79
    v_pk_mul_f32 v[154:155], v[154:155], v[150:151]
    v_cvt_pk_bf16_f32 v79, v154, v155
    s_mov_b32 s34, 1048576
L_lw_1:
    ds_read_b32 v255, v8 offset:48
    s_waitcnt lgkmcnt(0)
    v_cmp_gt_u32 vcc, 1, v255
    s_cbranch_vccz L_lwd_2
    s_sub_u32 s34, s34, 1
    s_cbranch_scc0 L_lw_1
L_lwd_2:
    s_mov_b32 s34, 1048576
L_lw_3:
    ds_read_b32 v255, v8 offset:16
    s_waitcnt lgkmcnt(0)
    v_cmp_gt_u32 vcc, 1, v255
    s_cbranch_vccz L_lwd_4
    s_sub_u32 s34, s34, 1
    s_cbranch_scc0 L_lw_3
L_lwd_4:
    ds_read_b128 v[160:163], v4 offset:0
    ds_read_b128 v[164:167], v4 offset:64
    ds_read_b128 v[208:211], v2 offset:0
    ds_read_b128 v[212:215], v2 offset:8448
    ds_read_b128 v[216:219], v2 offset:64
    ds_read_b128 v[220:223], v2 offset:8512
    ds_read_b128 v[224:227], v2 offset:128
    ds_read_b128 v[228:231], v2 offset:8576
    ds_read_b128 v[232:235], v2 offset:192
    s_waitcnt lgkmcnt(3)
    v_mfma_f32_16x16x32_bf16 v[144:147], v[208:211], v[16:19], v[160:163]
    v_mfma_f32_16x16x32_bf16 v[152:155], v[208:211], v[20:23], v[160:163]
    ds_read_b128 v[236:239], v2 offset:8640
    v_mfma_f32_16x16x32_bf16 v[148:151], v[212:215], v[16:19], v[164:167]
    ds_read_b128 v[192:195], v248 offset:33792
    ds_read_b128 v[196:199], v249 offset:33792
    v_mfma_f32_16x16x32_bf16 v[156:159], v[212:215], v[20:23], v[164:167]
    ds_read_b128 v[208:211], v2 offset:256
    ds_read_b128 v[200:203], v250 offset:33792
    v_mfma_f32_16x16x32_bf16 v[144:147], v[216:219], v[24:27], v[144:147]
    ds_read_b128 v[204:207], v251 offset:33792
    ds_read_b128 v[168:171], v4 offset:128
    v_mfma_f32_16x16x32_bf16 v[152:155], v[216:219], v[28:31], v[152:155]
    ds_read_b128 v[212:215], v2 offset:8704
    ds_read_b128 v[172:175], v4 offset:192
    v_mfma_f32_16x16x32_bf16 v[148:151], v[220:223], v[24:27], v[148:151]
    v_mfma_f32_16x16x32_bf16 v[156:159], v[220:223], v[28:31], v[156:159]
    ds_read_b128 v[216:219], v2 offset:320
    s_waitcnt lgkmcnt(9)
    v_mfma_f32_16x16x32_bf16 v[144:147], v[224:227], v[32:35], v[144:147]
    v_add_u32 v248, 0x10800, v248
    v_add_u32 v249, 0x10800, v249
    v_mfma_f32_16x16x32_bf16 v[152:155], v[224:227], v[36:39], v[152:155]
    ds_read_b128 v[220:223], v2 offset:8768
    v_add_u32 v250, 0x10800, v250
    v_mfma_f32_16x16x32_bf16 v[148:151], v[228:231], v[32:35], v[148:151]
    v_add_u32 v251, 0x10800, v251
    v_mfma_f32_16x16x32_bf16 v[156:159], v[228:231], v[36:39], v[156:159]
    ds_read_b128 v[224:227], v2 offset:384
    v_mfma_f32_16x16x32_bf16 v[144:147], v[232:235], v[40:43], v[144:147]
    v_mfma_f32_16x16x32_bf16 v[152:155], v[232:235], v[44:47], v[152:155]
    ds_read_b128 v[228:231], v2 offset:8832
    v_mfma_f32_16x16x32_bf16 v[148:151], v[236:239], v[40:43], v[148:151]
    v_mfma_f32_16x16x32_bf16 v[156:159], v[236:239], v[44:47], v[156:159]
    ds_read_b128 v[232:235], v2 offset:448
    s_waitcnt lgkmcnt(3)
    v_mfma_f32_16x16x32_bf16 v[144:147], v[208:211], v[48:51], v[144:147]
    v_mfma_f32_16x16x32_bf16 v[152:155], v[208:211], v[52:55], v[152:155]
    v_mfma_f32_16x16x32_bf16 v[12:15], v[192:195], v[192:195], 0
    ds_read_b128 v[236:239], v2 offset:8896
    v_mfma_f32_16x16x32_bf16 v[148:151], v[212:215], v[48:51], v[148:151]
    v_mfma_f32_16x16x32_bf16 v[156:159], v[212:215], v[52:55], v[156:159]
    v_mfma_f32_16x16x32_bf16 v[12:15], v[196:199], v[196:199], v[12:15]
    ds_read_b128 v[208:211], v2 offset:16896
    v_mfma_f32_16x16x32_bf16 v[144:147], v[216:219], v[56:59], v[144:147]
    ds_read_b32 v255, v8 offset:16
    v_mfma_f32_16x16x32_bf16 v[152:155], v[216:219], v[60:63], v[152:155]
    v_mfma_f32_16x16x32_bf16 v[12:15], v[200:203], v[200:203], v[12:15]
    ds_read_b128 v[212:215], v2 offset:25344
    v_mfma_f32_16x16x32_bf16 v[148:151], v[220:223], v[56:59], v[148:151]
    v_mfma_f32_16x16x32_bf16 v[156:159], v[220:223], v[60:63], v[156:159]
    v_mfma_f32_16x16x32_bf16 v[12:15], v[204:207], v[204:207], v[12:15]
    ds_read_b128 v[216:219], v2 offset:16960
    s_waitcnt lgkmcnt(4)
    v_mfma_f32_16x16x32_bf16 v[144:147], v[224:227], v[64:67], v[144:147]
    v_mfma_f32_16x16x32_bf16 v[152:155], v[224:227], v[68:71], v[152:155]
    ds_read_b128 v[220:223], v2 offset:25408
    v_mfma_f32_16x16x32_bf16 v[148:151], v[228:231], v[64:67], v[148:151]
    s_nop 1
    v_cndmask_b32 v12, v12, v13, s[4:5]
    v_cndmask_b32 v12, v12, v14, s[6:7]
    v_mfma_f32_16x16x32_bf16 v[156:159], v[228:231], v[68:71], v[156:159]
    ds_read_b128 v[224:227], v2 offset:17024
    v_cndmask_b32 v12, v12, v15, s[8:9]
    v_mfma_f32_16x16x32_bf16 v[144:147], v[232:235], v[72:75], v[144:147]
    v_mov_b32 v254, 2
    v_mfma_f32_16x16x32_bf16 v[152:155], v[232:235], v[76:79], v[152:155]
    ds_read_b128 v[228:231], v2 offset:25472
    v_add_f32_dpp v12, v12, v12 quad_perm:[1,0,3,2] row_mask:0xf bank_mask:0xf
    v_mfma_f32_16x16x32_bf16 v[148:151], v[236:239], v[72:75], v[148:151]
    v_fma_f32 v12, v12, s37, -4.0
    v_mfma_f32_16x16x32_bf16 v[156:159], v[236:239], v[76:79], v[156:159]
    ds_read_b128 v[232:235], v2 offset:17088
    s_waitcnt lgkmcnt(3)
    v_mfma_f32_16x16x32_bf16 v[176:179], v[208:211], v[16:19], v[168:171]
    ds_write_b32 v6, v12 offset:256
    ds_write_b32 v0, v254 offset:0
    v_cmp_gt_u32 vcc, 3, v255
    v_mfma_f32_16x16x32_bf16 v[184:187], v[208:211], v[20:23], v[168:171]
    ds_read_b128 v[236:239], v2 offset:25536
    s_cbranch_vccnz L_spin_5
L_go_6:
    v_mfma_f32_16x16x32_bf16 v[180:183], v[212:215], v[16:19], v[172:175]
    v_exp_f32 v144, v144
    v_mfma_f32_16x16x32_bf16 v[188:191], v[212:215], v[20:23], v[172:175]
    ds_read_b128 v[208:211], v2 offset:17152
    ds_read_b128 v[192:195], v248 offset:0
    ds_read_b128 v[196:199], v249 offset:0
    v_mfma_f32_16x16x32_bf16 v[176:179], v[216:219], v[24:27], v[176:179]
    v_exp_f32 v145, v145
    v_mfma_f32_16x16x32_bf16 v[184:187], v[216:219], v[28:31], v[184:187]
    ds_read_b128 v[212:215], v2 offset:25600
    ds_read_b128 v[200:203], v250 offset:0
    ds_read_b128 v[204:207], v251 offset:0
    v_mfma_f32_16x16x32_bf16 v[180:183], v[220:223], v[24:27], v[180:183]
    ds_read_b32 v255, v8 offset:0
    v_cvt_pk_bf16_f32 v80, v144, v145
    v_mfma_f32_16x16x32_bf16 v[188:191], v[220:223], v[28:31], v[188:191]
    ds_read_b128 v[216:219], v2 offset:17216
    s_waitcnt lgkmcnt(8)
    v_mfma_f32_16x16x32_bf16 v[176:179], v[224:227], v[32:35], v[176:179]
    v_exp_f32 v146, v146
    v_mfma_f32_16x16x32_bf16 v[184:187], v[224:227], v[36:39], v[184:187]
    ds_read_b128 v[220:223], v2 offset:25664
    v_mfma_f32_16x16x32_bf16 v[180:183], v[228:231], v[32:35], v[180:183]
    v_exp_f32 v147, v147
    v_mfma_f32_16x16x32_bf16 v[188:191], v[228:231], v[36:39], v[188:191]
    ds_read_b128 v[224:227], v2 offset:17280
    v_cvt_pk_bf16_f32 v81, v146, v147
    v_mfma_f32_16x16x32_bf16 v[176:179], v[232:235], v[40:43], v[176:179]
    v_exp_f32 v148, v148
    v_mfma_f32_16x16x32_bf16 v[184:187], v[232:235], v[44:47], v[184:187]
    ds_read_b128 v[228:231], v2 offset:25728
    v_exp_f32 v149, v149
    v_mfma_f32_16x16x32_bf16 v[180:183], v[236:239], v[40:43], v[180:183]
    v_exp_f32 v150, v150
    v_mfma_f32_16x16x32_bf16 v[188:191], v[236:239], v[44:47], v[188:191]
    ds_read_b128 v[232:235], v2 offset:17344
    s_waitcnt lgkmcnt(3)
    v_mfma_f32_16x16x32_bf16 v[176:179], v[208:211], v[48:51], v[176:179]
    v_cmp_gt_u32 vcc, 2, v255
    v_cvt_pk_bf16_f32 v82, v148, v149
    v_mfma_f32_16x16x32_bf16 v[184:187], v[208:211], v[52:55], v[184:187]
    s_cbranch_vccnz L_spin_7
L_go_8:
    v_mfma_f32_16x16x32_bf16 v[12:15], v[192:195], v[192:195], 0
    ds_read_b128 v[236:239], v2 offset:25792
    v_exp_f32 v151, v151
    v_mfma_f32_16x16x32_bf16 v[180:183], v[212:215], v[48:51], v[180:183]
    v_exp_f32 v152, v152
    v_mfma_f32_16x16x32_bf16 v[188:191], v[212:215], v[52:55], v[188:191]
    v_exp_f32 v153, v153
    v_mfma_f32_16x16x32_bf16 v[12:15], v[196:199], v[196:199], v[12:15]
    ds_read_b128 v[208:211], v2 offset:33792
    ds_read_b128 v[160:163], v4 offset:256
    v_mfma_f32_16x16x32_bf16 v[176:179], v[216:219], v[56:59], v[176:179]
    v_exp_f32 v154, v154
    v_mfma_f32_16x16x32_bf16 v[184:187], v[216:219], v[60:63], v[184:187]
    v_exp_f32 v155, v155
    v_mfma_f32_16x16x32_bf16 v[12:15], v[200:203], v[200:203], v[12:15]
    ds_read_b128 v[212:215], v2 offset:42240
    ds_read_b128 v[164:167], v4 offset:320
    v_mfma_f32_16x16x32_bf16 v[180:183], v[220:223], v[56:59], v[180:183]
    ds_read_b32 v255, v8 offset:16
    v_cvt_pk_bf16_f32 v83, v150, v151
    v_mfma_f32_16x16x32_bf16 v[188:191], v[220:223], v[60:63], v[188:191]
    v_exp_f32 v156, v156
    v_mfma_f32_16x16x32_bf16 v[12:15], v[204:207], v[204:207], v[12:15]
    ds_read_b128 v[216:219], v2 offset:33856
    s_waitcnt lgkmcnt(6)
    v_mfma_f32_16x16x32_bf16 v[176:179], v[224:227], v[64:67], v[176:179]
    v_exp_f32 v157, v157
    v_mfma_f32_16x16x32_bf16 v[184:187], v[224:227], v[68:71], v[184:187]
    ds_read_b128 v[220:223], v2 offset:42304
    v_cvt_pk_bf16_f32 v84, v152, v153
    v_mfma_f32_16x16x32_bf16 v[180:183], v[228:231], v[64:67], v[180:183]
    v_exp_f32 v158, v158
    v_mfma_f32_16x16x32_bf16 v[188:191], v[228:231], v[68:71], v[188:191]
    ds_read_b128 v[224:227], v2 offset:33920
    v_cvt_pk_bf16_f32 v85, v154, v155
    v_cvt_pk_bf16_f32 v86, v156, v157
    v_mfma_f32_16x16x32_bf16 v[176:179], v[232:235], v[72:75], v[176:179]
    v_exp_f32 v159, v159
    v_mfma_f32_16x16x32_bf16 v[184:187], v[232:235], v[76:79], v[184:187]
    ds_read_b128 v[228:231], v2 offset:42368
    v_cvt_pk_bf16_f32 v87, v158, v159
    v_cndmask_b32 v12, v12, v13, s[4:5]
    v_mfma_f32_16x16x32_bf16 v[180:183], v[236:239], v[72:75], v[180:183]
    v_cndmask_b32 v12, v12, v14, s[6:7]
    v_cndmask_b32 v12, v12, v15, s[8:9]
    v_mfma_f32_16x16x32_bf16 v[188:191], v[236:239], v[76:79], v[188:191]
    ds_read_b128 v[232:235], v2 offset:33984
    v_mov_b32 v254, 3
    s_waitcnt lgkmcnt(3)
    v_mfma_f32_16x16x32_bf16 v[144:147], v[208:211], v[16:19], v[160:163]
    v_add_f32_dpp v12, v12, v12 quad_perm:[1,0,3,2] row_mask:0xf bank_mask:0xf
    v_fma_f32 v12, v12, s37, -4.0
    v_cmp_gt_u32 vcc, 4, v255
    v_mfma_f32_16x16x32_bf16 v[152:155], v[208:211], v[20:23], v[160:163]
    ds_read_b128 v[236:239], v2 offset:42432
    ds_write_b32 v6, v12 offset:384
    ds_write_b32 v0, v254 offset:0
    s_cbranch_vccnz L_spin_9
L_go_10:
    v_mfma_f32_16x16x32_bf16 v[148:151], v[212:215], v[16:19], v[164:167]
    v_exp_f32 v176, v176
    v_mfma_f32_16x16x32_bf16 v[156:159], v[212:215], v[20:23], v[164:167]
    ds_read_b128 v[208:211], v2 offset:34048
    ds_read_b128 v[192:195], v248 offset:16896
    ds_read_b128 v[196:199], v249 offset:16896
    v_mfma_f32_16x16x32_bf16 v[144:147], v[216:219], v[24:27], v[144:147]
    v_exp_f32 v177, v177
    v_mfma_f32_16x16x32_bf16 v[152:155], v[216:219], v[28:31], v[152:155]
    ds_read_b128 v[212:215], v2 offset:42496
    ds_read_b128 v[200:203], v250 offset:16896
    ds_read_b128 v[204:207], v251 offset:16896
    v_mfma_f32_16x16x32_bf16 v[148:151], v[220:223], v[24:27], v[148:151]
    ds_read_b32 v255, v8 offset:0
    v_add_u32 v252, 0xc600, v2
    v_mfma_f32_16x16x32_bf16 v[156:159], v[220:223], v[28:31], v[156:159]
    ds_read_b128 v[216:219], v2 offset:34112
    s_waitcnt lgkmcnt(10)
    v_mfma_f32_16x16x32_bf16 v[144:147], v[224:227], v[32:35], v[144:147]
    v_exp_f32 v178, v178
    v_mfma_f32_16x16x32_bf16 v[152:155], v[224:227], v[36:39], v[152:155]
    ds_read_b128 v[220:223], v2 offset:42560
    v_cvt_pk_bf16_f32 v88, v176, v177
    v_mfma_f32_16x16x32_bf16 v[148:151], v[228:231], v[32:35], v[148:151]
    v_exp_f32 v179, v179
    v_mfma_f32_16x16x32_bf16 v[156:159], v[228:231], v[36:39], v[156:159]
    ds_read_b128 v[224:227], v2 offset:34176
    v_cvt_pk_bf16_f32 v89, v178, v179
    v_add_u32 v248, 0xfffef800, v248
    v_mfma_f32_16x16x32_bf16 v[144:147], v[232:235], v[40:43], v[144:147]
    v_exp_f32 v180, v180
    v_mfma_f32_16x16x32_bf16 v[152:155], v[232:235], v[44:47], v[152:155]
    ds_read_b128 v[228:231], v2 offset:42624
    v_add_u32 v249, 0xfffef800, v249
    v_add_u32 v250, 0xfffef800, v250
    v_mfma_f32_16x16x32_bf16 v[148:151], v[236:239], v[40:43], v[148:151]
    v_exp_f32 v181, v181
    v_mfma_f32_16x16x32_bf16 v[156:159], v[236:239], v[44:47], v[156:159]
    ds_read_b128 v[232:235], v2 offset:34240
    s_waitcnt lgkmcnt(3)
    v_mfma_f32_16x16x32_bf16 v[144:147], v[208:211], v[48:51], v[144:147]
    v_cmp_gt_u32 vcc, 3, v255
    v_cvt_pk_bf16_f32 v90, v180, v181
    v_mfma_f32_16x16x32_bf16 v[152:155], v[208:211], v[52:55], v[152:155]
    s_cbranch_vccnz L_spin_11
L_go_12:
    v_add_u32 v251, 0xfffef800, v251
    v_mfma_f32_16x16x32_bf16 v[12:15], v[192:195], v[192:195], 0
    ds_read_b128 v[236:239], v2 offset:42688
    v_exp_f32 v182, v182
    v_mfma_f32_16x16x32_bf16 v[148:151], v[212:215], v[48:51], v[148:151]
    v_exp_f32 v183, v183
    v_mfma_f32_16x16x32_bf16 v[156:159], v[212:215], v[52:55], v[156:159]
    v_exp_f32 v184, v184
    v_mfma_f32_16x16x32_bf16 v[12:15], v[196:199], v[196:199], v[12:15]
    ds_read_b128 v[208:211], v252 offset:16896
    ds_read_b128 v[168:171], v4 offset:384
    ds_read_b128 v[172:175], v4 offset:448
    v_mfma_f32_16x16x32_bf16 v[144:147], v[216:219], v[56:59], v[144:147]
    v_exp_f32 v185, v185
    v_mfma_f32_16x16x32_bf16 v[152:155], v[216:219], v[60:63], v[152:155]
    v_exp_f32 v186, v186
    v_mfma_f32_16x16x32_bf16 v[12:15], v[200:203], v[200:203], v[12:15]
    ds_read_b128 v[212:215], v252 offset:25344
    ds_read_b32 v255, v8 offset:16
    v_mfma_f32_16x16x32_bf16 v[148:151], v[220:223], v[56:59], v[148:151]
    v_exp_f32 v187, v187
    v_mfma_f32_16x16x32_bf16 v[156:159], v[220:223], v[60:63], v[156:159]
    v_exp_f32 v188, v188
    v_mfma_f32_16x16x32_bf16 v[12:15], v[204:207], v[204:207], v[12:15]
    ds_read_b128 v[216:219], v252 offset:16960
    s_waitcnt lgkmcnt(6)
    v_mfma_f32_16x16x32_bf16 v[144:147], v[224:227], v[64:67], v[144:147]
    v_exp_f32 v189, v189
    v_mfma_f32_16x16x32_bf16 v[152:155], v[224:227], v[68:71], v[152:155]
    ds_read_b128 v[220:223], v252 offset:25408
    v_cvt_pk_bf16_f32 v91, v182, v183
    v_mfma_f32_16x16x32_bf16 v[148:151], v[228:231], v[64:67], v[148:151]
    v_exp_f32 v190, v190
    v_cvt_pk_bf16_f32 v92, v184, v185
    v_mfma_f32_16x16x32_bf16 v[156:159], v[228:231], v[68:71], v[156:159]
    ds_read_b128 v[224:227], v252 offset:17024
    v_cvt_pk_bf16_f32 v93, v186, v187
    v_cvt_pk_bf16_f32 v94, v188, v189
    v_mfma_f32_16x16x32_bf16 v[144:147], v[232:235], v[72:75], v[144:147]
    v_exp_f32 v191, v191
    v_cndmask_b32 v12, v12, v13, s[4:5]
    v_mfma_f32_16x16x32_bf16 v[152:155], v[232:235], v[76:79], v[152:155]
    ds_read_b128 v[228:231], v252 offset:25472
    v_cvt_pk_bf16_f32 v95, v190, v191
    v_cndmask_b32 v12, v12, v14, s[6:7]
    v_mfma_f32_16x16x32_bf16 v[148:151], v[236:239], v[72:75], v[148:151]
    v_cndmask_b32 v12, v12, v15, s[8:9]
    v_mov_b32 v254, 4
    v_mfma_f32_16x16x32_bf16 v[156:159], v[236:239], v[76:79], v[156:159]
    ds_read_b128 v[232:235], v252 offset:17088
    s_waitcnt lgkmcnt(3)
    v_mfma_f32_16x16x32_bf16 v[176:179], v[208:211], v[16:19], v[168:171]
    v_add_f32_dpp v12, v12, v12 quad_perm:[1,0,3,2] row_mask:0xf bank_mask:0xf
    v_fma_f32 v12, v12, s37, -4.0
    v_cmp_gt_u32 vcc, 6, v255
    v_mfma_f32_16x16x32_bf16 v[184:187], v[208:211], v[20:23], v[168:171]
    ds_read_b128 v[236:239], v252 offset:25536
    ds_write_b32 v6, v12 offset:512
    ds_write_b32 v0, v254 offset:0
    s_cbranch_vccnz L_spin_13
L_go_14:
    v_mfma_f32_16x16x32_bf16 v[180:183], v[212:215], v[16:19], v[172:175]
    v_exp_f32 v144, v144
    v_mfma_f32_16x16x32_bf16 v[188:191], v[212:215], v[20:23], v[172:175]
    ds_read_b128 v[208:211], v252 offset:17152
    ds_read_b128 v[192:195], v248 offset:50688
    ds_read_b128 v[196:199], v249 offset:50688
    v_mfma_f32_16x16x32_bf16 v[176:179], v[216:219], v[24:27], v[176:179]
    v_exp_f32 v145, v145
    v_mfma_f32_16x16x32_bf16 v[184:187], v[216:219], v[28:31], v[184:187]
    ds_read_b128 v[212:215], v252 offset:25600
    ds_read_b128 v[200:203], v250 offset:50688
    ds_read_b128 v[204:207], v251 offset:50688
    v_mfma_f32_16x16x32_bf16 v[180:183], v[220:223], v[24:27], v[180:183]
    ds_read_b32 v255, v8 offset:0
    v_cvt_pk_bf16_f32 v96, v144, v145
    v_mfma_f32_16x16x32_bf16 v[188:191], v[220:223], v[28:31], v[188:191]
    ds_read_b128 v[216:219], v252 offset:17216
    s_waitcnt lgkmcnt(10)
    v_mfma_f32_16x16x32_bf16 v[176:179], v[224:227], v[32:35], v[176:179]
    v_exp_f32 v146, v146
    v_mfma_f32_16x16x32_bf16 v[184:187], v[224:227], v[36:39], v[184:187]
    ds_read_b128 v[220:223], v252 offset:25664
    v_add_u32 v248, 0x10800, v248
    v_add_u32 v249, 0x10800, v249
    v_mfma_f32_16x16x32_bf16 v[180:183], v[228:231], v[32:35], v[180:183]
    v_exp_f32 v147, v147
    v_mfma_f32_16x16x32_bf16 v[188:191], v[228:231], v[36:39], v[188:191]
    ds_read_b128 v[224:227], v252 offset:17280
    v_cvt_pk_bf16_f32 v97, v146, v147
    v_add_u32 v250, 0x10800, v250
    v_mfma_f32_16x16x32_bf16 v[176:179], v[232:235], v[40:43], v[176:179]
    v_exp_f32 v148, v148
    v_mfma_f32_16x16x32_bf16 v[184:187], v[232:235], v[44:47], v[184:187]
    ds_read_b128 v[228:231], v252 offset:25728
    v_add_u32 v251, 0x10800, v251
    v_mfma_f32_16x16x32_bf16 v[180:183], v[236:239], v[40:43], v[180:183]
    v_exp_f32 v149, v149
    v_mfma_f32_16x16x32_bf16 v[188:191], v[236:239], v[44:47], v[188:191]
    ds_read_b128 v[232:235], v252 offset:17344
    s_waitcnt lgkmcnt(3)
    v_mfma_f32_16x16x32_bf16 v[176:179], v[208:211], v[48:51], v[176:179]
    v_cmp_gt_u32 vcc, 4, v255
    v_cvt_pk_bf16_f32 v98, v148, v149
    v_mfma_f32_16x16x32_bf16 v[184:187], v[208:211], v[52:55], v[184:187]
    s_cbranch_vccnz L_spin_15
L_go_16:
    v_mfma_f32_16x16x32_bf16 v[12:15], v[192:195], v[192:195], 0
    ds_read_b128 v[236:239], v252 offset:25792
    v_exp_f32 v150, v150
    v_mfma_f32_16x16x32_bf16 v[180:183], v[212:215], v[48:51], v[180:183]
    v_exp_f32 v151, v151
    v_mfma_f32_16x16x32_bf16 v[188:191], v[212:215], v[52:55], v[188:191]
    v_exp_f32 v152, v152
    v_mfma_f32_16x16x32_bf16 v[12:15], v[196:199], v[196:199], v[12:15]
    ds_read_b128 v[208:211], v252 offset:33792
    ds_read_b128 v[160:163], v4 offset:512
    ds_read_b128 v[164:167], v4 offset:576
    v_mfma_f32_16x16x32_bf16 v[176:179], v[216:219], v[56:59], v[176:179]
    v_exp_f32 v153, v153
    v_mfma_f32_16x16x32_bf16 v[184:187], v[216:219], v[60:63], v[184:187]
    v_exp_f32 v154, v154
    v_mfma_f32_16x16x32_bf16 v[12:15], v[200:203], v[200:203], v[12:15]
    ds_read_b128 v[212:215], v252 offset:42240
    ds_read_b32 v255, v8 offset:16
    v_cvt_pk_bf16_f32 v99, v150, v151
    v_mfma_f32_16x16x32_bf16 v[180:183], v[220:223], v[56:59], v[180:183]
    v_exp_f32 v155, v155
    v_mfma_f32_16x16x32_bf16 v[188:191], v[220:223], v[60:63], v[188:191]
    v_exp_f32 v156, v156
    v_mfma_f32_16x16x32_bf16 v[12:15], v[204:207], v[204:207], v[12:15]
    ds_read_b128 v[216:219], v252 offset:33856
    s_waitcnt lgkmcnt(6)
    v_mfma_f32_16x16x32_bf16 v[176:179], v[224:227], v[64:67], v[176:179]
    v_exp_f32 v157, v157
    v_mfma_f32_16x16x32_bf16 v[184:187], v[224:227], v[68:71], v[184:187]
    ds_read_b128 v[220:223], v252 offset:42304
    v_cvt_pk_bf16_f32 v100, v152, v153
    v_cvt_pk_bf16_f32 v101, v154, v155
    v_mfma_f32_16x16x32_bf16 v[180:183], v[228:231], v[64:67], v[180:183]
    v_exp_f32 v158, v158
    v_mfma_f32_16x16x32_bf16 v[188:191], v[228:231], v[68:71], v[188:191]
    ds_read_b128 v[224:227], v252 offset:33920
    v_cvt_pk_bf16_f32 v102, v156, v157
    v_cndmask_b32 v12, v12, v13, s[4:5]
    v_mfma_f32_16x16x32_bf16 v[176:179], v[232:235], v[72:75], v[176:179]
    v_exp_f32 v159, v159
    v_mfma_f32_16x16x32_bf16 v[184:187], v[232:235], v[76:79], v[184:187]
    ds_read_b128 v[228:231], v252 offset:42368
    v_cvt_pk_bf16_f32 v103, v158, v159
    v_cndmask_b32 v12, v12, v14, s[6:7]
    v_mfma_f32_16x16x32_bf16 v[180:183], v[236:239], v[72:75], v[180:183]
    v_cndmask_b32 v12, v12, v15, s[8:9]
    v_mov_b32 v254, 5
    v_mfma_f32_16x16x32_bf16 v[188:191], v[236:239], v[76:79], v[188:191]
    ds_read_b128 v[232:235], v252 offset:33984
    s_waitcnt lgkmcnt(3)
    v_mfma_f32_16x16x32_bf16 v[144:147], v[208:211], v[16:19], v[160:163]
    v_add_f32_dpp v12, v12, v12 quad_perm:[1,0,3,2] row_mask:0xf bank_mask:0xf
    v_fma_f32 v12, v12, s37, -4.0
    v_cmp_gt_u32 vcc, 7, v255
    v_mfma_f32_16x16x32_bf16 v[152:155], v[208:211], v[20:23], v[160:163]
    ds_read_b128 v[236:239], v252 offset:42432
    ds_write_b32 v6, v12 offset:640
    ds_write_b32 v0, v254 offset:0
    s_cbranch_vccnz L_spin_17
L_go_18:
    v_mfma_f32_16x16x32_bf16 v[148:151], v[212:215], v[16:19], v[164:167]
    v_exp_f32 v176, v176
    v_mfma_f32_16x16x32_bf16 v[156:159], v[212:215], v[20:23], v[164:167]
    ds_read_b128 v[208:211], v252 offset:34048
    ds_read_b128 v[192:195], v248 offset:50688
    ds_read_b128 v[196:199], v249 offset:50688
    v_mfma_f32_16x16x32_bf16 v[144:147], v[216:219], v[24:27], v[144:147]
    v_exp_f32 v177, v177
    v_mfma_f32_16x16x32_bf16 v[152:155], v[216:219], v[28:31], v[152:155]
    ds_read_b128 v[212:215], v252 offset:42496
    ds_read_b128 v[200:203], v250 offset:50688
    ds_read_b128 v[204:207], v251 offset:50688
    v_mfma_f32_16x16x32_bf16 v[148:151], v[220:223], v[24:27], v[148:151]
    ds_read_b32 v255, v8 offset:0
    v_cvt_pk_bf16_f32 v104, v176, v177
    v_mfma_f32_16x16x32_bf16 v[156:159], v[220:223], v[28:31], v[156:159]
    ds_read_b128 v[216:219], v252 offset:34112
    s_waitcnt lgkmcnt(10)
    v_mfma_f32_16x16x32_bf16 v[144:147], v[224:227], v[32:35], v[144:147]
    v_exp_f32 v178, v178
    v_mfma_f32_16x16x32_bf16 v[152:155], v[224:227], v[36:39], v[152:155]
    ds_read_b128 v[220:223], v252 offset:42560
    v_mfma_f32_16x16x32_bf16 v[148:151], v[228:231], v[32:35], v[148:151]
    v_exp_f32 v179, v179
    v_mfma_f32_16x16x32_bf16 v[156:159], v[228:231], v[36:39], v[156:159]
    ds_read_b128 v[224:227], v252 offset:34176
    v_cvt_pk_bf16_f32 v105, v178, v179
    v_mfma_f32_16x16x32_bf16 v[144:147], v[232:235], v[40:43], v[144:147]
    v_exp_f32 v180, v180
    v_mfma_f32_16x16x32_bf16 v[152:155], v[232:235], v[44:47], v[152:155]
    ds_read_b128 v[228:231], v252 offset:42624
    v_exp_f32 v181, v181
    v_mfma_f32_16x16x32_bf16 v[148:151], v[236:239], v[40:43], v[148:151]
    v_exp_f32 v182, v182
    v_mfma_f32_16x16x32_bf16 v[156:159], v[236:239], v[44:47], v[156:159]
    ds_read_b128 v[232:235], v252 offset:34240
    s_waitcnt lgkmcnt(3)
    v_mfma_f32_16x16x32_bf16 v[144:147], v[208:211], v[48:51], v[144:147]
    v_cmp_gt_u32 vcc, 5, v255
    v_cvt_pk_bf16_f32 v106, v180, v181
    v_mfma_f32_16x16x32_bf16 v[152:155], v[208:211], v[52:55], v[152:155]
    s_cbranch_vccnz L_spin_19
L_go_20:
    v_mfma_f32_16x16x32_bf16 v[12:15], v[192:195], v[192:195], 0
    ds_read_b128 v[236:239], v252 offset:42688
    v_exp_f32 v183, v183
    v_mfma_f32_16x16x32_bf16 v[148:151], v[212:215], v[48:51], v[148:151]
    v_exp_f32 v184, v184
    v_mfma_f32_16x16x32_bf16 v[156:159], v[212:215], v[52:55], v[156:159]
    v_exp_f32 v185, v185
    v_mfma_f32_16x16x32_bf16 v[12:15], v[196:199], v[196:199], v[12:15]
    ds_read_b128 v[208:211], v252 offset:0
    ds_read_b128 v[168:171], v4 offset:640
    v_mfma_f32_16x16x32_bf16 v[144:147], v[216:219], v[56:59], v[144:147]
    v_exp_f32 v186, v186
    v_mfma_f32_16x16x32_bf16 v[152:155], v[216:219], v[60:63], v[152:155]
    v_exp_f32 v187, v187
    v_mfma_f32_16x16x32_bf16 v[12:15], v[200:203], v[200:203], v[12:15]
    ds_read_b128 v[212:215], v252 offset:8448
    ds_read_b128 v[172:175], v4 offset:704
    v_mfma_f32_16x16x32_bf16 v[148:151], v[220:223], v[56:59], v[148:151]
    ds_read_b32 v255, v8 offset:16
    v_cvt_pk_bf16_f32 v107, v182, v183
    v_mfma_f32_16x16x32_bf16 v[156:159], v[220:223], v[60:63], v[156:159]
    v_exp_f32 v188, v188
    v_mfma_f32_16x16x32_bf16 v[12:15], v[204:207], v[204:207], v[12:15]
    ds_read_b128 v[216:219], v252 offset:64
    s_waitcnt lgkmcnt(6)
    v_mfma_f32_16x16x32_bf16 v[144:147], v[224:227], v[64:67], v[144:147]
    v_exp_f32 v189, v189
    v_mfma_f32_16x16x32_bf16 v[152:155], v[224:227], v[68:71], v[152:155]
    ds_read_b128 v[220:223], v252 offset:8512
    v_cvt_pk_bf16_f32 v108, v184, v185
    v_mfma_f32_16x16x32_bf16 v[148:151], v[228:231], v[64:67], v[148:151]
    v_exp_f32 v190, v190
    v_mfma_f32_16x16x32_bf16 v[156:159], v[228:231], v[68:71], v[156:159]
    ds_read_b128 v[224:227], v252 offset:128
    v_cvt_pk_bf16_f32 v109, v186, v187
    v_cvt_pk_bf16_f32 v110, v188, v189
    v_mfma_f32_16x16x32_bf16 v[144:147], v[232:235], v[72:75], v[144:147]
    v_exp_f32 v191, v191
    v_cndmask_b32 v12, v12, v13, s[4:5]
    v_mfma_f32_16x16x32_bf16 v[152:155], v[232:235], v[76:79], v[152:155]
    ds_read_b128 v[228:231], v252 offset:8576
    v_cvt_pk_bf16_f32 v111, v190, v191
    v_cndmask_b32 v12, v12, v14, s[6:7]
    v_mfma_f32_16x16x32_bf16 v[148:151], v[236:239], v[72:75], v[148:151]
    v_cndmask_b32 v12, v12, v15, s[8:9]
    v_mov_b32 v254, 6
    v_mfma_f32_16x16x32_bf16 v[156:159], v[236:239], v[76:79], v[156:159]
    ds_read_b128 v[232:235], v252 offset:192
    s_waitcnt lgkmcnt(3)
    v_mfma_f32_16x16x32_bf16 v[176:179], v[208:211], v[16:19], v[168:171]
    v_add_f32_dpp v12, v12, v12 quad_perm:[1,0,3,2] row_mask:0xf bank_mask:0xf
    v_fma_f32 v12, v12, s37, -4.0
    v_cmp_gt_u32 vcc, 9, v255
    v_mfma_f32_16x16x32_bf16 v[184:187], v[208:211], v[20:23], v[168:171]
    ds_read_b128 v[236:239], v252 offset:8640
    ds_write_b32 v6, v12 offset:768
    ds_write_b32 v0, v254 offset:0
    s_cbranch_vccnz L_spin_21
L_go_22:
    v_mfma_f32_16x16x32_bf16 v[180:183], v[212:215], v[16:19], v[172:175]
    v_exp_f32 v144, v144
    v_mfma_f32_16x16x32_bf16 v[188:191], v[212:215], v[20:23], v[172:175]
    ds_read_b128 v[208:211], v252 offset:256
    ds_read_b128 v[192:195], v248 offset:33792
    ds_read_b128 v[196:199], v249 offset:33792
    v_mfma_f32_16x16x32_bf16 v[176:179], v[216:219], v[24:27], v[176:179]
    v_exp_f32 v145, v145
    v_mfma_f32_16x16x32_bf16 v[184:187], v[216:219], v[28:31], v[184:187]
    ds_read_b128 v[212:215], v252 offset:8704
    ds_read_b128 v[200:203], v250 offset:33792
    ds_read_b128 v[204:207], v251 offset:33792
    v_mfma_f32_16x16x32_bf16 v[180:183], v[220:223], v[24:27], v[180:183]
    ds_read_b32 v255, v8 offset:0
    v_add_u32 v253, 0x18c00, v2
    v_mfma_f32_16x16x32_bf16 v[188:191], v[220:223], v[28:31], v[188:191]
    ds_read_b128 v[216:219], v252 offset:320
    s_waitcnt lgkmcnt(10)
    v_mfma_f32_16x16x32_bf16 v[176:179], v[224:227], v[32:35], v[176:179]
    v_exp_f32 v146, v146
    v_mfma_f32_16x16x32_bf16 v[184:187], v[224:227], v[36:39], v[184:187]
    ds_read_b128 v[220:223], v252 offset:8768
    v_cvt_pk_bf16_f32 v112, v144, v145
    v_mfma_f32_16x16x32_bf16 v[180:183], v[228:231], v[32:35], v[180:183]
    v_exp_f32 v147, v147
    v_mfma_f32_16x16x32_bf16 v[188:191], v[228:231], v[36:39], v[188:191]
    ds_read_b128 v[224:227], v252 offset:384
    v_cvt_pk_bf16_f32 v113, v146, v147
    v_mfma_f32_16x16x32_bf16 v[176:179], v[232:235], v[40:43], v[176:179]
    v_exp_f32 v148, v148
    v_mfma_f32_16x16x32_bf16 v[184:187], v[232:235], v[44:47], v[184:187]
    ds_read_b128 v[228:231], v252 offset:8832
    v_exp_f32 v149, v149
    v_mfma_f32_16x16x32_bf16 v[180:183], v[236:239], v[40:43], v[180:183]
    v_exp_f32 v150, v150
    v_mfma_f32_16x16x32_bf16 v[188:191], v[236:239], v[44:47], v[188:191]
    ds_read_b128 v[232:235], v252 offset:448
    s_waitcnt lgkmcnt(3)
    v_mfma_f32_16x16x32_bf16 v[176:179], v[208:211], v[48:51], v[176:179]
    v_cmp_gt_u32 vcc, 6, v255
    v_cvt_pk_bf16_f32 v114, v148, v149
    v_mfma_f32_16x16x32_bf16 v[184:187], v[208:211], v[52:55], v[184:187]
    s_cbranch_vccnz L_spin_23
L_go_24:
    v_mfma_f32_16x16x32_bf16 v[12:15], v[192:195], v[192:195], 0
    ds_read_b128 v[236:239], v252 offset:8896
    v_mfma_f32_16x16x32_bf16 v[180:183], v[212:215], v[48:51], v[180:183]
    v_exp_f32 v151, v151
    v_mfma_f32_16x16x32_bf16 v[188:191], v[212:215], v[52:55], v[188:191]
    v_exp_f32 v152, v152
    v_mfma_f32_16x16x32_bf16 v[12:15], v[196:199], v[196:199], v[12:15]
    ds_read_b128 v[208:211], v253 offset:16896
    ds_read_b128 v[160:163], v4 offset:768
    ds_read_b128 v[164:167], v4 offset:832
    v_mfma_f32_16x16x32_bf16 v[176:179], v[216:219], v[56:59], v[176:179]
    v_exp_f32 v153, v153
    v_mfma_f32_16x16x32_bf16 v[184:187], v[216:219], v[60:63], v[184:187]
    v_exp_f32 v154, v154
    v_mfma_f32_16x16x32_bf16 v[12:15], v[200:203], v[200:203], v[12:15]
    ds_read_b128 v[212:215], v253 offset:25344
    v_cvt_pk_bf16_f32 v115, v150, v151
    v_cvt_pk_bf16_f32 v116, v152, v153
    v_mfma_f32_16x16x32_bf16 v[180:183], v[220:223], v[56:59], v[180:183]
    v_exp_f32 v155, v155
    v_mfma_f32_16x16x32_bf16 v[188:191], v[220:223], v[60:63], v[188:191]
    v_exp_f32 v156, v156
    v_mfma_f32_16x16x32_bf16 v[12:15], v[204:207], v[204:207], v[12:15]
    ds_read_b128 v[216:219], v253 offset:16960
    s_waitcnt lgkmcnt(5)
    v_mfma_f32_16x16x32_bf16 v[176:179], v[224:227], v[64:67], v[176:179]
    v_exp_f32 v157, v157
    v_mfma_f32_16x16x32_bf16 v[184:187], v[224:227], v[68:71], v[184:187]
    ds_read_b128 v[220:223], v253 offset:25408
    v_cvt_pk_bf16_f32 v117, v154, v155
    v_cvt_pk_bf16_f32 v118, v156, v157
    v_mfma_f32_16x16x32_bf16 v[180:183], v[228:231], v[64:67], v[180:183]
    v_exp_f32 v158, v158
    v_mfma_f32_16x16x32_bf16 v[188:191], v[228:231], v[68:71], v[188:191]
    ds_read_b128 v[224:227], v253 offset:17024
    v_cndmask_b32 v12, v12, v13, s[4:5]
    v_cndmask_b32 v12, v12, v14, s[6:7]
    v_mfma_f32_16x16x32_bf16 v[176:179], v[232:235], v[72:75], v[176:179]
    v_exp_f32 v159, v159
    v_mfma_f32_16x16x32_bf16 v[184:187], v[232:235], v[76:79], v[184:187]
    ds_read_b128 v[228:231], v253 offset:25472
    v_cvt_pk_bf16_f32 v119, v158, v159
    v_cndmask_b32 v12, v12, v15, s[8:9]
    v_mfma_f32_16x16x32_bf16 v[180:183], v[236:239], v[72:75], v[180:183]
    v_mov_b32 v254, 7
    v_mfma_f32_16x16x32_bf16 v[188:191], v[236:239], v[76:79], v[188:191]
    ds_read_b128 v[232:235], v253 offset:17088
    s_waitcnt lgkmcnt(3)
    v_mfma_f32_16x16x32_bf16 v[144:147], v[208:211], v[16:19], v[160:163]
    v_add_f32_dpp v12, v12, v12 quad_perm:[1,0,3,2] row_mask:0xf bank_mask:0xf
    v_fma_f32 v12, v12, s37, -4.0
    v_mfma_f32_16x16x32_bf16 v[152:155], v[208:211], v[20:23], v[160:163]
    ds_read_b128 v[236:239], v253 offset:25536
    ds_write_b32 v6, v12 offset:896
    ds_write_b32 v0, v254 offset:0
    v_mfma_f32_16x16x32_bf16 v[148:151], v[212:215], v[16:19], v[164:167]
    v_exp_f32 v176, v176
    v_mfma_f32_16x16x32_bf16 v[156:159], v[212:215], v[20:23], v[164:167]
    ds_read_b128 v[208:211], v253 offset:17152
    v_exp_f32 v177, v177
    v_mfma_f32_16x16x32_bf16 v[144:147], v[216:219], v[24:27], v[144:147]
    v_exp_f32 v178, v178
    v_mfma_f32_16x16x32_bf16 v[152:155], v[216:219], v[28:31], v[152:155]
    ds_read_b128 v[212:215], v253 offset:25600
    ds_read_b32 v255, v8 offset:0
    v_cvt_pk_bf16_f32 v120, v176, v177
    v_mfma_f32_16x16x32_bf16 v[148:151], v[220:223], v[24:27], v[148:151]
    v_exp_f32 v179, v179
    v_mfma_f32_16x16x32_bf16 v[156:159], v[220:223], v[28:31], v[156:159]
    ds_read_b128 v[216:219], v253 offset:17216
    s_waitcnt lgkmcnt(6)
    v_mfma_f32_16x16x32_bf16 v[144:147], v[224:227], v[32:35], v[144:147]
    v_exp_f32 v180, v180
    v_mfma_f32_16x16x32_bf16 v[152:155], v[224:227], v[36:39], v[152:155]
    ds_read_b128 v[220:223], v253 offset:25664
    v_cvt_pk_bf16_f32 v121, v178, v179
    v_mfma_f32_16x16x32_bf16 v[148:151], v[228:231], v[32:35], v[148:151]
    v_exp_f32 v181, v181
    v_mfma_f32_16x16x32_bf16 v[156:159], v[228:231], v[36:39], v[156:159]
    ds_read_b128 v[224:227], v253 offset:17280
    v_cvt_pk_bf16_f32 v122, v180, v181
    v_mfma_f32_16x16x32_bf16 v[144:147], v[232:235], v[40:43], v[144:147]
    v_exp_f32 v182, v182
    v_mfma_f32_16x16x32_bf16 v[152:155], v[232:235], v[44:47], v[152:155]
    ds_read_b128 v[228:231], v253 offset:25728
    v_exp_f32 v183, v183
    v_mfma_f32_16x16x32_bf16 v[148:151], v[236:239], v[40:43], v[148:151]
    v_exp_f32 v184, v184
    v_mfma_f32_16x16x32_bf16 v[156:159], v[236:239], v[44:47], v[156:159]
    ds_read_b128 v[232:235], v253 offset:17344
    s_waitcnt lgkmcnt(3)
    v_mfma_f32_16x16x32_bf16 v[144:147], v[208:211], v[48:51], v[144:147]
    v_cmp_gt_u32 vcc, 7, v255
    v_cvt_pk_bf16_f32 v123, v182, v183
    v_mfma_f32_16x16x32_bf16 v[152:155], v[208:211], v[52:55], v[152:155]
    ds_read_b128 v[236:239], v253 offset:25792
    s_cbranch_vccnz L_spin_25
L_go_26:
    v_mfma_f32_16x16x32_bf16 v[148:151], v[212:215], v[48:51], v[148:151]
    v_exp_f32 v185, v185
    v_mfma_f32_16x16x32_bf16 v[156:159], v[212:215], v[52:55], v[156:159]
    ds_read_b128 v[208:211], v253 offset:0
    ds_read_b128 v[168:171], v4 offset:896
    ds_read_b128 v[172:175], v4 offset:960
    v_mfma_f32_16x16x32_bf16 v[144:147], v[216:219], v[56:59], v[144:147]
    v_exp_f32 v186, v186
    v_mfma_f32_16x16x32_bf16 v[152:155], v[216:219], v[60:63], v[152:155]
    ds_read_b128 v[212:215], v253 offset:8448
    v_mov_b32 v254, 8
    v_cvt_pk_bf16_f32 v124, v184, v185
    v_mfma_f32_16x16x32_bf16 v[148:151], v[220:223], v[56:59], v[148:151]
    v_exp_f32 v187, v187
    v_mfma_f32_16x16x32_bf16 v[156:159], v[220:223], v[60:63], v[156:159]
    ds_read_b128 v[216:219], v253 offset:64
    s_waitcnt lgkmcnt(5)
    v_mfma_f32_16x16x32_bf16 v[144:147], v[224:227], v[64:67], v[144:147]
    ds_write_b32 v0, v254 offset:0
    v_cvt_pk_bf16_f32 v125, v186, v187
    v_mfma_f32_16x16x32_bf16 v[152:155], v[224:227], v[68:71], v[152:155]
    ds_read_b128 v[220:223], v253 offset:8512
    v_exp_f32 v188, v188
    v_mfma_f32_16x16x32_bf16 v[148:151], v[228:231], v[64:67], v[148:151]
    v_exp_f32 v189, v189
    v_mfma_f32_16x16x32_bf16 v[156:159], v[228:231], v[68:71], v[156:159]
    ds_read_b128 v[224:227], v253 offset:128
    v_cvt_pk_bf16_f32 v126, v188, v189
    v_mfma_f32_16x16x32_bf16 v[144:147], v[232:235], v[72:75], v[144:147]
    v_exp_f32 v190, v190
    v_mfma_f32_16x16x32_bf16 v[152:155], v[232:235], v[76:79], v[152:155]
    ds_read_b128 v[228:231], v253 offset:8576
    v_exp_f32 v191, v191
    v_mfma_f32_16x16x32_bf16 v[148:151], v[236:239], v[72:75], v[148:151]
    v_cvt_pk_bf16_f32 v127, v190, v191
    v_mfma_f32_16x16x32_bf16 v[156:159], v[236:239], v[76:79], v[156:159]
    ds_read_b128 v[232:235], v253 offset:192
    s_waitcnt lgkmcnt(3)
    v_mfma_f32_16x16x32_bf16 v[176:179], v[208:211], v[16:19], v[168:171]
    v_mfma_f32_16x16x32_bf16 v[184:187], v[208:211], v[20:23], v[168:171]
    ds_read_b128 v[236:239], v253 offset:8640
    v_mfma_f32_16x16x32_bf16 v[180:183], v[212:215], v[16:19], v[172:175]
    v_exp_f32 v144, v144
    v_mfma_f32_16x16x32_bf16 v[188:191], v[212:215], v[20:23], v[172:175]
    ds_read_b128 v[208:211], v253 offset:256
    v_exp_f32 v145, v145
    v_mfma_f32_16x16x32_bf16 v[176:179], v[216:219], v[24:27], v[176:179]
    v_exp_f32 v146, v146
    v_mfma_f32_16x16x32_bf16 v[184:187], v[216:219], v[28:31], v[184:187]
    ds_read_b128 v[212:215], v253 offset:8704
    ds_read_b32 v255, v8 offset:16
    v_cvt_pk_bf16_f32 v128, v144, v145
    v_mfma_f32_16x16x32_bf16 v[180:183], v[220:223], v[24:27], v[180:183]
    v_exp_f32 v147, v147
    v_mfma_f32_16x16x32_bf16 v[188:191], v[220:223], v[28:31], v[188:191]
    ds_read_b128 v[216:219], v253 offset:320
    v_cvt_pk_bf16_f32 v129, v146, v147
    s_waitcnt lgkmcnt(4)
    v_mfma_f32_16x16x32_bf16 v[176:179], v[224:227], v[32:35], v[176:179]
    v_exp_f32 v148, v148
    v_mfma_f32_16x16x32_bf16 v[184:187], v[224:227], v[36:39], v[184:187]
    ds_read_b128 v[220:223], v253 offset:8768
    v_exp_f32 v149, v149
    v_mfma_f32_16x16x32_bf16 v[180:183], v[228:231], v[32:35], v[180:183]
    v_exp_f32 v150, v150
    v_cvt_pk_bf16_f32 v130, v148, v149
    v_mfma_f32_16x16x32_bf16 v[188:191], v[228:231], v[36:39], v[188:191]
    ds_read_b128 v[224:227], v253 offset:384
    v_exp_f32 v151, v151
    v_mfma_f32_16x16x32_bf16 v[176:179], v[232:235], v[40:43], v[176:179]
    v_exp_f32 v152, v152
    v_mfma_f32_16x16x32_bf16 v[184:187], v[232:235], v[44:47], v[184:187]
    ds_read_b128 v[228:231], v253 offset:8832
    v_add_u32 v248, 0x0, v3
    v_cvt_pk_bf16_f32 v131, v150, v151
    v_mfma_f32_16x16x32_bf16 v[180:183], v[236:239], v[40:43], v[180:183]
    v_exp_f32 v153, v153
    v_mov_b32 v24, 0x3f803f80
    v_mfma_f32_16x16x32_bf16 v[188:191], v[236:239], v[44:47], v[188:191]
    ds_read_b128 v[232:235], v253 offset:448
    v_cvt_pk_bf16_f32 v132, v152, v153
    s_waitcnt lgkmcnt(3)
    v_mfma_f32_16x16x32_bf16 v[176:179], v[208:211], v[48:51], v[176:179]
    v_cmp_gt_u32 vcc, 12, v255
    v_exp_f32 v154, v154
    v_mfma_f32_16x16x32_bf16 v[184:187], v[208:211], v[52:55], v[184:187]
    ds_read_b128 v[236:239], v253 offset:8896
    s_cbranch_vccnz L_spin_27
L_go_28:
    v_mov_b32 v25, 0x3f803f80
    v_mfma_f32_16x16x32_bf16 v[180:183], v[212:215], v[48:51], v[180:183]
    ds_read_b64_tr_b16 v[208:209], v248 offset:0
    ds_read_b64_tr_b16 v[210:211], v248 offset:2048
    v_xor_b32 v249, 32, v248
    v_mfma_f32_16x16x32_bf16 v[188:191], v[212:215], v[52:55], v[188:191]
    v_exp_f32 v155, v155
    v_xor_b32 v250, 64, v248
    v_mfma_f32_16x16x32_bf16 v[176:179], v[216:219], v[56:59], v[176:179]
    ds_read_b64_tr_b16 v[212:213], v249 offset:0
    ds_read_b64_tr_b16 v[214:215], v249 offset:2048
    v_xor_b32 v251, 96, v248
    v_mfma_f32_16x16x32_bf16 v[184:187], v[216:219], v[60:63], v[184:187]
    v_exp_f32 v156, v156
    v_mfma_f32_16x16x32_bf16 v[180:183], v[220:223], v[56:59], v[180:183]
    ds_read_b64_tr_b16 v[216:217], v250 offset:0
    ds_read_b64_tr_b16 v[218:219], v250 offset:2048
    v_mov_b32 v254, 9
    v_mfma_f32_16x16x32_bf16 v[188:191], v[220:223], v[60:63], v[188:191]
    ds_write_b32 v0, v254 offset:0
    v_cvt_pk_bf16_f32 v133, v154, v155
    s_waitcnt lgkmcnt(7)
    v_mfma_f32_16x16x32_bf16 v[176:179], v[224:227], v[64:67], v[176:179]
    ds_read_b64_tr_b16 v[220:221], v251 offset:0
    v_mov_b32 v26, 0x3f803f80
    v_mov_b32 v27, 0x3f803f80
    v_mfma_f32_16x16x32_bf16 v[184:187], v[224:227], v[68:71], v[184:187]
    ds_read_b64_tr_b16 v[222:223], v251 offset:2048
    v_exp_f32 v157, v157
    v_mfma_f32_16x16x32_bf16 v[180:183], v[228:231], v[64:67], v[180:183]
    ds_read_b64_tr_b16 v[224:225], v248 offset:4096
    ds_read_b64_tr_b16 v[226:227], v248 offset:6144
    v_mfma_f32_16x16x32_bf16 v[188:191], v[228:231], v[68:71], v[188:191]
    v_exp_f32 v158, v158
    v_cvt_pk_bf16_f32 v134, v156, v157
    v_mfma_f32_16x16x32_bf16 v[176:179], v[232:235], v[72:75], v[176:179]
    ds_read_b64_tr_b16 v[228:229], v249 offset:4096
    ds_read_b64_tr_b16 v[230:231], v249 offset:6144
    v_mfma_f32_16x16x32_bf16 v[184:187], v[232:235], v[76:79], v[184:187]
    v_exp_f32 v159, v159
    v_mfma_f32_16x16x32_bf16 v[180:183], v[236:239], v[72:75], v[180:183]
    ds_read_b64_tr_b16 v[232:233], v250 offset:4096
    ds_read_b64_tr_b16 v[234:235], v250 offset:6144
    v_mfma_f32_16x16x32_bf16 v[188:191], v[236:239], v[76:79], v[188:191]
    v_cvt_pk_bf16_f32 v135, v158, v159
    s_waitcnt lgkmcnt(6)
    v_mfma_f32_16x16x32_bf16 v[144:147], v[80:83], v[208:211], 0
    ds_read_b64_tr_b16 v[236:237], v251 offset:4096
    v_mfma_f32_16x16x32_bf16 v[148:151], v[84:87], v[208:211], 0
    ds_read_b64_tr_b16 v[238:239], v251 offset:6144
    v_mfma_f32_16x16x32_bf16 v[152:155], v[80:83], v[212:215], 0
    ds_read_b64_tr_b16 v[208:209], v248 offset:8192
    ds_read_b64_tr_b16 v[210:211], v248 offset:10240
    v_mfma_f32_16x16x32_bf16 v[156:159], v[84:87], v[212:215], 0
    v_exp_f32 v176, v176
    v_mfma_f32_16x16x32_bf16 v[160:163], v[80:83], v[216:219], 0
    ds_read_b64_tr_b16 v[212:213], v249 offset:8192
    ds_read_b64_tr_b16 v[214:215], v249 offset:10240
    v_mfma_f32_16x16x32_bf16 v[164:167], v[84:87], v[216:219], 0
    v_exp_f32 v177, v177
    v_mfma_f32_16x16x32_bf16 v[16:19], v[80:83], v[24:27], 0
    v_exp_f32 v178, v178
    v_mfma_f32_16x16x32_bf16 v[20:23], v[84:87], v[24:27], 0
    v_exp_f32 v179, v179
    v_mfma_f32_16x16x32_bf16 v[168:171], v[80:83], v[220:223], 0
    ds_read_b64_tr_b16 v[216:217], v250 offset:8192
    ds_read_b64_tr_b16 v[218:219], v250 offset:10240
    v_mfma_f32_16x16x32_bf16 v[172:175], v[84:87], v[220:223], 0
    v_cvt_pk_bf16_f32 v136, v176, v177
    s_waitcnt lgkmcnt(6)
    v_mfma_f32_16x16x32_bf16 v[144:147], v[88:91], v[224:227], v[144:147]
    ds_read_b64_tr_b16 v[220:221], v251 offset:8192
    v_cvt_pk_bf16_f32 v137, v178, v179
    v_mfma_f32_16x16x32_bf16 v[148:151], v[92:95], v[224:227], v[148:151]
    ds_read_b64_tr_b16 v[222:223], v251 offset:10240
    v_mfma_f32_16x16x32_bf16 v[152:155], v[88:91], v[228:231], v[152:155]
    ds_read_b64_tr_b16 v[224:225], v248 offset:12288
    ds_read_b64_tr_b16 v[226:227], v248 offset:14336
    v_mfma_f32_16x16x32_bf16 v[156:159], v[92:95], v[228:231], v[156:159]
    v_exp_f32 v180, v180
    v_mfma_f32_16x16x32_bf16 v[16:19], v[88:91], v[24:27], v[16:19]
    v_exp_f32 v181, v181
    v_mfma_f32_16x16x32_bf16 v[20:23], v[92:95], v[24:27], v[20:23]
    v_exp_f32 v182, v182
    v_mfma_f32_16x16x32_bf16 v[160:163], v[88:91], v[232:235], v[160:163]
    ds_read_b64_tr_b16 v[228:229], v249 offset:12288
    ds_read_b64_tr_b16 v[230:231], v249 offset:14336
    v_mfma_f32_16x16x32_bf16 v[164:167], v[92:95], v[232:235], v[164:167]
    v_exp_f32 v183, v183
    v_mfma_f32_16x16x32_bf16 v[168:171], v[88:91], v[236:239], v[168:171]
    ds_read_b64_tr_b16 v[232:233], v250 offset:12288
    ds_read_b64_tr_b16 v[234:235], v250 offset:14336
    v_mfma_f32_16x16x32_bf16 v[172:175], v[92:95], v[236:239], v[172:175]
    ds_read_b32 v255, v0 offset:80
    s_waitcnt lgkmcnt(7)
    v_mfma_f32_16x16x32_bf16 v[144:147], v[96:99], v[208:211], v[144:147]
    ds_read_b64_tr_b16 v[236:237], v251 offset:12288
    v_add_u32 v248, 0x18c00, v3
    v_mfma_f32_16x16x32_bf16 v[148:151], v[100:103], v[208:211], v[148:151]
    ds_read_b64_tr_b16 v[238:239], v251 offset:14336
    v_cvt_pk_bf16_f32 v138, v180, v181
    v_mfma_f32_16x16x32_bf16 v[16:19], v[96:99], v[24:27], v[16:19]
    v_exp_f32 v184, v184
    v_mfma_f32_16x16x32_bf16 v[20:23], v[100:103], v[24:27], v[20:23]
    v_exp_f32 v185, v185
    v_mfma_f32_16x16x32_bf16 v[152:155], v[96:99], v[212:215], v[152:155]
    ds_read_b64_tr_b16 v[208:209], v248 offset:33792
    ds_read_b64_tr_b16 v[210:211], v248 offset:35840
    v_mfma_f32_16x16x32_bf16 v[156:159], v[100:103], v[212:215], v[156:159]
    v_xor_b32 v249, 32, v248
    v_xor_b32 v250, 64, v248
    v_mfma_f32_16x16x32_bf16 v[160:163], v[96:99], v[216:219], v[160:163]
    ds_read_b64_tr_b16 v[212:213], v249 offset:33792
    ds_read_b64_tr_b16 v[214:215], v249 offset:35840
    v_mfma_f32_16x16x32_bf16 v[164:167], v[100:103], v[216:219], v[164:167]
    v_exp_f32 v186, v186
    v_mfma_f32_16x16x32_bf16 v[168:171], v[96:99], v[220:223], v[168:171]
    ds_read_b64_tr_b16 v[216:217], v250 offset:33792
    ds_read_b64_tr_b16 v[218:219], v250 offset:35840
    v_mfma_f32_16x16x32_bf16 v[172:175], v[100:103], v[220:223], v[172:175]
    v_xor_b32 v251, 96, v248
    v_mov_b32 v254, 10
    v_mfma_f32_16x16x32_bf16 v[16:19], v[104:107], v[24:27], v[16:19]
    v_exp_f32 v187, v187
    v_mfma_f32_16x16x32_bf16 v[20:23], v[108:111], v[24:27], v[20:23]
    ds_write_b32 v0, v254 offset:0
    s_waitcnt lgkmcnt(7)
    v_mfma_f32_16x16x32_bf16 v[144:147], v[104:107], v[224:227], v[144:147]
    ds_read_b64_tr_b16 v[220:221], v251 offset:33792
    v_cmp_gt_u32 vcc, 1, v255
    v_mfma_f32_16x16x32_bf16 v[148:151], v[108:111], v[224:227], v[148:151]
    ds_read_b64_tr_b16 v[222:223], v251 offset:35840
    s_cbranch_vccnz L_spin_29
L_go_30:
    v_mfma_f32_16x16x32_bf16 v[152:155], v[104:107], v[228:231], v[152:155]
    ds_read_b64_tr_b16 v[224:225], v248 offset:37888
    ds_read_b64_tr_b16 v[226:227], v248 offset:39936
    v_mfma_f32_16x16x32_bf16 v[156:159], v[108:111], v[228:231], v[156:159]
    v_exp_f32 v188, v188
    v_mfma_f32_16x16x32_bf16 v[160:163], v[104:107], v[232:235], v[160:163]
    ds_read_b64_tr_b16 v[228:229], v249 offset:37888
    ds_read_b64_tr_b16 v[230:231], v249 offset:39936
    v_mfma_f32_16x16x32_bf16 v[164:167], v[108:111], v[232:235], v[164:167]
    v_readfirstlane_b32 s45, v255
    v_cvt_pk_bf16_f32 v139, v182, v183
    v_mfma_f32_16x16x32_bf16 v[16:19], v[112:115], v[24:27], v[16:19]
    v_exp_f32 v189, v189
    v_mfma_f32_16x16x32_bf16 v[20:23], v[116:119], v[24:27], v[20:23]
    v_exp_f32 v190, v190
    v_mfma_f32_16x16x32_bf16 v[168:171], v[104:107], v[236:239], v[168:171]
    ds_read_b64_tr_b16 v[232:233], v250 offset:37888
    ds_read_b64_tr_b16 v[234:235], v250 offset:39936
    v_mfma_f32_16x16x32_bf16 v[172:175], v[108:111], v[236:239], v[172:175]
    v_cvt_pk_bf16_f32 v140, v184, v185
    s_waitcnt lgkmcnt(6)
    v_mfma_f32_16x16x32_bf16 v[144:147], v[112:115], v[208:211], v[144:147]
    ds_read_b64_tr_b16 v[236:237], v251 offset:37888
    v_cvt_pk_bf16_f32 v141, v186, v187
    v_mfma_f32_16x16x32_bf16 v[148:151], v[116:119], v[208:211], v[148:151]
    ds_read_b64_tr_b16 v[238:239], v251 offset:39936
    v_cvt_pk_bf16_f32 v142, v188, v189
    v_mfma_f32_16x16x32_bf16 v[152:155], v[112:115], v[212:215], v[152:155]
    ds_read_b64_tr_b16 v[208:209], v248 offset:41984
    ds_read_b64_tr_b16 v[210:211], v248 offset:44032
    v_mfma_f32_16x16x32_bf16 v[156:159], v[116:119], v[212:215], v[156:159]
    v_exp_f32 v191, v191
    v_mfma_f32_16x16x32_bf16 v[16:19], v[120:123], v[24:27], v[16:19]
    v_cvt_pk_bf16_f32 v143, v190, v191
    v_mfma_f32_16x16x32_bf16 v[20:23], v[124:127], v[24:27], v[20:23]
    v_mfma_f32_16x16x32_bf16 v[160:163], v[112:115], v[216:219], v[160:163]
    ds_read_b64_tr_b16 v[212:213], v249 offset:41984
    ds_read_b64_tr_b16 v[214:215], v249 offset:44032
    v_mfma_f32_16x16x32_bf16 v[164:167], v[116:119], v[216:219], v[164:167]
    ds_read_b32 v255, v8 offset:16
    v_mfma_f32_16x16x32_bf16 v[168:171], v[112:115], v[220:223], v[168:171]
    ds_read_b64_tr_b16 v[216:217], v250 offset:41984
    ds_read_b64_tr_b16 v[218:219], v250 offset:44032
    v_mfma_f32_16x16x32_bf16 v[172:175], v[116:119], v[220:223], v[172:175]
    s_cmp_eq_u32 s45, 2
    s_cbranch_scc0 L_slow1
    s_waitcnt lgkmcnt(7)
    v_mfma_f32_16x16x32_bf16 v[144:147], v[120:123], v[224:227], v[144:147]
    ds_read_b64_tr_b16 v[220:221], v251 offset:41984
    v_mfma_f32_16x16x32_bf16 v[148:151], v[124:127], v[224:227], v[148:151]
    ds_read_b64_tr_b16 v[222:223], v251 offset:44032
    v_mfma_f32_16x16x32_bf16 v[16:19], v[128:131], v[24:27], v[16:19]
    v_mfma_f32_16x16x32_bf16 v[20:23], v[132:135], v[24:27], v[20:23]
    v_mfma_f32_16x16x32_bf16 v[152:155], v[120:123], v[228:231], v[152:155]
    ds_read_b64_tr_b16 v[224:225], v248 offset:46080
    ds_read_b64_tr_b16 v[226:227], v248 offset:48128
    v_mfma_f32_16x16x32_bf16 v[156:159], v[124:127], v[228:231], v[156:159]
    v_mfma_f32_16x16x32_bf16 v[160:163], v[120:123], v[232:235], v[160:163]
    ds_read_b64_tr_b16 v[228:229], v249 offset:46080
    ds_read_b64_tr_b16 v[230:231], v249 offset:48128
    v_mfma_f32_16x16x32_bf16 v[164:167], v[124:127], v[232:235], v[164:167]
    v_add_u32 v248, 0x0, v3
    v_mfma_f32_16x16x32_bf16 v[168:171], v[120:123], v[236:239], v[168:171]
    ds_read_b64_tr_b16 v[232:233], v250 offset:46080
    ds_read_b64_tr_b16 v[234:235], v250 offset:48128
    v_mfma_f32_16x16x32_bf16 v[172:175], v[124:127], v[236:239], v[172:175]
    s_waitcnt lgkmcnt(6)
    v_mfma_f32_16x16x32_bf16 v[144:147], v[128:131], v[208:211], v[144:147]
    ds_read_b64_tr_b16 v[236:237], v251 offset:46080
    v_cmp_gt_u32 vcc, 14, v255
    v_mfma_f32_16x16x32_bf16 v[148:151], v[132:135], v[208:211], v[148:151]
    ds_read_b64_tr_b16 v[238:239], v251 offset:48128
    s_cbranch_vccnz L_spin_31
L_go_32:
    v_mfma_f32_16x16x32_bf16 v[152:155], v[128:131], v[212:215], v[152:155]
    ds_read_b64_tr_b16 v[208:209], v248 offset:33792
    ds_read_b64_tr_b16 v[210:211], v248 offset:35840
    v_mfma_f32_16x16x32_bf16 v[156:159], v[132:135], v[212:215], v[156:159]
    v_xor_b32 v249, 32, v248
    v_xor_b32 v250, 64, v248
    v_mfma_f32_16x16x32_bf16 v[160:163], v[128:131], v[216:219], v[160:163]
    ds_read_b64_tr_b16 v[212:213], v249 offset:33792
    v_xor_b32 v251, 96, v248
    v_mfma_f32_16x16x32_bf16 v[164:167], v[132:135], v[216:219], v[164:167]
    ds_read_b64_tr_b16 v[214:215], v249 offset:35840
    v_mov_b32 v254, 11
    v_mfma_f32_16x16x32_bf16 v[168:171], v[128:131], v[220:223], v[168:171]
    ds_read_b64_tr_b16 v[216:217], v250 offset:33792
    ds_write_b32 v0, v254 offset:0
    v_mfma_f32_16x16x32_bf16 v[172:175], v[132:135], v[220:223], v[172:175]
    ds_read_b64_tr_b16 v[218:219], v250 offset:35840
    s_waitcnt lgkmcnt(7)
    v_mfma_f32_16x16x32_bf16 v[144:147], v[136:139], v[224:227], v[144:147]
    ds_read_b64_tr_b16 v[220:221], v251 offset:33792
    v_mfma_f32_16x16x32_bf16 v[148:151], v[140:143], v[224:227], v[148:151]
    ds_read_b64_tr_b16 v[222:223], v251 offset:35840
    v_mfma_f32_16x16x32_bf16 v[152:155], v[136:139], v[228:231], v[152:155]
    ds_read_b64_tr_b16 v[224:225], v248 offset:37888
    v_mfma_f32_16x16x32_bf16 v[156:159], v[140:143], v[228:231], v[156:159]
    ds_read_b64_tr_b16 v[226:227], v248 offset:39936
    v_mfma_f32_16x16x32_bf16 v[16:19], v[136:139], v[24:27], v[16:19]
    v_mfma_f32_16x16x32_bf16 v[20:23], v[140:143], v[24:27], v[20:23]
    v_mfma_f32_16x16x32_bf16 v[160:163], v[136:139], v[232:235], v[160:163]
    ds_read_b64_tr_b16 v[228:229], v249 offset:37888
    v_mfma_f32_16x16x32_bf16 v[164:167], v[140:143], v[232:235], v[164:167]
    ds_read_b64_tr_b16 v[230:231], v249 offset:39936
    v_mfma_f32_16x16x32_bf16 v[168:171], v[136:139], v[236:239], v[168:171]
    ds_read_b64_tr_b16 v[232:233], v250 offset:37888
    v_mfma_f32_16x16x32_bf16 v[172:175], v[140:143], v[236:239], v[172:175]
    ds_read_b64_tr_b16 v[234:235], v250 offset:39936
    s_waitcnt lgkmcnt(6)
    v_mfma_f32_16x16x32_bf16 v[176:179], v[80:83], v[208:211], 0
    ds_read_b64_tr_b16 v[236:237], v251 offset:37888
    buffer_store_dwordx4 v[16:19], v4, s[60:63], s14 offen offset:0 sc1
    v_mfma_f32_16x16x32_bf16 v[180:183], v[84:87], v[208:211], 0
    ds_read_b64_tr_b16 v[238:239], v251 offset:39936
    buffer_store_dwordx4 v[20:23], v4, s[60:63], s14 offen offset:64 sc1
    v_mfma_f32_16x16x32_bf16 v[184:187], v[80:83], v[212:215], 0
    ds_read_b64_tr_b16 v[208:209], v248 offset:41984
    v_mfma_f32_16x16x32_bf16 v[188:191], v[84:87], v[212:215], 0
    ds_read_b64_tr_b16 v[210:211], v248 offset:44032
    v_mfma_f32_16x16x32_bf16 v[192:195], v[80:83], v[216:219], 0
    ds_read_b64_tr_b16 v[212:213], v249 offset:41984
    v_cvt_pk_bf16_f32 v144, v144, v145
    v_cvt_pk_bf16_f32 v145, v146, v147
    v_mfma_f32_16x16x32_bf16 v[196:199], v[84:87], v[216:219], 0
    ds_read_b64_tr_b16 v[214:215], v249 offset:44032
    v_cvt_pk_bf16_f32 v146, v148, v149
    v_mfma_f32_16x16x32_bf16 v[200:203], v[80:83], v[220:223], 0
    ds_read_b64_tr_b16 v[216:217], v250 offset:41984
    v_cvt_pk_bf16_f32 v147, v150, v151
    v_mfma_f32_16x16x32_bf16 v[204:207], v[84:87], v[220:223], 0
    ds_read_b64_tr_b16 v[218:219], v250 offset:44032
    s_waitcnt lgkmcnt(6)
    v_mfma_f32_16x16x32_bf16 v[176:179], v[88:91], v[224:227], v[176:179]
    ds_read_b64_tr_b16 v[220:221], v251 offset:41984
    buffer_store_dwordx4 v[144:147], v9, s[52:55], s10 offen offset:256
    v_cvt_pk_bf16_f32 v148, v152, v153
    v_mfma_f32_16x16x32_bf16 v[180:183], v[92:95], v[224:227], v[180:183]
    ds_read_b64_tr_b16 v[222:223], v251 offset:44032
    v_cvt_pk_bf16_f32 v149, v154, v155
    v_mfma_f32_16x16x32_bf16 v[184:187], v[88:91], v[228:231], v[184:187]
    ds_read_b64_tr_b16 v[224:225], v248 offset:46080
    v_cvt_pk_bf16_f32 v150, v156, v157
    v_mfma_f32_16x16x32_bf16 v[188:191], v[92:95], v[228:231], v[188:191]
    ds_read_b64_tr_b16 v[226:227], v248 offset:48128
    v_cvt_pk_bf16_f32 v151, v158, v159
    v_mfma_f32_16x16x32_bf16 v[192:195], v[88:91], v[232:235], v[192:195]
    ds_read_b64_tr_b16 v[228:229], v249 offset:46080
    v_add_u32 v248, 0xc600, v3
    v_mfma_f32_16x16x32_bf16 v[196:199], v[92:95], v[232:235], v[196:199]
    ds_read_b64_tr_b16 v[230:231], v249 offset:48128
    buffer_store_dwordx4 v[148:151], v9, s[52:55], s11 offen offset:256
    v_mfma_f32_16x16x32_bf16 v[200:203], v[88:91], v[236:239], v[200:203]
    ds_read_b64_tr_b16 v[232:233], v250 offset:46080
    v_cvt_pk_bf16_f32 v152, v160, v161
    v_mfma_f32_16x16x32_bf16 v[204:207], v[92:95], v[236:239], v[204:207]
    ds_read_b64_tr_b16 v[234:235], v250 offset:48128
    s_waitcnt lgkmcnt(6)
    v_mfma_f32_16x16x32_bf16 v[176:179], v[96:99], v[208:211], v[176:179]
    ds_read_b64_tr_b16 v[236:237], v251 offset:46080
    v_cvt_pk_bf16_f32 v153, v162, v163
    v_mfma_f32_16x16x32_bf16 v[180:183], v[100:103], v[208:211], v[180:183]
    ds_read_b64_tr_b16 v[238:239], v251 offset:48128
    v_cvt_pk_bf16_f32 v154, v164, v165
    v_mfma_f32_16x16x32_bf16 v[184:187], v[96:99], v[212:215], v[184:187]
    ds_read_b64_tr_b16 v[208:209], v248 offset:16896
    v_xor_b32 v249, 32, v248
    v_mfma_f32_16x16x32_bf16 v[188:191], v[100:103], v[212:215], v[188:191]
    ds_read_b64_tr_b16 v[210:211], v248 offset:18944
    v_xor_b32 v250, 64, v248
    v_xor_b32 v251, 96, v248
    v_mfma_f32_16x16x32_bf16 v[192:195], v[96:99], v[216:219], v[192:195]
    ds_read_b64_tr_b16 v[212:213], v249 offset:16896
    v_mov_b32 v254, 12
    v_mfma_f32_16x16x32_bf16 v[196:199], v[100:103], v[216:219], v[196:199]
    ds_read_b64_tr_b16 v[214:215], v249 offset:18944
    ds_write_b32 v0, v254 offset:0
    v_mfma_f32_16x16x32_bf16 v[200:203], v[96:99], v[220:223], v[200:203]
    ds_read_b64_tr_b16 v[216:217], v250 offset:16896
    v_cvt_pk_bf16_f32 v155, v166, v167
    v_mfma_f32_16x16x32_bf16 v[204:207], v[100:103], v[220:223], v[204:207]
    ds_read_b64_tr_b16 v[218:219], v250 offset:18944
    s_waitcnt lgkmcnt(7)
    v_mfma_f32_16x16x32_bf16 v[176:179], v[104:107], v[224:227], v[176:179]
    ds_read_b64_tr_b16 v[220:221], v251 offset:16896
    buffer_store_dwordx4 v[152:155], v9, s[52:55], s12 offen offset:256
    v_mfma_f32_16x16x32_bf16 v[180:183], v[108:111], v[224:227], v[180:183]
    ds_read_b64_tr_b16 v[222:223], v251 offset:18944
    v_cvt_pk_bf16_f32 v156, v168, v169
    v_mfma_f32_16x16x32_bf16 v[184:187], v[104:107], v[228:231], v[184:187]
    ds_read_b64_tr_b16 v[224:225], v248 offset:20992
    v_cvt_pk_bf16_f32 v157, v170, v171
    v_mfma_f32_16x16x32_bf16 v[188:191], v[108:111], v[228:231], v[188:191]
    ds_read_b64_tr_b16 v[226:227], v248 offset:23040
    v_cvt_pk_bf16_f32 v158, v172, v173
    v_mfma_f32_16x16x32_bf16 v[192:195], v[104:107], v[232:235], v[192:195]
    ds_read_b64_tr_b16 v[228:229], v249 offset:20992
    v_cvt_pk_bf16_f32 v159, v174, v175
    v_mfma_f32_16x16x32_bf16 v[196:199], v[108:111], v[232:235], v[196:199]
    ds_read_b64_tr_b16 v[230:231], v249 offset:23040
    buffer_store_dwordx4 v[156:159], v9, s[52:55], s13 offen offset:256
    v_mfma_f32_16x16x32_bf16 v[200:203], v[104:107], v[236:239], v[200:203]
    ds_read_b64_tr_b16 v[232:233], v250 offset:20992
    v_mfma_f32_16x16x32_bf16 v[204:207], v[108:111], v[236:239], v[204:207]
    ds_read_b64_tr_b16 v[234:235], v250 offset:23040
    s_waitcnt lgkmcnt(6)
    v_mfma_f32_16x16x32_bf16 v[176:179], v[112:115], v[208:211], v[176:179]
    ds_read_b64_tr_b16 v[236:237], v251 offset:20992
    v_mfma_f32_16x16x32_bf16 v[180:183], v[116:119], v[208:211], v[180:183]
    ds_read_b64_tr_b16 v[238:239], v251 offset:23040
    v_mfma_f32_16x16x32_bf16 v[184:187], v[112:115], v[212:215], v[184:187]
    ds_read_b64_tr_b16 v[208:209], v248 offset:25088
    v_mfma_f32_16x16x32_bf16 v[188:191], v[116:119], v[212:215], v[188:191]
    ds_read_b64_tr_b16 v[210:211], v248 offset:27136
    v_mfma_f32_16x16x32_bf16 v[192:195], v[112:115], v[216:219], v[192:195]
    ds_read_b64_tr_b16 v[212:213], v249 offset:25088
    ds_read_b32 v255, v8 offset:16
    v_mfma_f32_16x16x32_bf16 v[196:199], v[116:119], v[216:219], v[196:199]
    ds_read_b64_tr_b16 v[214:215], v249 offset:27136
    v_mfma_f32_16x16x32_bf16 v[200:203], v[112:115], v[220:223], v[200:203]
    ds_read_b64_tr_b16 v[216:217], v250 offset:25088
    v_mfma_f32_16x16x32_bf16 v[204:207], v[116:119], v[220:223], v[204:207]
    ds_read_b64_tr_b16 v[218:219], v250 offset:27136
    s_waitcnt lgkmcnt(7)
    v_mfma_f32_16x16x32_bf16 v[176:179], v[120:123], v[224:227], v[176:179]
    ds_read_b64_tr_b16 v[220:221], v251 offset:25088
    v_mfma_f32_16x16x32_bf16 v[180:183], v[124:127], v[224:227], v[180:183]
    ds_read_b64_tr_b16 v[222:223], v251 offset:27136
    v_mfma_f32_16x16x32_bf16 v[184:187], v[120:123], v[228:231], v[184:187]
    ds_read_b64_tr_b16 v[224:225], v248 offset:29184
    v_mfma_f32_16x16x32_bf16 v[188:191], v[124:127], v[228:231], v[188:191]
    ds_read_b64_tr_b16 v[226:227], v248 offset:31232
    v_mfma_f32_16x16x32_bf16 v[192:195], v[120:123], v[232:235], v[192:195]
    ds_read_b64_tr_b16 v[228:229], v249 offset:29184
    v_add_u32 v248, 0x0, v3
    v_mfma_f32_16x16x32_bf16 v[196:199], v[124:127], v[232:235], v[196:199]
    ds_read_b64_tr_b16 v[230:231], v249 offset:31232
    v_mfma_f32_16x16x32_bf16 v[200:203], v[120:123], v[236:239], v[200:203]
    ds_read_b64_tr_b16 v[232:233], v250 offset:29184
    v_mfma_f32_16x16x32_bf16 v[204:207], v[124:127], v[236:239], v[204:207]
    ds_read_b64_tr_b16 v[234:235], v250 offset:31232
    s_waitcnt lgkmcnt(6)
    v_mfma_f32_16x16x32_bf16 v[176:179], v[128:131], v[208:211], v[176:179]
    ds_read_b64_tr_b16 v[236:237], v251 offset:29184
    v_cmp_gt_u32 vcc, 16, v255
    v_mfma_f32_16x16x32_bf16 v[180:183], v[132:135], v[208:211], v[180:183]
    ds_read_b64_tr_b16 v[238:239], v251 offset:31232
    s_cbranch_vccnz L_spin_33
L_go_34:
    v_mfma_f32_16x16x32_bf16 v[184:187], v[128:131], v[212:215], v[184:187]
    ds_read_b64_tr_b16 v[208:209], v248 offset:16896
    v_xor_b32 v249, 32, v248
    v_mfma_f32_16x16x32_bf16 v[188:191], v[132:135], v[212:215], v[188:191]
    ds_read_b64_tr_b16 v[210:211], v248 offset:18944
    v_mov_b32 v6, 1
    v_mfma_f32_16x16x32_bf16 v[192:195], v[128:131], v[216:219], v[192:195]
    ds_read_b64_tr_b16 v[212:213], v249 offset:16896
    v_xor_b32 v250, 64, v248
    v_mfma_f32_16x16x32_bf16 v[196:199], v[132:135], v[216:219], v[196:199]
    ds_read_b64_tr_b16 v[214:215], v249 offset:18944
    s_waitcnt vmcnt(0)
    s_mov_b32 exec_hi, 0
    buffer_store_dword v6, v11, s[60:63], s39 offen
    s_mov_b64 exec, -1
    v_mfma_f32_16x16x32_bf16 v[200:203], v[128:131], v[220:223], v[200:203]
    ds_read_b64_tr_b16 v[216:217], v250 offset:16896
    v_xor_b32 v251, 96, v248
    v_mfma_f32_16x16x32_bf16 v[204:207], v[132:135], v[220:223], v[204:207]
    ds_read_b64_tr_b16 v[218:219], v250 offset:18944
    s_waitcnt lgkmcnt(6)
    v_mfma_f32_16x16x32_bf16 v[176:179], v[136:139], v[224:227], v[176:179]
    ds_read_b64_tr_b16 v[220:221], v251 offset:16896
    v_mov_b32 v254, 13
    v_mfma_f32_16x16x32_bf16 v[180:183], v[140:143], v[224:227], v[180:183]
    ds_read_b64_tr_b16 v[222:223], v251 offset:18944
    ds_write_b32 v0, v254 offset:0
    v_mfma_f32_16x16x32_bf16 v[184:187], v[136:139], v[228:231], v[184:187]
    ds_read_b64_tr_b16 v[224:225], v248 offset:20992
    v_mfma_f32_16x16x32_bf16 v[188:191], v[140:143], v[228:231], v[188:191]
    ds_read_b64_tr_b16 v[226:227], v248 offset:23040
    v_mfma_f32_16x16x32_bf16 v[192:195], v[136:139], v[232:235], v[192:195]
    ds_read_b64_tr_b16 v[228:229], v249 offset:20992
    v_mfma_f32_16x16x32_bf16 v[196:199], v[140:143], v[232:235], v[196:199]
    ds_read_b64_tr_b16 v[230:231], v249 offset:23040
    v_mfma_f32_16x16x32_bf16 v[200:203], v[136:139], v[236:239], v[200:203]
    ds_read_b64_tr_b16 v[232:233], v250 offset:20992
    v_mfma_f32_16x16x32_bf16 v[204:207], v[140:143], v[236:239], v[204:207]
    ds_read_b64_tr_b16 v[234:235], v250 offset:23040
    s_waitcnt lgkmcnt(7)
    v_mfma_f32_16x16x32_bf16 v[144:147], v[80:83], v[208:211], 0
    ds_read_b64_tr_b16 v[236:237], v251 offset:20992
    v_mfma_f32_16x16x32_bf16 v[148:151], v[84:87], v[208:211], 0
    ds_read_b64_tr_b16 v[238:239], v251 offset:23040
    v_mfma_f32_16x16x32_bf16 v[152:155], v[80:83], v[212:215], 0
    ds_read_b64_tr_b16 v[208:209], v248 offset:25088
    v_mfma_f32_16x16x32_bf16 v[156:159], v[84:87], v[212:215], 0
    ds_read_b64_tr_b16 v[210:211], v248 offset:27136
    v_mfma_f32_16x16x32_bf16 v[160:163], v[80:83], v[216:219], 0
    ds_read_b64_tr_b16 v[212:213], v249 offset:25088
    v_cvt_pk_bf16_f32 v176, v176, v177
    v_mfma_f32_16x16x32_bf16 v[164:167], v[84:87], v[216:219], 0
    ds_read_b64_tr_b16 v[214:215], v249 offset:27136
    v_cvt_pk_bf16_f32 v177, v178, v179
    v_mfma_f32_16x16x32_bf16 v[168:171], v[80:83], v[220:223], 0
    ds_read_b64_tr_b16 v[216:217], v250 offset:25088
    v_cvt_pk_bf16_f32 v178, v180, v181
    v_mfma_f32_16x16x32_bf16 v[172:175], v[84:87], v[220:223], 0
    ds_read_b64_tr_b16 v[218:219], v250 offset:27136
    s_waitcnt lgkmcnt(6)
    v_mfma_f32_16x16x32_bf16 v[144:147], v[88:91], v[224:227], v[144:147]
    ds_read_b64_tr_b16 v[220:221], v251 offset:25088
    v_cvt_pk_bf16_f32 v179, v182, v183
    v_mfma_f32_16x16x32_bf16 v[148:151], v[92:95], v[224:227], v[148:151]
    ds_read_b64_tr_b16 v[222:223], v251 offset:27136
    buffer_store_dwordx4 v[176:179], v9, s[52:55], s10 offen offset:384
    v_mfma_f32_16x16x32_bf16 v[152:155], v[88:91], v[228:231], v[152:155]
    ds_read_b64_tr_b16 v[224:225], v248 offset:29184
    v_cvt_pk_bf16_f32 v180, v184, v185
    v_mfma_f32_16x16x32_bf16 v[156:159], v[92:95], v[228:231], v[156:159]
    ds_read_b64_tr_b16 v[226:227], v248 offset:31232
    v_cvt_pk_bf16_f32 v181, v186, v187
    v_cvt_pk_bf16_f32 v182, v188, v189
    v_mfma_f32_16x16x32_bf16 v[160:163], v[88:91], v[232:235], v[160:163]
    ds_read_b64_tr_b16 v[228:229], v249 offset:29184
    v_add_u32 v248, 0xc600, v3
    v_mfma_f32_16x16x32_bf16 v[164:167], v[92:95], v[232:235], v[164:167]
    ds_read_b64_tr_b16 v[230:231], v249 offset:31232
    v_cvt_pk_bf16_f32 v183, v190, v191
    v_mfma_f32_16x16x32_bf16 v[168:171], v[88:91], v[236:239], v[168:171]
    ds_read_b64_tr_b16 v[232:233], v250 offset:29184
    buffer_store_dwordx4 v[180:183], v9, s[52:55], s11 offen offset:384
    v_mfma_f32_16x16x32_bf16 v[172:175], v[92:95], v[236:239], v[172:175]
    ds_read_b64_tr_b16 v[234:235], v250 offset:31232
    s_waitcnt lgkmcnt(6)
    v_mfma_f32_16x16x32_bf16 v[144:147], v[96:99], v[208:211], v[144:147]
    ds_read_b64_tr_b16 v[236:237], v251 offset:29184
    v_cvt_pk_bf16_f32 v184, v192, v193
    v_mfma_f32_16x16x32_bf16 v[148:151], v[100:103], v[208:211], v[148:151]
    ds_read_b64_tr_b16 v[238:239], v251 offset:31232
    v_cvt_pk_bf16_f32 v185, v194, v195
    v_mfma_f32_16x16x32_bf16 v[152:155], v[96:99], v[212:215], v[152:155]
    ds_read_b64_tr_b16 v[208:209], v248 offset:33792
    v_xor_b32 v249, 32, v248
    v_xor_b32 v250, 64, v248
    v_mfma_f32_16x16x32_bf16 v[156:159], v[100:103], v[212:215], v[156:159]
    ds_read_b64_tr_b16 v[210:211], v248 offset:35840
    v_xor_b32 v251, 96, v248
    v_mfma_f32_16x16x32_bf16 v[160:163], v[96:99], v[216:219], v[160:163]
    ds_read_b64_tr_b16 v[212:213], v249 offset:33792
    v_mov_b32 v254, 14
    v_mfma_f32_16x16x32_bf16 v[164:167], v[100:103], v[216:219], v[164:167]
    ds_read_b64_tr_b16 v[214:215], v249 offset:35840
    ds_write_b32 v0, v254 offset:0
    v_mfma_f32_16x16x32_bf16 v[168:171], v[96:99], v[220:223], v[168:171]
    ds_read_b64_tr_b16 v[216:217], v250 offset:33792
    v_cvt_pk_bf16_f32 v186, v196, v197
    v_cvt_pk_bf16_f32 v187, v198, v199
    v_mfma_f32_16x16x32_bf16 v[172:175], v[100:103], v[220:223], v[172:175]
    ds_read_b64_tr_b16 v[218:219], v250 offset:35840
    s_waitcnt lgkmcnt(7)
    v_mfma_f32_16x16x32_bf16 v[144:147], v[104:107], v[224:227], v[144:147]
    ds_read_b64_tr_b16 v[220:221], v251 offset:33792
    buffer_store_dwordx4 v[184:187], v9, s[52:55], s12 offen offset:384
    v_mfma_f32_16x16x32_bf16 v[148:151], v[108:111], v[224:227], v[148:151]
    ds_read_b64_tr_b16 v[222:223], v251 offset:35840
    v_cvt_pk_bf16_f32 v188, v200, v201
    v_mfma_f32_16x16x32_bf16 v[152:155], v[104:107], v[228:231], v[152:155]
    ds_read_b64_tr_b16 v[224:225], v248 offset:37888
    v_cvt_pk_bf16_f32 v189, v202, v203
    v_mfma_f32_16x16x32_bf16 v[156:159], v[108:111], v[228:231], v[156:159]
    ds_read_b64_tr_b16 v[226:227], v248 offset:39936
    v_cvt_pk_bf16_f32 v190, v204, v205
    v_mfma_f32_16x16x32_bf16 v[160:163], v[104:107], v[232:235], v[160:163]
    ds_read_b64_tr_b16 v[228:229], v249 offset:37888
    v_cvt_pk_bf16_f32 v191, v206, v207
    v_mfma_f32_16x16x32_bf16 v[164:167], v[108:111], v[232:235], v[164:167]
    ds_read_b64_tr_b16 v[230:231], v249 offset:39936
    buffer_store_dwordx4 v[188:191], v9, s[52:55], s13 offen offset:384
    v_mfma_f32_16x16x32_bf16 v[168:171], v[104:107], v[236:239], v[168:171]
    ds_read_b64_tr_b16 v[232:233], v250 offset:37888
    v_mfma_f32_16x16x32_bf16 v[172:175], v[108:111], v[236:239], v[172:175]
    ds_read_b64_tr_b16 v[234:235], v250 offset:39936
    s_waitcnt lgkmcnt(6)
    v_mfma_f32_16x16x32_bf16 v[144:147], v[112:115], v[208:211], v[144:147]
    ds_read_b64_tr_b16 v[236:237], v251 offset:37888
    v_mfma_f32_16x16x32_bf16 v[148:151], v[116:119], v[208:211], v[148:151]
    ds_read_b64_tr_b16 v[238:239], v251 offset:39936
    v_mfma_f32_16x16x32_bf16 v[152:155], v[112:115], v[212:215], v[152:155]
    ds_read_b64_tr_b16 v[208:209], v248 offset:41984
    v_mfma_f32_16x16x32_bf16 v[156:159], v[116:119], v[212:215], v[156:159]
    ds_read_b64_tr_b16 v[210:211], v248 offset:44032
    v_mfma_f32_16x16x32_bf16 v[160:163], v[112:115], v[216:219], v[160:163]
    ds_read_b64_tr_b16 v[212:213], v249 offset:41984
    ds_read_b32 v255, v8 offset:16
    v_mfma_f32_16x16x32_bf16 v[164:167], v[116:119], v[216:219], v[164:167]
    ds_read_b64_tr_b16 v[214:215], v249 offset:44032
    v_mfma_f32_16x16x32_bf16 v[168:171], v[112:115], v[220:223], v[168:171]
    ds_read_b64_tr_b16 v[216:217], v250 offset:41984
    v_mfma_f32_16x16x32_bf16 v[172:175], v[116:119], v[220:223], v[172:175]
    ds_read_b64_tr_b16 v[218:219], v250 offset:44032
    s_waitcnt lgkmcnt(7)
    v_mfma_f32_16x16x32_bf16 v[144:147], v[120:123], v[224:227], v[144:147]
    ds_read_b64_tr_b16 v[220:221], v251 offset:41984
    v_mfma_f32_16x16x32_bf16 v[148:151], v[124:127], v[224:227], v[148:151]
    ds_read_b64_tr_b16 v[222:223], v251 offset:44032
    v_mfma_f32_16x16x32_bf16 v[152:155], v[120:123], v[228:231], v[152:155]
    ds_read_b64_tr_b16 v[224:225], v248 offset:46080
    v_mfma_f32_16x16x32_bf16 v[156:159], v[124:127], v[228:231], v[156:159]
    ds_read_b64_tr_b16 v[226:227], v248 offset:48128
    v_mfma_f32_16x16x32_bf16 v[160:163], v[120:123], v[232:235], v[160:163]
    ds_read_b64_tr_b16 v[228:229], v249 offset:46080
    v_mfma_f32_16x16x32_bf16 v[164:167], v[124:127], v[232:235], v[164:167]
    ds_read_b64_tr_b16 v[230:231], v249 offset:48128
    v_mfma_f32_16x16x32_bf16 v[168:171], v[120:123], v[236:239], v[168:171]
    ds_read_b64_tr_b16 v[232:233], v250 offset:46080
    v_mfma_f32_16x16x32_bf16 v[172:175], v[124:127], v[236:239], v[172:175]
    ds_read_b64_tr_b16 v[234:235], v250 offset:48128
    s_waitcnt lgkmcnt(6)
    v_mfma_f32_16x16x32_bf16 v[144:147], v[128:131], v[208:211], v[144:147]
    ds_read_b64_tr_b16 v[236:237], v251 offset:46080
    v_cmp_gt_u32 vcc, 18, v255
    v_mfma_f32_16x16x32_bf16 v[148:151], v[132:135], v[208:211], v[148:151]
    ds_read_b64_tr_b16 v[238:239], v251 offset:48128
    s_cbranch_vccnz L_spin_35
L_go_36:
    v_mfma_f32_16x16x32_bf16 v[152:155], v[128:131], v[212:215], v[152:155]
    ds_read_b64_tr_b16 v[208:209], v248 offset:0
    v_mov_b32 v6, 2
    v_mfma_f32_16x16x32_bf16 v[156:159], v[132:135], v[212:215], v[156:159]
    ds_read_b64_tr_b16 v[210:211], v248 offset:2048
    v_mfma_f32_16x16x32_bf16 v[160:163], v[128:131], v[216:219], v[160:163]
    ds_read_b64_tr_b16 v[212:213], v249 offset:0
    v_mov_b32 v254, 15
    v_mfma_f32_16x16x32_bf16 v[164:167], v[132:135], v[216:219], v[164:167]
    ds_read_b64_tr_b16 v[214:215], v249 offset:2048
    s_waitcnt vmcnt(0)
    s_mov_b32 exec_hi, 0
    buffer_store_dword v6, v11, s[60:63], s39 offen
    s_mov_b64 exec, -1
    v_mfma_f32_16x16x32_bf16 v[168:171], v[128:131], v[220:223], v[168:171]
    ds_read_b64_tr_b16 v[216:217], v250 offset:0
    ds_write_b32 v0, v254 offset:0
    v_mfma_f32_16x16x32_bf16 v[172:175], v[132:135], v[220:223], v[172:175]
    ds_read_b64_tr_b16 v[218:219], v250 offset:2048
    s_waitcnt lgkmcnt(7)
    v_mfma_f32_16x16x32_bf16 v[144:147], v[136:139], v[224:227], v[144:147]
    ds_read_b64_tr_b16 v[220:221], v251 offset:0
    v_mfma_f32_16x16x32_bf16 v[148:151], v[140:143], v[224:227], v[148:151]
    ds_read_b64_tr_b16 v[222:223], v251 offset:2048
    v_mfma_f32_16x16x32_bf16 v[152:155], v[136:139], v[228:231], v[152:155]
    ds_read_b64_tr_b16 v[224:225], v248 offset:4096
    v_mfma_f32_16x16x32_bf16 v[156:159], v[140:143], v[228:231], v[156:159]
    ds_read_b64_tr_b16 v[226:227], v248 offset:6144
    v_mfma_f32_16x16x32_bf16 v[160:163], v[136:139], v[232:235], v[160:163]
    ds_read_b64_tr_b16 v[228:229], v249 offset:4096
    v_mfma_f32_16x16x32_bf16 v[164:167], v[140:143], v[232:235], v[164:167]
    ds_read_b64_tr_b16 v[230:231], v249 offset:6144
    v_mfma_f32_16x16x32_bf16 v[168:171], v[136:139], v[236:239], v[168:171]
    ds_read_b64_tr_b16 v[232:233], v250 offset:4096
    v_mfma_f32_16x16x32_bf16 v[172:175], v[140:143], v[236:239], v[172:175]
    ds_read_b64_tr_b16 v[234:235], v250 offset:6144
    s_waitcnt lgkmcnt(6)
    v_mfma_f32_16x16x32_bf16 v[176:179], v[80:83], v[208:211], 0
    ds_read_b64_tr_b16 v[236:237], v251 offset:4096
    v_mfma_f32_16x16x32_bf16 v[180:183], v[84:87], v[208:211], 0
    ds_read_b64_tr_b16 v[238:239], v251 offset:6144
    v_mfma_f32_16x16x32_bf16 v[184:187], v[80:83], v[212:215], 0
    ds_read_b64_tr_b16 v[208:209], v248 offset:8192
    v_cvt_pk_bf16_f32 v144, v144, v145
    v_mfma_f32_16x16x32_bf16 v[188:191], v[84:87], v[212:215], 0
    ds_read_b64_tr_b16 v[210:211], v248 offset:10240
    v_cvt_pk_bf16_f32 v145, v146, v147
    v_mfma_f32_16x16x32_bf16 v[192:195], v[80:83], v[216:219], 0
    ds_read_b64_tr_b16 v[212:213], v249 offset:8192
    v_cvt_pk_bf16_f32 v146, v148, v149
    v_mfma_f32_16x16x32_bf16 v[196:199], v[84:87], v[216:219], 0
    ds_read_b64_tr_b16 v[214:215], v249 offset:10240
    v_cvt_pk_bf16_f32 v147, v150, v151
    v_mfma_f32_16x16x32_bf16 v[200:203], v[80:83], v[220:223], 0
    ds_read_b64_tr_b16 v[216:217], v250 offset:8192
    v_cvt_pk_bf16_f32 v148, v152, v153
    v_mfma_f32_16x16x32_bf16 v[204:207], v[84:87], v[220:223], 0
    ds_read_b64_tr_b16 v[218:219], v250 offset:10240
    s_waitcnt lgkmcnt(6)
    v_mfma_f32_16x16x32_bf16 v[176:179], v[88:91], v[224:227], v[176:179]
    ds_read_b64_tr_b16 v[220:221], v251 offset:8192
    v_cvt_pk_bf16_f32 v149, v154, v155
    v_mfma_f32_16x16x32_bf16 v[180:183], v[92:95], v[224:227], v[180:183]
    ds_read_b64_tr_b16 v[222:223], v251 offset:10240
    v_cvt_pk_bf16_f32 v150, v156, v157
    v_mfma_f32_16x16x32_bf16 v[184:187], v[88:91], v[228:231], v[184:187]
    ds_read_b64_tr_b16 v[224:225], v248 offset:12288
    v_cvt_pk_bf16_f32 v151, v158, v159
    v_mfma_f32_16x16x32_bf16 v[188:191], v[92:95], v[228:231], v[188:191]
    ds_read_b64_tr_b16 v[226:227], v248 offset:14336
    v_cvt_pk_bf16_f32 v152, v160, v161
    v_mfma_f32_16x16x32_bf16 v[192:195], v[88:91], v[232:235], v[192:195]
    ds_read_b64_tr_b16 v[228:229], v249 offset:12288
    v_add_u32 v248, 0x18c00, v3
    v_mfma_f32_16x16x32_bf16 v[196:199], v[92:95], v[232:235], v[196:199]
    ds_read_b64_tr_b16 v[230:231], v249 offset:14336
    v_cvt_pk_bf16_f32 v153, v162, v163
    v_mfma_f32_16x16x32_bf16 v[200:203], v[88:91], v[236:239], v[200:203]
    ds_read_b64_tr_b16 v[232:233], v250 offset:12288
    v_cvt_pk_bf16_f32 v154, v164, v165
    v_mfma_f32_16x16x32_bf16 v[204:207], v[92:95], v[236:239], v[204:207]
    ds_read_b64_tr_b16 v[234:235], v250 offset:14336
    s_waitcnt lgkmcnt(6)
    v_mfma_f32_16x16x32_bf16 v[176:179], v[96:99], v[208:211], v[176:179]
    ds_read_b64_tr_b16 v[236:237], v251 offset:12288
    v_cvt_pk_bf16_f32 v155, v166, v167
    v_mfma_f32_16x16x32_bf16 v[180:183], v[100:103], v[208:211], v[180:183]
    ds_read_b64_tr_b16 v[238:239], v251 offset:14336
    v_cvt_pk_bf16_f32 v156, v168, v169
    v_mfma_f32_16x16x32_bf16 v[184:187], v[96:99], v[212:215], v[184:187]
    ds_read_b64_tr_b16 v[208:209], v248 offset:16896
    v_xor_b32 v249, 32, v248
    v_mfma_f32_16x16x32_bf16 v[188:191], v[100:103], v[212:215], v[188:191]
    ds_read_b64_tr_b16 v[210:211], v248 offset:18944
    v_xor_b32 v250, 64, v248
    v_mfma_f32_16x16x32_bf16 v[192:195], v[96:99], v[216:219], v[192:195]
    ds_read_b64_tr_b16 v[212:213], v249 offset:16896
    v_xor_b32 v251, 96, v248
    v_mfma_f32_16x16x32_bf16 v[196:199], v[100:103], v[216:219], v[196:199]
    ds_read_b64_tr_b16 v[214:215], v249 offset:18944
    v_mov_b32 v254, 16
    v_mfma_f32_16x16x32_bf16 v[200:203], v[96:99], v[220:223], v[200:203]
    ds_read_b64_tr_b16 v[216:217], v250 offset:16896
    ds_write_b32 v0, v254 offset:0
    v_mfma_f32_16x16x32_bf16 v[204:207], v[100:103], v[220:223], v[204:207]
    ds_read_b64_tr_b16 v[218:219], v250 offset:18944
    s_waitcnt lgkmcnt(7)
    v_mfma_f32_16x16x32_bf16 v[176:179], v[104:107], v[224:227], v[176:179]
    ds_read_b64_tr_b16 v[220:221], v251 offset:16896
    v_cvt_pk_bf16_f32 v157, v170, v171
    v_mfma_f32_16x16x32_bf16 v[180:183], v[108:111], v[224:227], v[180:183]
    ds_read_b64_tr_b16 v[222:223], v251 offset:18944
    v_cvt_pk_bf16_f32 v158, v172, v173
    v_mfma_f32_16x16x32_bf16 v[184:187], v[104:107], v[228:231], v[184:187]
    ds_read_b64_tr_b16 v[224:225], v248 offset:20992
    v_cvt_pk_bf16_f32 v159, v174, v175
    v_mfma_f32_16x16x32_bf16 v[188:191], v[108:111], v[228:231], v[188:191]
    ds_read_b64_tr_b16 v[226:227], v248 offset:23040
    v_mfma_f32_16x16x32_bf16 v[192:195], v[104:107], v[232:235], v[192:195]
    ds_read_b64_tr_b16 v[228:229], v249 offset:20992
    v_mfma_f32_16x16x32_bf16 v[196:199], v[108:111], v[232:235], v[196:199]
    ds_read_b64_tr_b16 v[230:231], v249 offset:23040
    v_mfma_f32_16x16x32_bf16 v[200:203], v[104:107], v[236:239], v[200:203]
    ds_read_b64_tr_b16 v[232:233], v250 offset:20992
    v_mfma_f32_16x16x32_bf16 v[204:207], v[108:111], v[236:239], v[204:207]
    ds_read_b64_tr_b16 v[234:235], v250 offset:23040
    s_waitcnt lgkmcnt(6)
    v_mfma_f32_16x16x32_bf16 v[176:179], v[112:115], v[208:211], v[176:179]
    ds_read_b64_tr_b16 v[236:237], v251 offset:20992
    v_mfma_f32_16x16x32_bf16 v[180:183], v[116:119], v[208:211], v[180:183]
    ds_read_b64_tr_b16 v[238:239], v251 offset:23040
    v_mfma_f32_16x16x32_bf16 v[184:187], v[112:115], v[212:215], v[184:187]
    ds_read_b64_tr_b16 v[208:209], v248 offset:25088
    v_mfma_f32_16x16x32_bf16 v[188:191], v[116:119], v[212:215], v[188:191]
    ds_read_b64_tr_b16 v[210:211], v248 offset:27136
    v_mfma_f32_16x16x32_bf16 v[192:195], v[112:115], v[216:219], v[192:195]
    ds_read_b64_tr_b16 v[212:213], v249 offset:25088
    v_mfma_f32_16x16x32_bf16 v[196:199], v[116:119], v[216:219], v[196:199]
    ds_read_b64_tr_b16 v[214:215], v249 offset:27136
    v_mfma_f32_16x16x32_bf16 v[200:203], v[112:115], v[220:223], v[200:203]
    ds_read_b64_tr_b16 v[216:217], v250 offset:25088
    v_mfma_f32_16x16x32_bf16 v[204:207], v[116:119], v[220:223], v[204:207]
    ds_read_b64_tr_b16 v[218:219], v250 offset:27136
    s_waitcnt lgkmcnt(6)
    v_mfma_f32_16x16x32_bf16 v[176:179], v[120:123], v[224:227], v[176:179]
    ds_read_b64_tr_b16 v[220:221], v251 offset:25088
    v_mfma_f32_16x16x32_bf16 v[180:183], v[124:127], v[224:227], v[180:183]
    ds_read_b64_tr_b16 v[222:223], v251 offset:27136
    v_mfma_f32_16x16x32_bf16 v[184:187], v[120:123], v[228:231], v[184:187]
    ds_read_b64_tr_b16 v[224:225], v248 offset:29184
    v_mfma_f32_16x16x32_bf16 v[188:191], v[124:127], v[228:231], v[188:191]
    ds_read_b64_tr_b16 v[226:227], v248 offset:31232
    v_mfma_f32_16x16x32_bf16 v[192:195], v[120:123], v[232:235], v[192:195]
    ds_read_b64_tr_b16 v[228:229], v249 offset:29184
    v_mfma_f32_16x16x32_bf16 v[196:199], v[124:127], v[232:235], v[196:199]
    ds_read_b64_tr_b16 v[230:231], v249 offset:31232
    v_mfma_f32_16x16x32_bf16 v[200:203], v[120:123], v[236:239], v[200:203]
    ds_read_b64_tr_b16 v[232:233], v250 offset:29184
    v_mfma_f32_16x16x32_bf16 v[204:207], v[124:127], v[236:239], v[204:207]
    ds_read_b64_tr_b16 v[234:235], v250 offset:31232
    s_waitcnt lgkmcnt(6)
    v_mfma_f32_16x16x32_bf16 v[176:179], v[128:131], v[208:211], v[176:179]
    ds_read_b64_tr_b16 v[236:237], v251 offset:29184
    v_mfma_f32_16x16x32_bf16 v[180:183], v[132:135], v[208:211], v[180:183]
    ds_read_b64_tr_b16 v[238:239], v251 offset:31232
    v_mfma_f32_16x16x32_bf16 v[184:187], v[128:131], v[212:215], v[184:187]
    v_mfma_f32_16x16x32_bf16 v[188:191], v[132:135], v[212:215], v[188:191]
    v_mfma_f32_16x16x32_bf16 v[192:195], v[128:131], v[216:219], v[192:195]
    v_mov_b32 v254, 17
    v_mfma_f32_16x16x32_bf16 v[196:199], v[132:135], v[216:219], v[196:199]
    ds_write_b32 v0, v254 offset:0
    v_mfma_f32_16x16x32_bf16 v[200:203], v[128:131], v[220:223], v[200:203]
    v_mfma_f32_16x16x32_bf16 v[204:207], v[132:135], v[220:223], v[204:207]
    s_waitcnt lgkmcnt(1)
    v_mfma_f32_16x16x32_bf16 v[176:179], v[136:139], v[224:227], v[176:179]
    v_mfma_f32_16x16x32_bf16 v[180:183], v[140:143], v[224:227], v[180:183]
    v_mfma_f32_16x16x32_bf16 v[184:187], v[136:139], v[228:231], v[184:187]
    v_mfma_f32_16x16x32_bf16 v[188:191], v[140:143], v[228:231], v[188:191]
    v_mfma_f32_16x16x32_bf16 v[192:195], v[136:139], v[232:235], v[192:195]
    v_mfma_f32_16x16x32_bf16 v[196:199], v[140:143], v[232:235], v[196:199]
    v_mfma_f32_16x16x32_bf16 v[200:203], v[136:139], v[236:239], v[200:203]
    v_mfma_f32_16x16x32_bf16 v[204:207], v[140:143], v[236:239], v[204:207]
    s_lshl_b32 s32, s44, 4
    v_add_u32 v3, s32, v8
    s_cmp_eq_u32 s44, 0
    s_cbranch_scc0 L_skip_37
    s_mov_b32 s34, 262144
L_poll_38:
    buffer_load_dword v255, v1, s[60:63], s39 offen sc1
    s_waitcnt vmcnt(0)
    v_cmp_gt_u32 vcc, 1, v255
    s_cbranch_vccz L_polled_39
    s_sleep 1
    s_sub_u32 s34, s34, 1
    s_cbranch_scc0 L_poll_38
L_polled_39:
    v_mov_b32 v254, 1
    ds_write_b32 v3, v254 offset:96
L_skip_37:
    s_cmp_ge_u32 s44, 2
    s_cbranch_scc0 L_skip_40
    v_lshrrev_b32 v12, 9, v5
    v_lshlrev_b32 v12, 4, v12
    v_xor_b32 v12, v12, v5
    s_cmp_eq_u32 s44, 2
    s_cselect_b32 s4, 4, 5
    s_cselect_b32 s5, 1, 3
    s_mul_i32 s4, s4, 16896
    s_mul_i32 s5, s5, 16896
    s_lshl_b32 s35, s44, 15
    s_mov_b32 s34, 1048576
L_lw_41:
    ds_read_b32 v255, v8 offset:0
    s_waitcnt lgkmcnt(0)
    v_cmp_gt_u32 vcc, 16, v255
    s_cbranch_vccz L_lwd_42
    s_sleep 1
    s_sub_u32 s34, s34, 1
    s_cbranch_scc0 L_lw_41
L_lwd_42:
    s_add_u32 m0, s4, 0
    s_add_u32 s100, s35, 0x0
    buffer_load_dwordx4 v12, s[48:51], s100 offen offset:0 lds
    s_add_u32 m0, m0, 32
    s_nop 0
    buffer_load_dwordx4 v12, s[48:51], s100 offen offset:1024 lds
    s_add_u32 m0, m0, 32
    s_nop 0
    buffer_load_dwordx4 v12, s[48:51], s100 offen offset:2048 lds
    s_add_u32 m0, m0, 32
    s_nop 0
    buffer_load_dwordx4 v12, s[48:51], s100 offen offset:3072 lds
    s_add_u32 m0, s4, 4224
    s_add_u32 s100, s35, 0x1000
    buffer_load_dwordx4 v12, s[48:51], s100 offen offset:0 lds
    s_add_u32 m0, m0, 32
    s_nop 0
    buffer_load_dwordx4 v12, s[48:51], s100 offen offset:1024 lds
    s_add_u32 m0, m0, 32
    s_nop 0
    buffer_load_dwordx4 v12, s[48:51], s100 offen offset:2048 lds
    s_add_u32 m0, m0, 32
    s_nop 0
    buffer_load_dwordx4 v12, s[48:51], s100 offen offset:3072 lds
    s_add_u32 m0, s4, 8448
    s_add_u32 s100, s35, 0x2000
    buffer_load_dwordx4 v12, s[48:51], s100 offen offset:0 lds
    s_add_u32 m0, m0, 32
    s_nop 0
    buffer_load_dwordx4 v12, s[48:51], s100 offen offset:1024 lds
    s_add_u32 m0, m0, 32
    s_nop 0
    buffer_load_dwordx4 v12, s[48:51], s100 offen offset:2048 lds
    s_add_u32 m0, m0, 32
    s_nop 0
    buffer_load_dwordx4 v12, s[48:51], s100 offen offset:3072 lds
    s_add_u32 m0, s4, 12672
    s_add_u32 s100, s35, 0x3000
    buffer_load_dwordx4 v12, s[48:51], s100 offen offset:0 lds
    s_add_u32 m0, m0, 32
    s_nop 0
    buffer_load_dwordx4 v12, s[48:51], s100 offen offset:1024 lds
    s_add_u32 m0, m0, 32
    s_nop 0
    buffer_load_dwordx4 v12, s[48:51], s100 offen offset:2048 lds
    s_add_u32 m0, m0, 32
    s_nop 0
    buffer_load_dwordx4 v12, s[48:51], s100 offen offset:3072 lds
    s_add_u32 m0, s5, 0
    s_add_u32 s100, s35, 0x4000
    buffer_load_dwordx4 v12, s[48:51], s100 offen offset:0 lds
    s_add_u32 m0, m0, 32
    s_nop 0
    buffer_load_dwordx4 v12, s[48:51], s100 offen offset:1024 lds
    s_add_u32 m0, m0, 32
    s_nop 0
    buffer_load_dwordx4 v12, s[48:51], s100 offen offset:2048 lds
    s_add_u32 m0, m0, 32
    s_nop 0
    buffer_load_dwordx4 v12, s[48:51], s100 offen offset:3072 lds
    s_add_u32 m0, s5, 4224
    s_add_u32 s100, s35, 0x5000
    buffer_load_dwordx4 v12, s[48:51], s100 offen offset:0 lds
    s_add_u32 m0, m0, 32
    s_nop 0
    buffer_load_dwordx4 v12, s[48:51], s100 offen offset:1024 lds
    s_add_u32 m0, m0, 32
    s_nop 0
    buffer_load_dwordx4 v12, s[48:51], s100 offen offset:2048 lds
    s_add_u32 m0, m0, 32
    s_nop 0
    buffer_load_dwordx4 v12, s[48:51], s100 offen offset:3072 lds
    s_add_u32 m0, s5, 8448
    s_add_u32 s100, s35, 0x6000
    buffer_load_dwordx4 v12, s[48:51], s100 offen offset:0 lds
    s_add_u32 m0, m0, 32
    s_nop 0
    buffer_load_dwordx4 v12, s[48:51], s100 offen offset:1024 lds
    s_add_u32 m0, m0, 32
    s_nop 0
    buffer_load_dwordx4 v12, s[48:51], s100 offen offset:2048 lds
    s_add_u32 m0, m0, 32
    s_nop 0
    buffer_load_dwordx4 v12, s[48:51], s100 offen offset:3072 lds
    s_add_u32 m0, s5, 12672
    s_add_u32 s100, s35, 0x7000
    buffer_load_dwordx4 v12, s[48:51], s100 offen offset:0 lds
    s_add_u32 m0, m0, 32
    s_nop 0
    buffer_load_dwordx4 v12, s[48:51], s100 offen offset:1024 lds
    s_add_u32 m0, m0, 32
    s_nop 0
    buffer_load_dwordx4 v12, s[48:51], s100 offen offset:2048 lds
    s_add_u32 m0, m0, 32
    s_nop 0
    buffer_load_dwordx4 v12, s[48:51], s100 offen offset:3072 lds
L_skip_40:
    s_nop 3
    v_cvt_pk_bf16_f32 v176, v176, v177
    v_cvt_pk_bf16_f32 v177, v178, v179
    v_cvt_pk_bf16_f32 v178, v180, v181
    v_cvt_pk_bf16_f32 v179, v182, v183
    v_cvt_pk_bf16_f32 v180, v184, v185
    v_cvt_pk_bf16_f32 v181, v186, v187
    v_cvt_pk_bf16_f32 v182, v188, v189
    v_cvt_pk_bf16_f32 v183, v190, v191
    v_cvt_pk_bf16_f32 v184, v192, v193
    v_cvt_pk_bf16_f32 v185, v194, v195
    v_cvt_pk_bf16_f32 v186, v196, v197
    v_cvt_pk_bf16_f32 v187, v198, v199
    v_cvt_pk_bf16_f32 v188, v200, v201
    v_cvt_pk_bf16_f32 v189, v202, v203
    v_cvt_pk_bf16_f32 v190, v204, v205
    v_cvt_pk_bf16_f32 v191, v206, v207
    s_lshl_b32 s33, s44, 7
    s_add_u32 s19, s19, s33
    s_lshl_b32 s35, s44, 3
    s_lshr_b32 s4, 0x18161412, s35
    s_and_b32 s4, s4, 0xff
    s_lshr_b32 s5, 0x1020007, s35
    s_and_b32 s5, s5, 0xff
    s_lshr_b32 s6, 0x5040806, s35
    s_and_b32 s6, s6, 0xff
    s_mul_i32 s5, s5, 16896
    s_mul_i32 s6, s6, 16896
    s_cmp_ge_u32 s44, 2
    s_cbranch_scc0 L_skip_43
    s_waitcnt vmcnt(0)
    v_mov_b32 v254, 1
    ds_write_b32 v3, v254 offset:192
L_skip_43:
    s_mov_b32 s34, 1048576
L_lw_44:
    ds_read_b32 v255, v0 offset:96
    s_waitcnt lgkmcnt(0)
    v_cmp_gt_u32 vcc, 1, v255
    s_cbranch_vccz L_lwd_45
    s_sleep 1
    s_sub_u32 s34, s34, 1
    s_cbranch_scc0 L_lw_44
L_lwd_45:
    buffer_store_dwordx4 v[144:147], v9, s[52:55], s10 offen offset:256
    buffer_store_dwordx4 v[148:151], v9, s[52:55], s11 offen offset:256
    buffer_store_dwordx4 v[152:155], v9, s[52:55], s12 offen offset:256
    buffer_store_dwordx4 v[156:159], v9, s[52:55], s13 offen offset:256
    v_mov_b32 v6, 3
    s_waitcnt vmcnt(0)
    s_mov_b32 exec_hi, 0
    buffer_store_dword v6, v11, s[60:63], s39 offen
    s_mov_b64 exec, -1
    s_cmp_eq_u32 s44, 1
    s_cbranch_scc0 L_skip_46
    s_mov_b32 s34, 262144
L_poll_47:
    buffer_load_dword v255, v1, s[60:63], s39 offen sc1
    s_waitcnt vmcnt(0)
    v_cmp_gt_u32 vcc, 1, v255
    s_cbranch_vccz L_polled_48
    s_sleep 1
    s_sub_u32 s34, s34, 1
    s_cbranch_scc0 L_poll_47
L_polled_48:
    v_mov_b32 v254, 1
    ds_write_b32 v3, v254 offset:96
L_skip_46:
    s_mov_b32 s34, 1048576
L_lw_49:
    ds_read_b32 v255, v0 offset:112
    s_waitcnt lgkmcnt(0)
    v_cmp_gt_u32 vcc, 1, v255
    s_cbranch_vccz L_lwd_50
    s_sleep 1
    s_sub_u32 s34, s34, 1
    s_cbranch_scc0 L_lw_49
L_lwd_50:
    buffer_store_dwordx4 v[176:179], v9, s[52:55], s10 offen offset:384
    buffer_store_dwordx4 v[180:183], v9, s[52:55], s11 offen offset:384
    buffer_store_dwordx4 v[184:187], v9, s[52:55], s12 offen offset:384
    buffer_store_dwordx4 v[188:191], v9, s[52:55], s13 offen offset:384
    v_mov_b32 v6, 4
    s_waitcnt vmcnt(0)
    s_mov_b32 exec_hi, 0
    buffer_store_dword v6, v11, s[60:63], s39 offen
    s_mov_b64 exec, -1
    s_cmp_ge_u32 s44, 2
    s_cbranch_scc0 L_skip_51
    v_bfe_u32 v12, v5, 4, 3
    s_lshl_b32 s34, s42, 10
    v_lshl_add_u32 v2, v12, 7, s34
    s_add_u32 s32, s44, 1
    s_mov_b32 s34, 262144
L_poll_52:
    buffer_load_dword v255, v2, s[60:63], s39 offen sc1
    s_waitcnt vmcnt(0)
    v_cmp_gt_u32 vcc, s32, v255
    s_cbranch_vccz L_polled_53
    s_sleep 1
    s_sub_u32 s34, s34, 1
    s_cbranch_scc0 L_poll_52
L_polled_53:
    s_add_u32 s33, s19, 0x0
    buffer_load_dwordx4 v[16:19], v7, s[56:59], s33 offen offset:0 sc1
    buffer_load_dwordx4 v[20:23], v7, s[56:59], s33 offen offset:1024 sc1
    s_add_u32 s33, s19, 0x80000
    buffer_load_dwordx4 v[24:27], v7, s[56:59], s33 offen offset:0 sc1
    buffer_load_dwordx4 v[28:31], v7, s[56:59], s33 offen offset:1024 sc1
    s_add_u32 s33, s19, 0x1000
    buffer_load_dwordx4 v[32:35], v7, s[56:59], s33 offen offset:0 sc1
    buffer_load_dwordx4 v[36:39], v7, s[56:59], s33 offen offset:1024 sc1
    s_add_u32 s33, s19, 0x81000
    buffer_load_dwordx4 v[40:43], v7, s[56:59], s33 offen offset:0 sc1
    buffer_load_dwordx4 v[44:47], v7, s[56:59], s33 offen offset:1024 sc1
    s_add_u32 s33, s19, 0x2000
    buffer_load_dwordx4 v[48:51], v7, s[56:59], s33 offen offset:0 sc1
    buffer_load_dwordx4 v[52:55], v7, s[56:59], s33 offen offset:1024 sc1
    s_add_u32 s33, s19, 0x82000
    buffer_load_dwordx4 v[56:59], v7, s[56:59], s33 offen offset:0 sc1
    buffer_load_dwordx4 v[60:63], v7, s[56:59], s33 offen offset:1024 sc1
    s_add_u32 s33, s19, 0x3000
    buffer_load_dwordx4 v[64:67], v7, s[56:59], s33 offen offset:0 sc1
    buffer_load_dwordx4 v[68:71], v7, s[56:59], s33 offen offset:1024 sc1
    s_add_u32 s33, s19, 0x83000
    buffer_load_dwordx4 v[72:75], v7, s[56:59], s33 offen offset:0 sc1
    buffer_load_dwordx4 v[76:79], v7, s[56:59], s33 offen offset:1024 sc1
    s_waitcnt vmcnt(8)
    v_mfma_f32_16x16x32_bf16 v[80:83], v[240:243], v[16:19], 0
    v_mfma_f32_16x16x32_bf16 v[84:87], v[240:243], v[20:23], 0
    v_mfma_f32_16x16x32_bf16 v[80:83], v[240:243], v[24:27], v[80:83]
    v_mfma_f32_16x16x32_bf16 v[84:87], v[240:243], v[28:31], v[84:87]
    v_mfma_f32_16x16x32_bf16 v[80:83], v[244:247], v[32:35], v[80:83]
    v_mfma_f32_16x16x32_bf16 v[84:87], v[244:247], v[36:39], v[84:87]
    v_mfma_f32_16x16x32_bf16 v[80:83], v[244:247], v[40:43], v[80:83]
    v_mfma_f32_16x16x32_bf16 v[84:87], v[244:247], v[44:47], v[84:87]
    s_waitcnt vmcnt(0)
    v_mfma_f32_16x16x32_bf16 v[88:91], v[240:243], v[48:51], 0
    v_mfma_f32_16x16x32_bf16 v[92:95], v[240:243], v[52:55], 0
    v_mfma_f32_16x16x32_bf16 v[88:91], v[240:243], v[56:59], v[88:91]
    v_mfma_f32_16x16x32_bf16 v[92:95], v[240:243], v[60:63], v[92:95]
    v_mfma_f32_16x16x32_bf16 v[88:91], v[244:247], v[64:67], v[88:91]
    v_mfma_f32_16x16x32_bf16 v[92:95], v[244:247], v[68:71], v[92:95]
    v_mfma_f32_16x16x32_bf16 v[88:91], v[244:247], v[72:75], v[88:91]
    v_mfma_f32_16x16x32_bf16 v[92:95], v[244:247], v[76:79], v[92:95]
    s_nop 7
    v_cvt_pk_bf16_f32 v80, v80, v81
    v_cvt_pk_bf16_f32 v81, v82, v83
    v_cvt_pk_bf16_f32 v84, v84, v85
    v_cvt_pk_bf16_f32 v85, v86, v87
    v_cvt_pk_bf16_f32 v88, v88, v89
    v_cvt_pk_bf16_f32 v89, v90, v91
    v_cvt_pk_bf16_f32 v92, v92, v93
    v_cvt_pk_bf16_f32 v93, v94, v95
    buffer_store_dwordx2 v[80:81], v10, s[60:63], s18 offen offset:0
    buffer_store_dwordx2 v[84:85], v10, s[60:63], s18 offen offset:256
    buffer_store_dwordx2 v[88:89], v10, s[60:63], s18 offen offset:128
    buffer_store_dwordx2 v[92:93], v10, s[60:63], s18 offen offset:384
    v_mov_b32 v6, 1
    s_waitcnt vmcnt(0)
    s_mov_b32 exec_hi, 0
    buffer_store_dword v6, v11, s[60:63], s101 offen
    s_mov_b64 exec, -1
    s_mov_b32 s34, 262144
L_poll_54:
    buffer_load_dword v255, v1, s[60:63], s39 offen sc1
    s_waitcnt vmcnt(0)
    v_cmp_gt_u32 vcc, 1, v255
    s_cbranch_vccz L_polled_55
    s_sleep 1
    s_sub_u32 s34, s34, 1
    s_cbranch_scc0 L_poll_54
L_polled_55:
L_skip_51:
    s_mov_b32 s34, 1048576
L_lw_56:
    ds_read_b32 v255, v8 offset:0
    s_waitcnt lgkmcnt(0)
    v_cmp_gt_u32 vcc, 17, v255
    s_cbranch_vccz L_lwd_57
    s_sleep 1
    s_sub_u32 s34, s34, 1
    s_cbranch_scc0 L_lw_56
L_lwd_57:
    s_mov_b32 s34, 1048576
L_lw_58:
    ds_read_b32 v255, v8 offset:32
    s_waitcnt lgkmcnt(0)
    v_cmp_gt_u32 vcc, s4, v255
    s_cbranch_vccz L_lwd_59
    s_sleep 1
    s_sub_u32 s34, s34, 1
    s_cbranch_scc0 L_lw_58
L_lwd_59:
    s_add_u32 m0, s5, 0
    s_add_u32 s100, s15, 0x0
    buffer_load_dwordx4 v5, s[60:63], s100 offen offset:0 sc1 lds
    buffer_load_dwordx4 v5, s[60:63], s100 offen offset:1024 sc1 lds
    buffer_load_dwordx4 v5, s[60:63], s100 offen offset:2048 sc1 lds
    buffer_load_dwordx4 v5, s[60:63], s100 offen offset:3072 sc1 lds
    s_add_u32 m0, s5, 4096
    s_add_u32 s100, s15, 0x1000
    buffer_load_dwordx4 v5, s[60:63], s100 offen offset:0 sc1 lds
    buffer_load_dwordx4 v5, s[60:63], s100 offen offset:1024 sc1 lds
    buffer_load_dwordx4 v5, s[60:63], s100 offen offset:2048 sc1 lds
    buffer_load_dwordx4 v5, s[60:63], s100 offen offset:3072 sc1 lds
    s_add_u32 m0, s5, 8192
    s_add_u32 s100, s15, 0x2000
    buffer_load_dwordx4 v5, s[60:63], s100 offen offset:0 sc1 lds
    buffer_load_dwordx4 v5, s[60:63], s100 offen offset:1024 sc1 lds
    buffer_load_dwordx4 v5, s[60:63], s100 offen offset:2048 sc1 lds
    buffer_load_dwordx4 v5, s[60:63], s100 offen offset:3072 sc1 lds
    s_add_u32 m0, s5, 12288
    s_add_u32 s100, s15, 0x3000
    buffer_load_dwordx4 v5, s[60:63], s100 offen offset:0 sc1 lds
    buffer_load_dwordx4 v5, s[60:63], s100 offen offset:1024 sc1 lds
    buffer_load_dwordx4 v5, s[60:63], s100 offen offset:2048 sc1 lds
    buffer_load_dwordx4 v5, s[60:63], s100 offen offset:3072 sc1 lds
    s_add_u32 m0, s6, 0
    s_add_u32 s100, s15, 0x4000
    buffer_load_dwordx4 v5, s[60:63], s100 offen offset:0 sc1 lds
    buffer_load_dwordx4 v5, s[60:63], s100 offen offset:1024 sc1 lds
    buffer_load_dwordx4 v5, s[60:63], s100 offen offset:2048 sc1 lds
    buffer_load_dwordx4 v5, s[60:63], s100 offen offset:3072 sc1 lds
    s_add_u32 m0, s6, 4096
    s_add_u32 s100, s15, 0x5000
    buffer_load_dwordx4 v5, s[60:63], s100 offen offset:0 sc1 lds
    buffer_load_dwordx4 v5, s[60:63], s100 offen offset:1024 sc1 lds
    buffer_load_dwordx4 v5, s[60:63], s100 offen offset:2048 sc1 lds
    buffer_load_dwordx4 v5, s[60:63], s100 offen offset:3072 sc1 lds
    s_add_u32 m0, s6, 8192
    s_add_u32 s100, s15, 0x6000
    buffer_load_dwordx4 v5, s[60:63], s100 offen offset:0 sc1 lds
    buffer_load_dwordx4 v5, s[60:63], s100 offen offset:1024 sc1 lds
    buffer_load_dwordx4 v5, s[60:63], s100 offen offset:2048 sc1 lds
    buffer_load_dwordx4 v5, s[60:63], s100 offen offset:3072 sc1 lds
    s_add_u32 m0, s6, 12288
    s_add_u32 s100, s15, 0x7000
    buffer_load_dwordx4 v5, s[60:63], s100 offen offset:0 sc1 lds
    buffer_load_dwordx4 v5, s[60:63], s100 offen offset:1024 sc1 lds
    buffer_load_dwordx4 v5, s[60:63], s100 offen offset:2048 sc1 lds
    buffer_load_dwordx4 v5, s[60:63], s100 offen offset:3072 sc1 lds
    s_cmp_eq_u32 s44, 0
    s_cbranch_scc0 L_skip_60
    s_lshl_b32 s32, s40, 13
    s_add_u32 s32, s32, 0x200000
    buffer_load_dwordx4 v[16:19], v5, s[60:63], s32 offen offset:0 sc1
    buffer_load_dwordx4 v[20:23], v5, s[60:63], s32 offen offset:1024 sc1
    buffer_load_dwordx4 v[24:27], v5, s[60:63], s32 offen offset:2048 sc1
    buffer_load_dwordx4 v[28:31], v5, s[60:63], s32 offen offset:3072 sc1
    s_add_u32 s32, s32, 4096
    buffer_load_dwordx4 v[32:35], v5, s[60:63], s32 offen offset:0 sc1
    buffer_load_dwordx4 v[36:39], v5, s[60:63], s32 offen offset:1024 sc1
    buffer_load_dwordx4 v[40:43], v5, s[60:63], s32 offen offset:2048 sc1
    buffer_load_dwordx4 v[44:47], v5, s[60:63], s32 offen offset:3072 sc1
    v_lshrrev_b32 v12, 7, v5
    v_lshlrev_b32 v12, 6, v12
    v_and_b32 v13, 48, v5
    v_add_u32 v12, v12, v13
    v_bfe_u32 v13, v5, 6, 1
    v_lshl_add_u32 v12, v13, 3, v12
    v_add_u32 v12, 0x25600, v12
    s_waitcnt vmcnt(0)
    v_add_f32 v16, v16, v20
    v_add_f32 v17, v17, v21
    v_add_f32 v18, v18, v22
    v_add_f32 v19, v19, v23
    v_add_f32 v16, v16, v24
    v_add_f32 v17, v17, v25
    v_add_f32 v18, v18, v26
    v_add_f32 v19, v19, v27
    v_add_f32 v16, v16, v28
    v_add_f32 v17, v17, v29
    v_add_f32 v18, v18, v30
    v_add_f32 v19, v19, v31
    v_add_f32 v16, v16, v32
    v_add_f32 v17, v17, v33
    v_add_f32 v18, v18, v34
    v_add_f32 v19, v19, v35
    v_add_f32 v16, v16, v36
    v_add_f32 v17, v17, v37
    v_add_f32 v18, v18, v38
    v_add_f32 v19, v19, v39
    v_add_f32 v16, v16, v40
    v_add_f32 v17, v17, v41
    v_add_f32 v18, v18, v42
    v_add_f32 v19, v19, v43
    v_add_f32 v16, v16, v44
    v_add_f32 v17, v17, v45
    v_add_f32 v18, v18, v46
    v_add_f32 v19, v19, v47
    v_cvt_pk_bf16_f32 v16, v16, v17
    v_cvt_pk_bf16_f32 v17, v18, v19
    ds_write_b64 v12, v[16:17]
L_skip_60:
    s_waitcnt vmcnt(0)
    v_mov_b32 v254, 1
    ds_write_b32 v3, v254 offset:128
    s_waitcnt lgkmcnt(0)
    s_endpgm
L_spin_5:
    s_mov_b32 s34, 1048576
L_spin_5b:
    ds_read_b32 v255, v8 offset:16
    s_waitcnt lgkmcnt(0)
    v_cmp_gt_u32 vcc, 3, v255
    s_cbranch_vccz L_go_6
    s_sub_u32 s34, s34, 1
    s_cbranch_scc0 L_spin_5b
    s_branch L_go_6
L_spin_7:
    s_mov_b32 s34, 1048576
L_spin_7b:
    ds_read_b32 v255, v8 offset:0
    s_waitcnt lgkmcnt(0)
    v_cmp_gt_u32 vcc, 2, v255
    s_cbranch_vccz L_go_8
    s_sub_u32 s34, s34, 1
    s_cbranch_scc0 L_spin_7b
    s_branch L_go_8
L_spin_9:
    s_mov_b32 s34, 1048576
L_spin_9b:
    ds_read_b32 v255, v8 offset:16
    s_waitcnt lgkmcnt(0)
    v_cmp_gt_u32 vcc, 4, v255
    s_cbranch_vccz L_go_10
    s_sub_u32 s34, s34, 1
    s_cbranch_scc0 L_spin_9b
    s_branch L_go_10
L_spin_11:
    s_mov_b32 s34, 1048576
L_spin_11b:
    ds_read_b32 v255, v8 offset:0
    s_waitcnt lgkmcnt(0)
    v_cmp_gt_u32 vcc, 3, v255
    s_cbranch_vccz L_go_12
    s_sub_u32 s34, s34, 1
    s_cbranch_scc0 L_spin_11b
    s_branch L_go_12
L_spin_13:
    s_mov_b32 s34, 1048576
L_spin_13b:
    ds_read_b32 v255, v8 offset:16
    s_waitcnt lgkmcnt(0)
    v_cmp_gt_u32 vcc, 6, v255
    s_cbranch_vccz L_go_14
    s_sub_u32 s34, s34, 1
    s_cbranch_scc0 L_spin_13b
    s_branch L_go_14
L_spin_15:
    s_mov_b32 s34, 1048576
L_spin_15b:
    ds_read_b32 v255, v8 offset:0
    s_waitcnt lgkmcnt(0)
    v_cmp_gt_u32 vcc, 4, v255
    s_cbranch_vccz L_go_16
    s_sub_u32 s34, s34, 1
    s_cbranch_scc0 L_spin_15b
    s_branch L_go_16
L_spin_17:
    s_mov_b32 s34, 1048576
L_spin_17b:
    ds_read_b32 v255, v8 offset:16
    s_waitcnt lgkmcnt(0)
    v_cmp_gt_u32 vcc, 7, v255
    s_cbranch_vccz L_go_18
    s_sub_u32 s34, s34, 1
    s_cbranch_scc0 L_spin_17b
    s_branch L_go_18
L_spin_19:
    s_mov_b32 s34, 1048576
L_spin_19b:
    ds_read_b32 v255, v8 offset:0
    s_waitcnt lgkmcnt(0)
    v_cmp_gt_u32 vcc, 5, v255
    s_cbranch_vccz L_go_20
    s_sub_u32 s34, s34, 1
    s_cbranch_scc0 L_spin_19b
    s_branch L_go_20
L_spin_21:
    s_mov_b32 s34, 1048576
L_spin_21b:
    ds_read_b32 v255, v8 offset:16
    s_waitcnt lgkmcnt(0)
    v_cmp_gt_u32 vcc, 9, v255
    s_cbranch_vccz L_go_22
    s_sub_u32 s34, s34, 1
    s_cbranch_scc0 L_spin_21b
    s_branch L_go_22
L_spin_23:
    s_mov_b32 s34, 1048576
L_spin_23b:
    ds_read_b32 v255, v8 offset:0
    s_waitcnt lgkmcnt(0)
    v_cmp_gt_u32 vcc, 6, v255
    s_cbranch_vccz L_go_24
    s_sub_u32 s34, s34, 1
    s_cbranch_scc0 L_spin_23b
    s_branch L_go_24
L_spin_25:
    s_mov_b32 s34, 1048576
L_spin_25b:
    ds_read_b32 v255, v8 offset:0
    s_waitcnt lgkmcnt(0)
    v_cmp_gt_u32 vcc, 7, v255
    s_cbranch_vccz L_go_26
    s_sub_u32 s34, s34, 1
    s_cbranch_scc0 L_spin_25b
    s_branch L_go_26
L_spin_27:
    s_mov_b32 s34, 1048576
L_spin_27b:
    ds_read_b32 v255, v8 offset:16
    s_waitcnt lgkmcnt(0)
    v_cmp_gt_u32 vcc, 12, v255
    s_cbranch_vccz L_go_28
    s_sub_u32 s34, s34, 1
    s_cbranch_scc0 L_spin_27b
    s_branch L_go_28
L_spin_29:
    s_mov_b32 s34, 1048576
L_spin_29b:
    ds_read_b32 v255, v0 offset:80
    s_waitcnt lgkmcnt(0)
    v_cmp_gt_u32 vcc, 1, v255
    s_cbranch_vccz L_go_30
    s_sub_u32 s34, s34, 1
    s_cbranch_scc0 L_spin_29b
    s_branch L_go_30
L_spin_31:
    s_mov_b32 s34, 1048576
L_spin_31b:
    ds_read_b32 v255, v8 offset:16
    s_waitcnt lgkmcnt(0)
    v_cmp_gt_u32 vcc, 14, v255
    s_cbranch_vccz L_go_32
    s_sub_u32 s34, s34, 1
    s_cbranch_scc0 L_spin_31b
    s_branch L_go_32
L_spin_33:
    s_mov_b32 s34, 1048576
L_spin_33b:
    ds_read_b32 v255, v8 offset:16
    s_waitcnt lgkmcnt(0)
    v_cmp_gt_u32 vcc, 16, v255
    s_cbranch_vccz L_go_34
    s_sub_u32 s34, s34, 1
    s_cbranch_scc0 L_spin_33b
    s_branch L_go_34
L_spin_35:
    s_mov_b32 s34, 1048576
L_spin_35b:
    ds_read_b32 v255, v8 offset:16
    s_waitcnt lgkmcnt(0)
    v_cmp_gt_u32 vcc, 18, v255
    s_cbranch_vccz L_go_36
    s_sub_u32 s34, s34, 1
    s_cbranch_scc0 L_spin_35b
    s_branch L_go_36
L_g2:
    s_add_u32 m0, s46, 0
    s_add_u32 s100, s47, 0x0
    buffer_load_dwordx4 v1, s[20:23], s100 offen offset:0 nt lds
    s_add_u32 m0, s46, 32
    s_add_u32 s100, s47, 0x0
    buffer_load_dwordx4 v1, s[20:23], s100 offen offset:1024 nt lds
    s_add_u32 m0, s46, 64
    s_add_u32 s100, s47, 0x0
    buffer_load_dwordx4 v1, s[20:23], s100 offen offset:2048 nt lds
    s_add_u32 m0, s46, 96
    s_add_u32 s100, s47, 0x0
    buffer_load_dwordx4 v1, s[20:23], s100 offen offset:3072 nt lds
    s_add_u32 m0, s46, 16896
    s_add_u32 s100, s47, 0x4000
    buffer_load_dwordx4 v1, s[20:23], s100 offen offset:0 nt lds
    s_add_u32 m0, s46, 16928
    s_add_u32 s100, s47, 0x4000
    buffer_load_dwordx4 v1, s[20:23], s100 offen offset:1024 nt lds
    s_lshl_b32 s39, s40, 14
    s_add_u32 s39, s39, 0x280000
    s_mov_b32 s36, 0x3eb8aa3b
    s_mov_b32 s37, 0xbd38aa3b
    s_mov_b32 s38, 0xffff0000
    v_lshrrev_b32 v146, 4, v0
    v_and_b32 v145, 1, v0
    v_lshlrev_b32 v147, 9, v145
    v_xor_b32 v145, v145, v146
    v_lshl_add_u32 v147, v145, 4, v147
    v_bfe_u32 v144, v0, 1, 3
    v_mul_u32_u24 v144, 1056, v144
    v_add_u32 v2, v144, v147
    v_lshlrev_b32 v4, 4, v146
    v_add_u32 v4, 0x25200, v4
    v_lshlrev_b32 v5, 4, v0
    v_and_b32 v144, 3, v0
    v_lshlrev_b32 v144, 2, v144
    v_add_u32 v8, 0x25800, v144
    s_cmp_eq_u32 s44, 1
    s_cbranch_scc1 L_w2_61
    s_cmp_lg_u32 s44, 0
    s_cbranch_scc1 L_wdone_62
    v_lshrrev_b32 v146, 3, v0
    s_lshl_b32 s32, s43, 12
    s_lshl_b32 s33, s42, 7
    s_add_u32 s32, s32, s33
    v_lshl_add_u32 v144, v146, 10, s32
    s_lshl_b32 s33, s41, 9
    s_add_u32 s33, s33, 7680
    v_lshl_add_u32 v145, v146, 7, s33
    v_cmp_gt_u32 vcc, 32, v0
    v_and_b32 v146, 7, v0
    s_getreg_b32 s32, hwreg(HW_REG_XCC_ID, 0, 3)
    v_cndmask_b32 v144, v145, v144, vcc
    v_lshl_add_u32 v144, v146, 4, v144
    v_mov_b32 v160, 0
    v_mov_b32 v161, 0
    v_mov_b32 v162, 0
    v_mov_b32 v163, 0
    buffer_store_dwordx4 v[160:163], v144, s[60:63], s39 offen sc1
    s_lshl_b32 s32, s32, 3
    s_lshl_b64 s[18:19], 1, s32
    v_mov_b32 v164, s18
    v_mov_b32 v165, s19
    s_branch L_wdone_62
L_w2_61:
    s_getpc_b64 s[18:19]
L_pc:
    s_sub_u32 s18, s18, L_pc-standalone__linear_kernel_performer__prompt_kernel
    s_subb_u32 s19, s19, 0
    s_mul_i32 s32, s41, 21*128
    v_min_u32 v144, 20, v0
    v_lshl_add_u32 v144, v144, 7, s32
    v_min_u32 v144, L_fastend-standalone__linear_kernel_performer__prompt_kernel-4, v144
    global_load_dword v166, v144, s[18:19]
L_wdone_62:
    v_lshrrev_b32 v147, 3, v0
    v_and_b32 v145, 6, v147
    v_and_b32 v146, 7, v0
    v_xor_b32 v145, v145, v146
    v_lshlrev_b32 v145, 4, v145
    v_lshl_add_u32 v200, v147, 9, v145
    v_add_u32 v201, 0xc00, v200
    v_add_u32 v202, 0x1800, v200
    v_add_u32 v203, 0x2400, v200
    v_lshrrev_b32 v146, 4, v0
    v_and_b32 v145, 15, v0
    v_lshlrev_b32 v145, 3, v145
    v_lshl_add_u32 v10, v146, 11, v145
    v_lshrrev_b32 v144, 4, v0
    v_bfe_u32 v145, v0, 2, 2
    v_lshlrev_b32 v146, 1, v144
    v_mov_b32 v147, 0x9c
    v_lshrrev_b32 v146, v146, v147
    v_and_b32 v146, 3, v146
    v_xor_b32 v146, v146, v145
    v_lshlrev_b32 v147, 1, v145
    v_sub_u32 v146, v146, v147
    v_mul_u32_u24 v147, 1056, v145
    v_bfe_u32 v148, v0, 1, 1
    v_lshl_add_u32 v147, v148, 9, v147
    v_and_b32 v148, 1, v0
    v_lshl_add_u32 v147, v148, 8, v147
    v_add_u32 v147, s46, v147
    v_add_u32 v148, 0, v0
    v_and_b32 v148, 3, v148
    v_lshl_add_u32 v148, v148, 2, v146
    v_and_b32 v148, 15, v148
    v_lshl_add_u32 v248, v148, 4, v147
    v_add_u32 v148, 1, v0
    v_and_b32 v148, 3, v148
    v_lshl_add_u32 v148, v148, 2, v146
    v_and_b32 v148, 15, v148
    v_lshl_add_u32 v249, v148, 4, v147
    v_add_u32 v148, 2, v0
    v_and_b32 v148, 3, v148
    v_lshl_add_u32 v148, v148, 2, v146
    v_and_b32 v148, 15, v148
    v_lshl_add_u32 v250, v148, 4, v147
    v_add_u32 v148, 3, v0
    v_and_b32 v148, 3, v148
    v_lshl_add_u32 v148, v148, 2, v146
    v_and_b32 v148, 15, v148
    v_lshl_add_u32 v251, v148, 4, v147
    v_bfe_u32 v147, v0, 1, 3
    s_lshl_b32 s34, s44, 3
    v_add_u32 v147, s34, v147
    v_lshlrev_b32 v147, 2, v147
    v_add_u32 v147, 0x25200, v147
    v_mov_b32 v148, 0x25900
    v_cmp_eq_u32 vcc, v145, v144
    v_and_b32 v145, 3, v0
    s_mov_b64 s[14:15], vcc
    v_cndmask_b32 v6, v148, v147, vcc
    v_cmp_eq_u32 s[4:5], 1, v145
    v_cmp_eq_u32 s[6:7], 2, v145
    v_cmp_eq_u32 s[8:9], 3, v145
    s_lshl_b32 s32, s44, 3
    s_lshr_b32 s35, 0x6030108, s32
    s_and_b32 s35, s35, 0xff
    s_lshr_b32 s1, 0x5020b08, s32
    s_and_b32 s1, s1, 0xff
    s_mul_i32 s35, s35, 16896
    v_add_u32 v7, s35, v2
    s_lshl_b32 s10, s44, 14
    s_add_u32 s11, s10, 4096
    s_add_u32 s12, s10, 8192
    s_add_u32 s13, s10, 12288
    v_mov_b32 v9, v0
    s_lshl_b32 s33, s44, 2
    s_add_u32 s33, s33, 0x25800
    v_mov_b32 v0, s33
    s_barrier
    s_setprio 3
    s_add_u32 m0, s46, 16960
    s_add_u32 s100, s47, 0x4000
    buffer_load_dwordx4 v1, s[20:23], s100 offen offset:2048 nt lds
    s_add_u32 m0, s46, 16992
    s_add_u32 s100, s47, 0x4000
    buffer_load_dwordx4 v1, s[20:23], s100 offen offset:3072 nt lds
    s_cmp_ge_u32 s44, 2
    s_cbranch_scc1 L_loader
    s_waitcnt vmcnt(4)
    ds_read_b128 v[172:175], v248 offset:0
    ds_read_b128 v[176:179], v249 offset:0
    ds_read_b128 v[180:183], v250 offset:0
    ds_read_b128 v[184:187], v251 offset:0
    s_waitcnt lgkmcnt(0)
    v_mfma_f32_16x16x32_bf16 v[12:15], v[172:175], v[172:175], 0
    v_mfma_f32_16x16x32_bf16 v[12:15], v[176:179], v[176:179], v[12:15]
    v_mfma_f32_16x16x32_bf16 v[12:15], v[180:183], v[180:183], v[12:15]
    v_mfma_f32_16x16x32_bf16 v[12:15], v[184:187], v[184:187], v[12:15]
    s_nop 7
    v_cndmask_b32 v12, v12, v13, s[4:5]
    v_cndmask_b32 v12, v12, v14, s[6:7]
    v_cndmask_b32 v12, v12, v15, s[8:9]
    s_nop 1
    v_add_f32_dpp v12, v12, v12 quad_perm:[1,0,3,2] row_mask:0xf bank_mask:0xf
    v_fma_f32 v12, v12, s37, -4.0
    ds_write_b32 v6, v12 offset:0
    s_waitcnt vmcnt(0)
    ds_read_b128 v[172:175], v248 offset:16896
    ds_read_b128 v[176:179], v249 offset:16896
    ds_read_b128 v[180:183], v250 offset:16896
    ds_read_b128 v[184:187], v251 offset:16896
    s_waitcnt lgkmcnt(0)
    v_mfma_f32_16x16x32_bf16 v[12:15], v[172:175], v[172:175], 0
    v_mfma_f32_16x16x32_bf16 v[12:15], v[176:179], v[176:179], v[12:15]
    v_mfma_f32_16x16x32_bf16 v[12:15], v[180:183], v[180:183], v[12:15]
    v_mfma_f32_16x16x32_bf16 v[12:15], v[184:187], v[184:187], v[12:15]
    s_nop 7
    v_cndmask_b32 v12, v12, v13, s[4:5]
    v_cndmask_b32 v12, v12, v14, s[6:7]
    v_cndmask_b32 v12, v12, v15, s[8:9]
    s_nop 1
    v_add_f32_dpp v12, v12, v12 quad_perm:[1,0,3,2] row_mask:0xf bank_mask:0xf
    v_fma_f32 v12, v12, s37, -4.0
    ds_write_b32 v6, v12 offset:128
    v_mov_b32 v254, 1
    ds_write_b32 v0, v254 offset:48
    s_cmp_lg_u32 s44, 0
    s_cbranch_scc1 L_nojoin_63
    s_lshl_b32 s32, s40, 4
    s_mov_b64 exec, 1
    buffer_atomic_add_x2 v[164:165], off, s[64:67], s32
    s_mov_b64 exec, -1
L_nojoin_63:
    s_setprio 0
    v_mov_b32 v0, v9
    s_cmp_eq_u32 s44, 1
    s_cbranch_scc1 L_w1
L_w1back:
    v_and_b32 v144, 1, v0
    v_lshlrev_b32 v144, 4, v144
    v_mov_b32 v145, 0x3f80
    v_lshlrev_b32 v145, v144, v145
    v_bfe_u32 v144, v0, 1, 3
    v_cmp_eq_u32 vcc, 0, v144
    s_nop 1
    v_cndmask_b32 v208, 0, v145, vcc
    v_cmp_eq_u32 vcc, 1, v144
    s_nop 1
    v_cndmask_b32 v209, 0, v145, vcc
    v_cmp_eq_u32 vcc, 2, v144
    s_nop 1
    v_cndmask_b32 v210, 0, v145, vcc
    v_cmp_eq_u32 vcc, 3, v144
    s_nop 1
    v_cndmask_b32 v211, 0, v145, vcc
    v_cmp_eq_u32 vcc, 4, v144
    s_nop 1
    v_cndmask_b32 v212, 0, v145, vcc
    v_cmp_eq_u32 vcc, 5, v144
    s_nop 1
    v_cndmask_b32 v213, 0, v145, vcc
    v_cmp_eq_u32 vcc, 6, v144
    s_nop 1
    v_cndmask_b32 v214, 0, v145, vcc
    v_cmp_eq_u32 vcc, 7, v144
    s_nop 1
    v_cndmask_b32 v215, 0, v145, vcc
    v_lshrrev_b32 v144, 4, v0
    v_lshlrev_b32 v145, 17, v144
    v_bfe_u32 v146, v0, 3, 1
    v_lshl_add_u32 v145, v146, 9, v145
    v_and_b32 v146, 7, v0
    v_lshl_add_u32 v216, v146, 4, v145
    v_and_b32 v145, 3, v0
    v_lshlrev_b32 v145, 10, v145
    v_lshrrev_b32 v146, 5, v0
    v_lshl_add_u32 v145, v146, 6, v145
    v_bfe_u32 v146, v0, 2, 2
    v_lshl_add_u32 v145, v146, 4, v145
    v_and_b32 v146, 1, v144
    v_lshl_add_u32 v217, v146, 3, v145
    s_lshr_b32 s34, s41, 3
    s_lshl_b32 s19, s34, 16
    s_and_b32 s34, s42, 3
    s_lshl_b32 s34, s34, 14
    s_add_u32 s19, s19, s34
    s_lshl_b32 s34, s43, 11
    s_add_u32 s19, s19, s34
    s_lshl_b32 s18, s40, 17
    s_lshl_b32 s34, s44, 15
    s_add_u32 s18, s18, s34
    s_lshl_b32 s34, s42, 12
    s_add_u32 s18, s18, s34
    s_lshl_b32 s34, s43, 9
    s_add_u32 s18, s18, s34
    v_and_b32 v144, 7, v0
    s_lshl_b32 s34, s42, 10
    v_lshl_add_u32 v218, v144, 7, s34
    v_and_b32 v145, 15, v0
    s_lshl_b32 s34, s44, 7
    s_add_u32 s34, s34, 8192
    v_lshl_add_u32 v219, v145, 9, s34
    s_lshl_b32 s33, s41, 9
    s_add_u32 s101, s34, s33
    s_lshl_b32 s32, s43, 2
    s_add_u32 s32, s32, s44
    s_lshl_b32 s32, s32, 3
    s_add_u32 s32, s32, s42
    s_lshl_b32 s32, s32, 7
    v_lshl_add_u32 v11, v0, 2, s32
    s_sub_u32 s101, s101, s32
    s_add_u32 s101, s101, s39
    s_lshl_b32 s33, s44, 2
    s_add_u32 s33, s33, 0x25800
    v_mov_b32 v0, s33
    s_mov_b32 s34, 1048576
L_lw_64:
    ds_read_b32 v255, v8 offset:16
    s_waitcnt lgkmcnt(0)
    v_cmp_gt_u32 vcc, s1, v255
    s_cbranch_vccz L_lwd_65
    s_sleep 2
    s_sub_u32 s34, s34, 1
    s_cbranch_scc0 L_lw_64
L_lwd_65:
    ds_read_b128 v[16:19], v7 offset:0
    ds_read_b128 v[24:27], v7 offset:64
    ds_read_b128 v[32:35], v7 offset:128
    ds_read_b128 v[40:43], v7 offset:192
    ds_read_b128 v[48:51], v7 offset:256
    ds_read_b128 v[56:59], v7 offset:320
    ds_read_b128 v[64:67], v7 offset:384
    ds_read_b128 v[72:75], v7 offset:448
    ds_read_b128 v[20:23], v7 offset:8448
    ds_read_b128 v[28:31], v7 offset:8512
    ds_read_b128 v[36:39], v7 offset:8576
    ds_read_b128 v[44:47], v7 offset:8640
    ds_read_b128 v[52:55], v7 offset:8704
    ds_read_b128 v[60:63], v7 offset:8768
    ds_read_b128 v[68:71], v7 offset:8832
    ds_read_b128 v[76:79], v7 offset:8896
    v_mov_b32 v254, 1
    ds_write_b32 v0, v254 offset:64
L_qfin:
    s_setprio 0
    s_waitcnt lgkmcnt(0)
    v_mfma_f32_16x16x32_bf16 v[240:243], v[16:19], v[16:19], 0
    v_mfma_f32_16x16x32_bf16 v[244:247], v[20:23], v[20:23], 0
    v_mfma_f32_16x16x32_bf16 v[240:243], v[24:27], v[24:27], v[240:243]
    v_mfma_f32_16x16x32_bf16 v[244:247], v[28:31], v[28:31], v[244:247]
    v_mfma_f32_16x16x32_bf16 v[240:243], v[32:35], v[32:35], v[240:243]
    v_mfma_f32_16x16x32_bf16 v[244:247], v[36:39], v[36:39], v[244:247]
    v_mfma_f32_16x16x32_bf16 v[240:243], v[40:43], v[40:43], v[240:243]
    v_mfma_f32_16x16x32_bf16 v[244:247], v[44:47], v[44:47], v[244:247]
    v_mfma_f32_16x16x32_bf16 v[240:243], v[48:51], v[48:51], v[240:243]
    v_mfma_f32_16x16x32_bf16 v[244:247], v[52:55], v[52:55], v[244:247]
    v_mfma_f32_16x16x32_bf16 v[240:243], v[56:59], v[56:59], v[240:243]
    v_mfma_f32_16x16x32_bf16 v[244:247], v[60:63], v[60:63], v[244:247]
    v_mfma_f32_16x16x32_bf16 v[240:243], v[64:67], v[64:67], v[240:243]
    v_mfma_f32_16x16x32_bf16 v[244:247], v[68:71], v[68:71], v[244:247]
    v_mfma_f32_16x16x32_bf16 v[240:243], v[72:75], v[72:75], v[240:243]
    v_mfma_f32_16x16x32_bf16 v[244:247], v[76:79], v[76:79], v[244:247]
    v_lshlrev_b32 v152, 16, v16
    v_and_b32 v153, s38, v16
    v_mul_f32 v152, s36, v152
    v_mul_f32 v153, s36, v153
    v_cvt_pk_bf16_f32 v16, v152, v153
    v_lshlrev_b32 v154, 16, v17
    v_and_b32 v155, s38, v17
    v_mul_f32 v154, s36, v154
    v_mul_f32 v155, s36, v155
    v_cvt_pk_bf16_f32 v17, v154, v155
    v_lshlrev_b32 v152, 16, v18
    v_and_b32 v153, s38, v18
    v_mul_f32 v152, s36, v152
    v_mul_f32 v153, s36, v153
    v_cvt_pk_bf16_f32 v18, v152, v153
    v_lshlrev_b32 v154, 16, v19
    v_and_b32 v155, s38, v19
    v_mul_f32 v154, s36, v154
    v_mul_f32 v155, s36, v155
    v_cvt_pk_bf16_f32 v19, v154, v155
    v_lshlrev_b32 v152, 16, v20
    v_and_b32 v153, s38, v20
    v_mul_f32 v152, s36, v152
    v_mul_f32 v153, s36, v153
    v_cvt_pk_bf16_f32 v20, v152, v153
    v_lshlrev_b32 v154, 16, v21
    v_and_b32 v155, s38, v21
    v_mul_f32 v154, s36, v154
    v_mul_f32 v155, s36, v155
    v_cvt_pk_bf16_f32 v21, v154, v155
    v_lshlrev_b32 v152, 16, v22
    v_and_b32 v153, s38, v22
    v_mul_f32 v152, s36, v152
    v_mul_f32 v153, s36, v153
    v_cvt_pk_bf16_f32 v22, v152, v153
    v_lshlrev_b32 v154, 16, v23
    v_and_b32 v155, s38, v23
    v_mul_f32 v154, s36, v154
    v_mul_f32 v155, s36, v155
    v_cvt_pk_bf16_f32 v23, v154, v155
    v_lshlrev_b32 v152, 16, v24
    v_and_b32 v153, s38, v24
    v_mul_f32 v152, s36, v152
    v_mul_f32 v153, s36, v153
    v_cvt_pk_bf16_f32 v24, v152, v153
    v_lshlrev_b32 v154, 16, v25
    v_and_b32 v155, s38, v25
    v_mul_f32 v154, s36, v154
    v_mul_f32 v155, s36, v155
    v_cvt_pk_bf16_f32 v25, v154, v155
    v_lshlrev_b32 v152, 16, v26
    v_and_b32 v153, s38, v26
    v_mul_f32 v152, s36, v152
    v_mul_f32 v153, s36, v153
    v_cvt_pk_bf16_f32 v26, v152, v153
    v_lshlrev_b32 v154, 16, v27
    v_and_b32 v155, s38, v27
    v_mul_f32 v154, s36, v154
    v_mul_f32 v155, s36, v155
    v_cvt_pk_bf16_f32 v27, v154, v155
    v_lshlrev_b32 v152, 16, v28
    v_and_b32 v153, s38, v28
    v_mul_f32 v152, s36, v152
    v_mul_f32 v153, s36, v153
    v_cvt_pk_bf16_f32 v28, v152, v153
    v_lshlrev_b32 v154, 16, v29
    v_and_b32 v155, s38, v29
    v_mul_f32 v154, s36, v154
    v_mul_f32 v155, s36, v155
    v_cvt_pk_bf16_f32 v29, v154, v155
    v_lshlrev_b32 v152, 16, v30
    v_and_b32 v153, s38, v30
    v_mul_f32 v152, s36, v152
    v_mul_f32 v153, s36, v153
    v_cvt_pk_bf16_f32 v30, v152, v153
    v_lshlrev_b32 v154, 16, v31
    v_and_b32 v155, s38, v31
    v_mul_f32 v154, s36, v154
    v_mul_f32 v155, s36, v155
    v_cvt_pk_bf16_f32 v31, v154, v155
    v_lshlrev_b32 v152, 16, v32
    v_and_b32 v153, s38, v32
    v_mul_f32 v152, s36, v152
    v_mul_f32 v153, s36, v153
    v_cvt_pk_bf16_f32 v32, v152, v153
    v_lshlrev_b32 v154, 16, v33
    v_and_b32 v155, s38, v33
    v_mul_f32 v154, s36, v154
    v_mul_f32 v155, s36, v155
    v_cvt_pk_bf16_f32 v33, v154, v155
    v_lshlrev_b32 v152, 16, v34
    v_and_b32 v153, s38, v34
    v_mul_f32 v152, s36, v152
    v_mul_f32 v153, s36, v153
    v_cvt_pk_bf16_f32 v34, v152, v153
    v_lshlrev_b32 v154, 16, v35
    v_and_b32 v155, s38, v35
    v_mul_f32 v154, s36, v154
    v_mul_f32 v155, s36, v155
    v_cvt_pk_bf16_f32 v35, v154, v155
    v_lshlrev_b32 v152, 16, v36
    v_and_b32 v153, s38, v36
    v_mul_f32 v152, s36, v152
    v_mul_f32 v153, s36, v153
    v_cvt_pk_bf16_f32 v36, v152, v153
    v_lshlrev_b32 v154, 16, v37
    v_and_b32 v155, s38, v37
    v_mul_f32 v154, s36, v154
    v_mul_f32 v155, s36, v155
    v_cvt_pk_bf16_f32 v37, v154, v155
    v_lshlrev_b32 v152, 16, v38
    v_and_b32 v153, s38, v38
    v_mul_f32 v152, s36, v152
    v_mul_f32 v153, s36, v153
    v_cvt_pk_bf16_f32 v38, v152, v153
    v_lshlrev_b32 v154, 16, v39
    v_and_b32 v155, s38, v39
    v_mul_f32 v154, s36, v154
    v_mul_f32 v155, s36, v155
    v_cvt_pk_bf16_f32 v39, v154, v155
    v_lshlrev_b32 v152, 16, v40
    v_and_b32 v153, s38, v40
    v_mul_f32 v152, s36, v152
    v_mul_f32 v153, s36, v153
    v_cvt_pk_bf16_f32 v40, v152, v153
    v_lshlrev_b32 v154, 16, v41
    v_and_b32 v155, s38, v41
    v_mul_f32 v154, s36, v154
    v_mul_f32 v155, s36, v155
    v_cvt_pk_bf16_f32 v41, v154, v155
    v_lshlrev_b32 v152, 16, v42
    v_and_b32 v153, s38, v42
    v_mul_f32 v152, s36, v152
    v_mul_f32 v153, s36, v153
    v_cvt_pk_bf16_f32 v42, v152, v153
    v_lshlrev_b32 v154, 16, v43
    v_and_b32 v155, s38, v43
    v_mul_f32 v154, s36, v154
    v_mul_f32 v155, s36, v155
    v_cvt_pk_bf16_f32 v43, v154, v155
    v_lshlrev_b32 v152, 16, v44
    v_and_b32 v153, s38, v44
    v_mul_f32 v152, s36, v152
    v_mul_f32 v153, s36, v153
    v_cvt_pk_bf16_f32 v44, v152, v153
    v_lshlrev_b32 v154, 16, v45
    v_and_b32 v155, s38, v45
    v_mul_f32 v154, s36, v154
    v_mul_f32 v155, s36, v155
    v_cvt_pk_bf16_f32 v45, v154, v155
    v_lshlrev_b32 v152, 16, v46
    v_and_b32 v153, s38, v46
    v_mul_f32 v152, s36, v152
    v_mul_f32 v153, s36, v153
    v_cvt_pk_bf16_f32 v46, v152, v153
    v_lshlrev_b32 v154, 16, v47
    v_and_b32 v155, s38, v47
    v_mul_f32 v154, s36, v154
    v_mul_f32 v155, s36, v155
    v_cvt_pk_bf16_f32 v47, v154, v155
    v_lshlrev_b32 v152, 16, v48
    v_and_b32 v153, s38, v48
    v_mul_f32 v152, s36, v152
    v_mul_f32 v153, s36, v153
    v_cvt_pk_bf16_f32 v48, v152, v153
    v_lshlrev_b32 v154, 16, v49
    v_and_b32 v155, s38, v49
    v_mul_f32 v154, s36, v154
    v_mul_f32 v155, s36, v155
    v_cvt_pk_bf16_f32 v49, v154, v155
    v_lshlrev_b32 v152, 16, v50
    v_and_b32 v153, s38, v50
    v_mul_f32 v152, s36, v152
    v_mul_f32 v153, s36, v153
    v_cvt_pk_bf16_f32 v50, v152, v153
    v_lshlrev_b32 v154, 16, v51
    v_and_b32 v155, s38, v51
    v_mul_f32 v154, s36, v154
    v_mul_f32 v155, s36, v155
    v_cvt_pk_bf16_f32 v51, v154, v155
    v_lshlrev_b32 v152, 16, v52
    v_and_b32 v153, s38, v52
    v_mul_f32 v152, s36, v152
    v_mul_f32 v153, s36, v153
    v_cvt_pk_bf16_f32 v52, v152, v153
    v_lshlrev_b32 v154, 16, v53
    v_and_b32 v155, s38, v53
    v_mul_f32 v154, s36, v154
    v_mul_f32 v155, s36, v155
    v_cvt_pk_bf16_f32 v53, v154, v155
    v_lshlrev_b32 v152, 16, v54
    v_and_b32 v153, s38, v54
    v_mul_f32 v152, s36, v152
    v_mul_f32 v153, s36, v153
    v_cvt_pk_bf16_f32 v54, v152, v153
    v_lshlrev_b32 v154, 16, v55
    v_and_b32 v155, s38, v55
    v_mul_f32 v154, s36, v154
    v_mul_f32 v155, s36, v155
    v_cvt_pk_bf16_f32 v55, v154, v155
    v_lshlrev_b32 v152, 16, v56
    v_and_b32 v153, s38, v56
    v_mul_f32 v152, s36, v152
    v_mul_f32 v153, s36, v153
    v_cvt_pk_bf16_f32 v56, v152, v153
    v_lshlrev_b32 v154, 16, v57
    v_and_b32 v155, s38, v57
    v_mul_f32 v154, s36, v154
    v_mul_f32 v155, s36, v155
    v_cvt_pk_bf16_f32 v57, v154, v155
    v_lshlrev_b32 v152, 16, v58
    v_and_b32 v153, s38, v58
    v_mul_f32 v152, s36, v152
    v_mul_f32 v153, s36, v153
    v_cvt_pk_bf16_f32 v58, v152, v153
    v_lshlrev_b32 v154, 16, v59
    v_and_b32 v155, s38, v59
    v_mul_f32 v154, s36, v154
    v_mul_f32 v155, s36, v155
    v_cvt_pk_bf16_f32 v59, v154, v155
    v_lshlrev_b32 v152, 16, v60
    v_and_b32 v153, s38, v60
    v_mul_f32 v152, s36, v152
    v_mul_f32 v153, s36, v153
    v_cvt_pk_bf16_f32 v60, v152, v153
    v_lshlrev_b32 v154, 16, v61
    v_and_b32 v155, s38, v61
    v_mul_f32 v154, s36, v154
    v_mul_f32 v155, s36, v155
    v_cvt_pk_bf16_f32 v61, v154, v155
    v_lshlrev_b32 v152, 16, v62
    v_and_b32 v153, s38, v62
    v_mul_f32 v152, s36, v152
    v_mul_f32 v153, s36, v153
    v_cvt_pk_bf16_f32 v62, v152, v153
    v_lshlrev_b32 v154, 16, v63
    v_and_b32 v155, s38, v63
    v_mul_f32 v154, s36, v154
    v_mul_f32 v155, s36, v155
    v_cvt_pk_bf16_f32 v63, v154, v155
    v_lshlrev_b32 v152, 16, v64
    v_and_b32 v153, s38, v64
    v_mul_f32 v152, s36, v152
    v_mul_f32 v153, s36, v153
    v_cvt_pk_bf16_f32 v64, v152, v153
    v_lshlrev_b32 v154, 16, v65
    v_and_b32 v155, s38, v65
    v_mul_f32 v154, s36, v154
    v_mul_f32 v155, s36, v155
    v_cvt_pk_bf16_f32 v65, v154, v155
    v_lshlrev_b32 v152, 16, v66
    v_and_b32 v153, s38, v66
    v_mul_f32 v152, s36, v152
    v_mul_f32 v153, s36, v153
    v_cvt_pk_bf16_f32 v66, v152, v153
    v_lshlrev_b32 v154, 16, v67
    v_and_b32 v155, s38, v67
    v_mul_f32 v154, s36, v154
    v_mul_f32 v155, s36, v155
    v_cvt_pk_bf16_f32 v67, v154, v155
    v_lshlrev_b32 v152, 16, v68
    v_and_b32 v153, s38, v68
    v_mul_f32 v152, s36, v152
    v_mul_f32 v153, s36, v153
    v_cvt_pk_bf16_f32 v68, v152, v153
    v_lshlrev_b32 v154, 16, v69
    v_and_b32 v155, s38, v69
    v_mul_f32 v154, s36, v154
    v_mul_f32 v155, s36, v155
    v_cvt_pk_bf16_f32 v69, v154, v155
    v_lshlrev_b32 v152, 16, v70
    v_and_b32 v153, s38, v70
    v_mul_f32 v152, s36, v152
    v_mul_f32 v153, s36, v153
    v_cvt_pk_bf16_f32 v70, v152, v153
    v_lshlrev_b32 v154, 16, v71
    v_and_b32 v155, s38, v71
    v_mul_f32 v154, s36, v154
    v_mul_f32 v155, s36, v155
    v_cvt_pk_bf16_f32 v71, v154, v155
    v_lshlrev_b32 v152, 16, v72
    v_and_b32 v153, s38, v72
    v_mul_f32 v152, s36, v152
    v_mul_f32 v153, s36, v153
    v_cvt_pk_bf16_f32 v72, v152, v153
    v_lshlrev_b32 v154, 16, v73
    v_and_b32 v155, s38, v73
    v_mul_f32 v154, s36, v154
    v_mul_f32 v155, s36, v155
    v_cvt_pk_bf16_f32 v73, v154, v155
    v_lshlrev_b32 v152, 16, v74
    v_and_b32 v153, s38, v74
    v_mul_f32 v152, s36, v152
    v_mul_f32 v153, s36, v153
    v_cvt_pk_bf16_f32 v74, v152, v153
    v_lshlrev_b32 v154, 16, v75
    v_and_b32 v155, s38, v75
    v_mul_f32 v154, s36, v154
    v_mul_f32 v155, s36, v155
    v_cvt_pk_bf16_f32 v75, v154, v155
    v_lshlrev_b32 v152, 16, v76
    v_and_b32 v153, s38, v76
    v_mul_f32 v152, s36, v152
    v_mul_f32 v153, s36, v153
    v_cvt_pk_bf16_f32 v76, v152, v153
    v_lshlrev_b32 v154, 16, v77
    v_and_b32 v155, s38, v77
    v_mul_f32 v154, s36, v154
    v_mul_f32 v155, s36, v155
    v_cvt_pk_bf16_f32 v77, v154, v155
    v_lshlrev_b32 v152, 16, v78
    v_and_b32 v153, s38, v78
    v_mul_f32 v152, s36, v152
    v_mul_f32 v153, s36, v153
    v_cvt_pk_bf16_f32 v78, v152, v153
    v_lshlrev_b32 v154, 16, v79
    v_and_b32 v155, s38, v79
    v_mul_f32 v154, s36, v154
    v_mul_f32 v155, s36, v155
    v_cvt_pk_bf16_f32 v79, v154, v155
    v_cndmask_b32 v240, v240, v241, s[4:5]
    v_cndmask_b32 v240, v240, v242, s[6:7]
    v_cndmask_b32 v240, v240, v243, s[8:9]
    v_cndmask_b32 v240, 0, v240, s[14:15]
    v_mov_b32 v241, v240
    s_nop 1
    v_permlane16_swap_b32 v240, v241
    v_add_f32 v240, v240, v241
    v_mov_b32 v241, v240
    s_nop 1
    v_permlane32_swap_b32 v240, v241
    v_add_f32 v240, v240, v241
    v_fma_f32 v240, v240, s37, -4.0
    v_mov_b32 v241, v240
    v_mov_b32 v242, v240
    v_mov_b32 v243, v240
    v_cndmask_b32 v244, v244, v245, s[4:5]
    v_cndmask_b32 v244, v244, v246, s[6:7]
    v_cndmask_b32 v244, v244, v247, s[8:9]
    v_cndmask_b32 v244, 0, v244, s[14:15]
    v_mov_b32 v245, v244
    s_nop 1
    v_permlane16_swap_b32 v244, v245
    v_add_f32 v244, v244, v245
    v_mov_b32 v245, v244
    s_nop 1
    v_permlane32_swap_b32 v244, v245
    v_add_f32 v244, v244, v245
    v_fma_f32 v244, v244, s37, -4.0
    v_mov_b32 v245, v244
    v_mov_b32 v246, v244
    v_mov_b32 v247, v244
    s_setprio 3
    s_cmp_ge_u32 s44, 2
    s_cbranch_scc1 L_q
    s_mov_b32 s34, 1048576
L_lw_66:
    ds_read_b32 v255, v0 offset:80
    s_waitcnt lgkmcnt(0)
    v_cmp_gt_u32 vcc, 1, v255
    s_cbranch_vccz L_lwd_67
    s_sleep 1
    s_sub_u32 s34, s34, 1
    s_cbranch_scc0 L_lw_66
L_lwd_67:
    v_readfirstlane_b32 s45, v255
    s_or_b32 s33, s44, 2
    s_cmp_eq_u32 s45, 2
    s_cselect_b32 s33, s33, s44
    s_lshl_b32 s33, s33, 7
    s_add_u32 s19, s19, s33
    s_cmp_eq_u32 s44, 0
    s_cselect_b32 s32, 13, 15
    s_mov_b32 s34, 1048576
L_lw_68:
    ds_read_b32 v255, v0 offset:0
    s_waitcnt lgkmcnt(0)
    v_cmp_gt_u32 vcc, s32, v255
    s_cbranch_vccz L_lwd_69
    s_sleep 2
    s_sub_u32 s34, s34, 1
    s_cbranch_scc0 L_lw_68
L_lwd_69:
    s_add_u32 s32, s44, 1
    s_mov_b32 s34, 262144
L_poll_70:
    buffer_load_dword v255, v218, s[60:63], s39 offen sc1
    s_waitcnt vmcnt(0)
    v_cmp_gt_u32 vcc, s32, v255
    s_cbranch_vccz L_polled_71
    s_sleep 1
    s_sub_u32 s34, s34, 1
    s_cbranch_scc0 L_poll_70
L_polled_71:
    s_add_u32 s33, s19, 0x0
    buffer_load_dwordx4 v[80:83], v216, s[56:59], s33 offen offset:0 sc1
    buffer_load_dwordx4 v[84:87], v216, s[56:59], s33 offen offset:1024 sc1
    s_add_u32 s33, s19, 0x80000
    buffer_load_dwordx4 v[88:91], v216, s[56:59], s33 offen offset:0 sc1
    buffer_load_dwordx4 v[92:95], v216, s[56:59], s33 offen offset:1024 sc1
    s_add_u32 s33, s19, 0x1000
    buffer_load_dwordx4 v[96:99], v216, s[56:59], s33 offen offset:0 sc1
    buffer_load_dwordx4 v[100:103], v216, s[56:59], s33 offen offset:1024 sc1
    s_add_u32 s33, s19, 0x81000
    buffer_load_dwordx4 v[104:107], v216, s[56:59], s33 offen offset:0 sc1
    buffer_load_dwordx4 v[108:111], v216, s[56:59], s33 offen offset:1024 sc1
    s_add_u32 s33, s19, 0x2000
    buffer_load_dwordx4 v[112:115], v216, s[56:59], s33 offen offset:0 sc1
    buffer_load_dwordx4 v[116:119], v216, s[56:59], s33 offen offset:1024 sc1
    s_add_u32 s33, s19, 0x82000
    buffer_load_dwordx4 v[120:123], v216, s[56:59], s33 offen offset:0 sc1
    buffer_load_dwordx4 v[124:127], v216, s[56:59], s33 offen offset:1024 sc1
    s_add_u32 s33, s19, 0x3000
    buffer_load_dwordx4 v[128:131], v216, s[56:59], s33 offen offset:0 sc1
    buffer_load_dwordx4 v[132:135], v216, s[56:59], s33 offen offset:1024 sc1
    s_add_u32 s33, s19, 0x83000
    buffer_load_dwordx4 v[136:139], v216, s[56:59], s33 offen offset:0 sc1
    buffer_load_dwordx4 v[140:143], v216, s[56:59], s33 offen offset:1024 sc1
    s_waitcnt vmcnt(8)
    v_mfma_f32_16x16x32_bf16 v[220:223], v[208:211], v[80:83], 0
    v_mfma_f32_16x16x32_bf16 v[224:227], v[208:211], v[84:87], 0
    v_mfma_f32_16x16x32_bf16 v[220:223], v[208:211], v[88:91], v[220:223]
    v_mfma_f32_16x16x32_bf16 v[224:227], v[208:211], v[92:95], v[224:227]
    v_mfma_f32_16x16x32_bf16 v[220:223], v[212:215], v[96:99], v[220:223]
    v_mfma_f32_16x16x32_bf16 v[224:227], v[212:215], v[100:103], v[224:227]
    v_mfma_f32_16x16x32_bf16 v[220:223], v[212:215], v[104:107], v[220:223]
    v_mfma_f32_16x16x32_bf16 v[224:227], v[212:215], v[108:111], v[224:227]
    s_waitcnt vmcnt(0)
    v_mfma_f32_16x16x32_bf16 v[228:231], v[208:211], v[112:115], 0
    v_mfma_f32_16x16x32_bf16 v[232:235], v[208:211], v[116:119], 0
    v_mfma_f32_16x16x32_bf16 v[228:231], v[208:211], v[120:123], v[228:231]
    v_mfma_f32_16x16x32_bf16 v[232:235], v[208:211], v[124:127], v[232:235]
    v_mfma_f32_16x16x32_bf16 v[228:231], v[212:215], v[128:131], v[228:231]
    v_mfma_f32_16x16x32_bf16 v[232:235], v[212:215], v[132:135], v[232:235]
    v_mfma_f32_16x16x32_bf16 v[228:231], v[212:215], v[136:139], v[228:231]
    v_mfma_f32_16x16x32_bf16 v[232:235], v[212:215], v[140:143], v[232:235]
    s_nop 7
    v_cvt_pk_bf16_f32 v220, v220, v221
    v_cvt_pk_bf16_f32 v221, v222, v223
    v_cvt_pk_bf16_f32 v224, v224, v225
    v_cvt_pk_bf16_f32 v225, v226, v227
    v_cvt_pk_bf16_f32 v228, v228, v229
    v_cvt_pk_bf16_f32 v229, v230, v231
    v_cvt_pk_bf16_f32 v232, v232, v233
    v_cvt_pk_bf16_f32 v233, v234, v235
    s_cmp_eq_u32 s45, 2
    s_cbranch_scc0 L_wt_72
    buffer_store_dwordx2 v[220:221], v217, s[60:63], s18 offen offset:0
    buffer_store_dwordx2 v[224:225], v217, s[60:63], s18 offen offset:256
    buffer_store_dwordx2 v[228:229], v217, s[60:63], s18 offen offset:128
    buffer_store_dwordx2 v[232:233], v217, s[60:63], s18 offen offset:384
    s_branch L_wtd_73
L_wt_72:
    buffer_store_dwordx2 v[220:221], v217, s[60:63], s18 offen offset:0 sc1
    buffer_store_dwordx2 v[224:225], v217, s[60:63], s18 offen offset:256 sc1
    buffer_store_dwordx2 v[228:229], v217, s[60:63], s18 offen offset:128 sc1
    buffer_store_dwordx2 v[232:233], v217, s[60:63], s18 offen offset:384 sc1
L_wtd_73:
    v_mov_b32 v6, 1
    s_waitcnt vmcnt(0)
    s_mov_b32 exec_hi, 0
    s_cmp_eq_u32 s45, 2
    s_cbranch_scc0 L_wt_74
    buffer_store_dword v6, v11, s[60:63], s101 offen
    s_branch L_wtd_75
L_wt_74:
    buffer_store_dword v6, v11, s[60:63], s101 offen sc1
L_wtd_75:
    s_mov_b64 exec, -1
    s_branch L_q
L_w1:
    s_mov_b32 s34, 1048576
L_lw_76:
    ds_read_b32 v255, v8 offset:0
    s_waitcnt lgkmcnt(0)
    v_cmp_gt_u32 vcc, 4, v255
    s_cbranch_vccz L_lwd_77
    s_sleep 2
    s_sub_u32 s34, s34, 1
    s_cbranch_scc0 L_lw_76
L_lwd_77:
    s_mov_b32 s34, 262144
    s_lshl_b32 s33, s40, 4
L_gate_78:
    buffer_load_dwordx2 v[166:167], off, s[64:67], s33 sc1
    s_waitcnt vmcnt(0)
    v_readfirstlane_b32 s18, v166
    v_readfirstlane_b32 s19, v167
    s_nop 1
    s_add_u32 s32, s18, s19
    s_mul_i32 s32, s32, 0x01010101
    s_lshr_b32 s45, s32, 24
    s_sub_u32 s32, s45, 1
    s_and_b32 s32, s32, 0x8000000f
    s_cmp_eq_u32 s32, 15
    s_cbranch_scc1 L_gated_79
    s_sleep 4
    s_sub_u32 s34, s34, 1
    s_cbranch_scc0 L_gate_78
L_gated_79:
    s_getreg_b32 s32, hwreg(HW_REG_XCC_ID, 0, 3)
    s_lshl_b32 s32, s32, 3
    s_lshr_b64 s[18:19], s[18:19], s32
    s_and_b32 s32, s18, 0xff
    s_cmp_eq_u32 s32, s45
    s_cselect_b32 s32, 2, 1
    v_mov_b32 v254, s32
    ds_write_b32 v8, v254 offset:80
    v_lshrrev_b32 v145, 4, v9
    v_lshlrev_b32 v145, 15, v145
    v_bfe_u32 v146, v9, 2, 2
    v_lshl_add_u32 v145, v146, 10, v145
    v_and_b32 v146, 3, v9
    v_lshl_add_u32 v145, v146, 7, v145
    s_lshl_b32 s33, s40, 17
    s_lshl_b32 s32, s42, 12
    s_add_u32 s33, s33, s32
    s_lshl_b32 s32, s43, 9
    s_add_u32 s33, s33, s32
    buffer_load_dword v164, v145, s[60:63], s33 offen
    s_branch L_w1back
L_q:
    s_mov_b32 s34, 1048576
L_lw_80:
    ds_read_b32 v255, v0 offset:80
    s_waitcnt lgkmcnt(0)
    v_cmp_gt_u32 vcc, 1, v255
    s_cbranch_vccz L_lwd_81
    s_sleep 1
    s_sub_u32 s34, s34, 1
    s_cbranch_scc0 L_lw_80
L_lwd_81:
    v_readfirstlane_b32 s45, v255
    s_mov_b32 s34, 1048576
L_lw_82:
    ds_read_b32 v255, v8 offset:16
    s_waitcnt lgkmcnt(0)
    v_cmp_gt_u32 vcc, 20, v255
    s_cbranch_vccz L_lwd_83
    s_sleep 2
    s_sub_u32 s34, s34, 1
    s_cbranch_scc0 L_lw_82
L_lwd_83:
    s_setprio 0
    v_add_u32 v252, 0x18c00, v2
    ds_read_b128 v[208:211], v252 offset:0
    ds_read_b128 v[212:215], v252 offset:8448
    ds_read_b128 v[216:219], v252 offset:64
    ds_read_b128 v[220:223], v252 offset:8512
    ds_read_b128 v[224:227], v252 offset:128
    ds_read_b128 v[228:231], v252 offset:8576
    ds_read_b128 v[232:235], v252 offset:192
    s_waitcnt lgkmcnt(3)
    v_mfma_f32_16x16x32_bf16 v[144:147], v[208:211], v[16:19], v[240:243]
    v_mfma_f32_16x16x32_bf16 v[152:155], v[208:211], v[20:23], v[244:247]
    ds_read_b128 v[236:239], v252 offset:8640
    v_mfma_f32_16x16x32_bf16 v[148:151], v[212:215], v[16:19], v[240:243]
    v_mfma_f32_16x16x32_bf16 v[156:159], v[212:215], v[20:23], v[244:247]
    ds_read_b128 v[208:211], v252 offset:256
    v_mfma_f32_16x16x32_bf16 v[144:147], v[216:219], v[24:27], v[144:147]
    v_mfma_f32_16x16x32_bf16 v[152:155], v[216:219], v[28:31], v[152:155]
    ds_read_b128 v[212:215], v252 offset:8704
    v_mfma_f32_16x16x32_bf16 v[148:151], v[220:223], v[24:27], v[148:151]
    v_mfma_f32_16x16x32_bf16 v[156:159], v[220:223], v[28:31], v[156:159]
    ds_read_b128 v[216:219], v252 offset:320
    s_waitcnt lgkmcnt(3)
    v_mfma_f32_16x16x32_bf16 v[144:147], v[224:227], v[32:35], v[144:147]
    v_mfma_f32_16x16x32_bf16 v[152:155], v[224:227], v[36:39], v[152:155]
    ds_read_b128 v[220:223], v252 offset:8768
    v_mfma_f32_16x16x32_bf16 v[148:151], v[228:231], v[32:35], v[148:151]
    v_mfma_f32_16x16x32_bf16 v[156:159], v[228:231], v[36:39], v[156:159]
    ds_read_b128 v[224:227], v252 offset:384
    v_mfma_f32_16x16x32_bf16 v[144:147], v[232:235], v[40:43], v[144:147]
    v_mfma_f32_16x16x32_bf16 v[152:155], v[232:235], v[44:47], v[152:155]
    ds_read_b128 v[228:231], v252 offset:8832
    v_mfma_f32_16x16x32_bf16 v[148:151], v[236:239], v[40:43], v[148:151]
    v_mfma_f32_16x16x32_bf16 v[156:159], v[236:239], v[44:47], v[156:159]
    ds_read_b128 v[232:235], v252 offset:448
    s_waitcnt lgkmcnt(3)
    v_mfma_f32_16x16x32_bf16 v[144:147], v[208:211], v[48:51], v[144:147]
    v_mfma_f32_16x16x32_bf16 v[152:155], v[208:211], v[52:55], v[152:155]
    ds_read_b128 v[236:239], v252 offset:8896
    v_mfma_f32_16x16x32_bf16 v[148:151], v[212:215], v[48:51], v[148:151]
    v_mfma_f32_16x16x32_bf16 v[156:159], v[212:215], v[52:55], v[156:159]
    ds_read_b128 v[208:211], v2 offset:0
    v_mfma_f32_16x16x32_bf16 v[144:147], v[216:219], v[56:59], v[144:147]
    v_mov_b32 v254, 18
    v_mfma_f32_16x16x32_bf16 v[152:155], v[216:219], v[60:63], v[152:155]
    ds_read_b128 v[212:215], v2 offset:8448
    ds_write_b32 v0, v254 offset:32
    v_mfma_f32_16x16x32_bf16 v[148:151], v[220:223], v[56:59], v[148:151]
    v_mfma_f32_16x16x32_bf16 v[156:159], v[220:223], v[60:63], v[156:159]
    ds_read_b128 v[216:219], v2 offset:64
    s_waitcnt lgkmcnt(4)
    v_mfma_f32_16x16x32_bf16 v[144:147], v[224:227], v[64:67], v[144:147]
    v_mfma_f32_16x16x32_bf16 v[152:155], v[224:227], v[68:71], v[152:155]
    ds_read_b128 v[220:223], v2 offset:8512
    v_mfma_f32_16x16x32_bf16 v[148:151], v[228:231], v[64:67], v[148:151]
    v_mfma_f32_16x16x32_bf16 v[156:159], v[228:231], v[68:71], v[156:159]
    ds_read_b128 v[224:227], v2 offset:128
    v_mfma_f32_16x16x32_bf16 v[144:147], v[232:235], v[72:75], v[144:147]
    v_mfma_f32_16x16x32_bf16 v[152:155], v[232:235], v[76:79], v[152:155]
    ds_read_b128 v[228:231], v2 offset:8576
    v_mfma_f32_16x16x32_bf16 v[148:151], v[236:239], v[72:75], v[148:151]
    v_mfma_f32_16x16x32_bf16 v[156:159], v[236:239], v[76:79], v[156:159]
    ds_read_b128 v[232:235], v2 offset:192
    s_waitcnt lgkmcnt(3)
    v_mfma_f32_16x16x32_bf16 v[176:179], v[208:211], v[16:19], v[240:243]
    v_mfma_f32_16x16x32_bf16 v[184:187], v[208:211], v[20:23], v[244:247]
    ds_read_b128 v[236:239], v2 offset:8640
    v_mfma_f32_16x16x32_bf16 v[180:183], v[212:215], v[16:19], v[240:243]
    v_exp_f32 v144, v144
    v_mfma_f32_16x16x32_bf16 v[188:191], v[212:215], v[20:23], v[244:247]
    ds_read_b128 v[208:211], v2 offset:256
    v_exp_f32 v145, v145
    v_mfma_f32_16x16x32_bf16 v[176:179], v[216:219], v[24:27], v[176:179]
    v_exp_f32 v146, v146
    v_mfma_f32_16x16x32_bf16 v[184:187], v[216:219], v[28:31], v[184:187]
    ds_read_b128 v[212:215], v2 offset:8704
    ds_read_b32 v255, v8 offset:16
    v_mfma_f32_16x16x32_bf16 v[180:183], v[220:223], v[24:27], v[180:183]
    v_exp_f32 v147, v147
    v_mfma_f32_16x16x32_bf16 v[188:191], v[220:223], v[28:31], v[188:191]
    ds_read_b128 v[216:219], v2 offset:320
    s_waitcnt lgkmcnt(4)
    v_mfma_f32_16x16x32_bf16 v[176:179], v[224:227], v[32:35], v[176:179]
    v_exp_f32 v148, v148
    v_mfma_f32_16x16x32_bf16 v[184:187], v[224:227], v[36:39], v[184:187]
    ds_read_b128 v[220:223], v2 offset:8768
    v_cvt_pk_bf16_f32 v80, v144, v145
    v_mfma_f32_16x16x32_bf16 v[180:183], v[228:231], v[32:35], v[180:183]
    v_exp_f32 v149, v149
    v_mfma_f32_16x16x32_bf16 v[188:191], v[228:231], v[36:39], v[188:191]
    ds_read_b128 v[224:227], v2 offset:384
    v_cvt_pk_bf16_f32 v81, v146, v147
    v_cvt_pk_bf16_f32 v82, v148, v149
    v_mfma_f32_16x16x32_bf16 v[176:179], v[232:235], v[40:43], v[176:179]
    v_exp_f32 v150, v150
    v_mfma_f32_16x16x32_bf16 v[184:187], v[232:235], v[44:47], v[184:187]
    ds_read_b128 v[228:231], v2 offset:8832
    v_exp_f32 v151, v151
    v_mfma_f32_16x16x32_bf16 v[180:183], v[236:239], v[40:43], v[180:183]
    v_exp_f32 v152, v152
    v_mfma_f32_16x16x32_bf16 v[188:191], v[236:239], v[44:47], v[188:191]
    ds_read_b128 v[232:235], v2 offset:448
    s_waitcnt lgkmcnt(3)
    v_mfma_f32_16x16x32_bf16 v[176:179], v[208:211], v[48:51], v[176:179]
    v_cmp_gt_u32 vcc, 22, v255
    v_cvt_pk_bf16_f32 v83, v150, v151
    v_mfma_f32_16x16x32_bf16 v[184:187], v[208:211], v[52:55], v[184:187]
    ds_read_b128 v[236:239], v2 offset:8896
    s_cbranch_vccnz L_spin_84
L_go_85:
    v_mfma_f32_16x16x32_bf16 v[180:183], v[212:215], v[48:51], v[180:183]
    v_exp_f32 v153, v153
    v_mfma_f32_16x16x32_bf16 v[188:191], v[212:215], v[52:55], v[188:191]
    ds_read_b128 v[208:211], v252 offset:33792
    v_cvt_pk_bf16_f32 v84, v152, v153
    v_mfma_f32_16x16x32_bf16 v[176:179], v[216:219], v[56:59], v[176:179]
    v_exp_f32 v154, v154
    v_mfma_f32_16x16x32_bf16 v[184:187], v[216:219], v[60:63], v[184:187]
    ds_read_b128 v[212:215], v252 offset:42240
    v_exp_f32 v155, v155
    v_mfma_f32_16x16x32_bf16 v[180:183], v[220:223], v[56:59], v[180:183]
    v_exp_f32 v156, v156
    v_mfma_f32_16x16x32_bf16 v[188:191], v[220:223], v[60:63], v[188:191]
    ds_read_b128 v[216:219], v252 offset:33856
    s_waitcnt lgkmcnt(3)
    v_mfma_f32_16x16x32_bf16 v[176:179], v[224:227], v[64:67], v[176:179]
    v_exp_f32 v157, v157
    v_mfma_f32_16x16x32_bf16 v[184:187], v[224:227], v[68:71], v[184:187]
    ds_read_b128 v[220:223], v252 offset:42304
    v_cvt_pk_bf16_f32 v85, v154, v155
    v_cvt_pk_bf16_f32 v86, v156, v157
    v_mfma_f32_16x16x32_bf16 v[180:183], v[228:231], v[64:67], v[180:183]
    v_exp_f32 v158, v158
    v_mfma_f32_16x16x32_bf16 v[188:191], v[228:231], v[68:71], v[188:191]
    ds_read_b128 v[224:227], v252 offset:33920
    v_mfma_f32_16x16x32_bf16 v[176:179], v[232:235], v[72:75], v[176:179]
    v_exp_f32 v159, v159
    v_mfma_f32_16x16x32_bf16 v[184:187], v[232:235], v[76:79], v[184:187]
    ds_read_b128 v[228:231], v252 offset:42368
    v_cvt_pk_bf16_f32 v87, v158, v159
    v_mfma_f32_16x16x32_bf16 v[180:183], v[236:239], v[72:75], v[180:183]
    v_mfma_f32_16x16x32_bf16 v[188:191], v[236:239], v[76:79], v[188:191]
    ds_read_b128 v[232:235], v252 offset:33984
    s_waitcnt lgkmcnt(3)
    v_mfma_f32_16x16x32_bf16 v[144:147], v[208:211], v[16:19], v[240:243]
    v_mfma_f32_16x16x32_bf16 v[152:155], v[208:211], v[20:23], v[244:247]
    ds_read_b128 v[236:239], v252 offset:42432
    v_mfma_f32_16x16x32_bf16 v[148:151], v[212:215], v[16:19], v[240:243]
    v_exp_f32 v176, v176
    v_mfma_f32_16x16x32_bf16 v[156:159], v[212:215], v[20:23], v[244:247]
    ds_read_b128 v[208:211], v252 offset:34048
    v_exp_f32 v177, v177
    v_mfma_f32_16x16x32_bf16 v[144:147], v[216:219], v[24:27], v[144:147]
    v_exp_f32 v178, v178
    v_mfma_f32_16x16x32_bf16 v[152:155], v[216:219], v[28:31], v[152:155]
    ds_read_b128 v[212:215], v252 offset:42496
    v_cvt_pk_bf16_f32 v88, v176, v177
    v_mfma_f32_16x16x32_bf16 v[148:151], v[220:223], v[24:27], v[148:151]
    v_exp_f32 v179, v179
    v_mfma_f32_16x16x32_bf16 v[156:159], v[220:223], v[28:31], v[156:159]
    ds_read_b128 v[216:219], v252 offset:34112
    s_waitcnt lgkmcnt(3)
    v_mfma_f32_16x16x32_bf16 v[144:147], v[224:227], v[32:35], v[144:147]
    v_exp_f32 v180, v180
    v_mfma_f32_16x16x32_bf16 v[152:155], v[224:227], v[36:39], v[152:155]
    ds_read_b128 v[220:223], v252 offset:42560
    v_cvt_pk_bf16_f32 v89, v178, v179
    v_mfma_f32_16x16x32_bf16 v[148:151], v[228:231], v[32:35], v[148:151]
    v_exp_f32 v181, v181
    v_mfma_f32_16x16x32_bf16 v[156:159], v[228:231], v[36:39], v[156:159]
    ds_read_b128 v[224:227], v252 offset:34176
    v_cvt_pk_bf16_f32 v90, v180, v181
    v_mfma_f32_16x16x32_bf16 v[144:147], v[232:235], v[40:43], v[144:147]
    v_exp_f32 v182, v182
    v_mfma_f32_16x16x32_bf16 v[152:155], v[232:235], v[44:47], v[152:155]
    ds_read_b128 v[228:231], v252 offset:42624
    v_mfma_f32_16x16x32_bf16 v[148:151], v[236:239], v[40:43], v[148:151]
    v_exp_f32 v183, v183
    v_mfma_f32_16x16x32_bf16 v[156:159], v[236:239], v[44:47], v[156:159]
    ds_read_b128 v[232:235], v252 offset:34240
    s_waitcnt lgkmcnt(3)
    v_mfma_f32_16x16x32_bf16 v[144:147], v[208:211], v[48:51], v[144:147]
    v_exp_f32 v184, v184
    v_mfma_f32_16x16x32_bf16 v[152:155], v[208:211], v[52:55], v[152:155]
    ds_read_b128 v[236:239], v252 offset:42688
    v_cvt_pk_bf16_f32 v91, v182, v183
    v_mfma_f32_16x16x32_bf16 v[148:151], v[212:215], v[48:51], v[148:151]
    v_exp_f32 v185, v185
    v_mfma_f32_16x16x32_bf16 v[156:159], v[212:215], v[52:55], v[156:159]
    ds_read_b128 v[208:211], v2 offset:33792
    v_cvt_pk_bf16_f32 v92, v184, v185
    v_mfma_f32_16x16x32_bf16 v[144:147], v[216:219], v[56:59], v[144:147]
    v_exp_f32 v186, v186
    v_mfma_f32_16x16x32_bf16 v[152:155], v[216:219], v[60:63], v[152:155]
    ds_read_b128 v[212:215], v2 offset:42240
    v_mov_b32 v254, 20
    v_mfma_f32_16x16x32_bf16 v[148:151], v[220:223], v[56:59], v[148:151]
    v_exp_f32 v187, v187
    v_mfma_f32_16x16x32_bf16 v[156:159], v[220:223], v[60:63], v[156:159]
    ds_read_b128 v[216:219], v2 offset:33856
    s_waitcnt lgkmcnt(3)
    v_mfma_f32_16x16x32_bf16 v[144:147], v[224:227], v[64:67], v[144:147]
    ds_write_b32 v0, v254 offset:32
    v_cvt_pk_bf16_f32 v93, v186, v187
    v_mfma_f32_16x16x32_bf16 v[152:155], v[224:227], v[68:71], v[152:155]
    ds_read_b128 v[220:223], v2 offset:42304
    v_exp_f32 v188, v188
    v_mfma_f32_16x16x32_bf16 v[148:151], v[228:231], v[64:67], v[148:151]
    v_exp_f32 v189, v189
    v_mfma_f32_16x16x32_bf16 v[156:159], v[228:231], v[68:71], v[156:159]
    ds_read_b128 v[224:227], v2 offset:33920
    v_cvt_pk_bf16_f32 v94, v188, v189
    v_mfma_f32_16x16x32_bf16 v[144:147], v[232:235], v[72:75], v[144:147]
    v_exp_f32 v190, v190
    v_mfma_f32_16x16x32_bf16 v[152:155], v[232:235], v[76:79], v[152:155]
    ds_read_b128 v[228:231], v2 offset:42368
    v_exp_f32 v191, v191
    v_mfma_f32_16x16x32_bf16 v[148:151], v[236:239], v[72:75], v[148:151]
    v_cvt_pk_bf16_f32 v95, v190, v191
    v_mfma_f32_16x16x32_bf16 v[156:159], v[236:239], v[76:79], v[156:159]
    ds_read_b128 v[232:235], v2 offset:33984
    s_waitcnt lgkmcnt(3)
    v_mfma_f32_16x16x32_bf16 v[176:179], v[208:211], v[16:19], v[240:243]
    v_mfma_f32_16x16x32_bf16 v[184:187], v[208:211], v[20:23], v[244:247]
    ds_read_b128 v[236:239], v2 offset:42432
    v_mfma_f32_16x16x32_bf16 v[180:183], v[212:215], v[16:19], v[240:243]
    v_exp_f32 v144, v144
    v_mfma_f32_16x16x32_bf16 v[188:191], v[212:215], v[20:23], v[244:247]
    ds_read_b128 v[208:211], v2 offset:34048
    v_add_u32 v253, 0xc600, v2
    v_mfma_f32_16x16x32_bf16 v[176:179], v[216:219], v[24:27], v[176:179]
    v_exp_f32 v145, v145
    v_mfma_f32_16x16x32_bf16 v[184:187], v[216:219], v[28:31], v[184:187]
    ds_read_b128 v[212:215], v2 offset:42496
    ds_read_b32 v255, v0 offset:224
    v_cvt_pk_bf16_f32 v96, v144, v145
    v_mfma_f32_16x16x32_bf16 v[180:183], v[220:223], v[24:27], v[180:183]
    v_exp_f32 v146, v146
    v_mfma_f32_16x16x32_bf16 v[188:191], v[220:223], v[28:31], v[188:191]
    ds_read_b128 v[216:219], v2 offset:34112
    s_waitcnt lgkmcnt(4)
    v_mfma_f32_16x16x32_bf16 v[176:179], v[224:227], v[32:35], v[176:179]
    v_exp_f32 v147, v147
    v_mfma_f32_16x16x32_bf16 v[184:187], v[224:227], v[36:39], v[184:187]
    ds_read_b128 v[220:223], v2 offset:42560
    v_cvt_pk_bf16_f32 v97, v146, v147
    v_mfma_f32_16x16x32_bf16 v[180:183], v[228:231], v[32:35], v[180:183]
    v_exp_f32 v148, v148
    v_mfma_f32_16x16x32_bf16 v[188:191], v[228:231], v[36:39], v[188:191]
    ds_read_b128 v[224:227], v2 offset:34176
    v_exp_f32 v149, v149
    v_mfma_f32_16x16x32_bf16 v[176:179], v[232:235], v[40:43], v[176:179]
    v_exp_f32 v150, v150
    v_mfma_f32_16x16x32_bf16 v[184:187], v[232:235], v[44:47], v[184:187]
    ds_read_b128 v[228:231], v2 offset:42624
    v_cvt_pk_bf16_f32 v98, v148, v149
    v_mfma_f32_16x16x32_bf16 v[180:183], v[236:239], v[40:43], v[180:183]
    v_exp_f32 v151, v151
    v_mfma_f32_16x16x32_bf16 v[188:191], v[236:239], v[44:47], v[188:191]
    ds_read_b128 v[232:235], v2 offset:34240
    s_waitcnt lgkmcnt(3)
    v_mfma_f32_16x16x32_bf16 v[176:179], v[208:211], v[48:51], v[176:179]
    v_cmp_gt_u32 vcc, 1, v255
    v_cvt_pk_bf16_f32 v99, v150, v151
    v_mfma_f32_16x16x32_bf16 v[184:187], v[208:211], v[52:55], v[184:187]
    ds_read_b128 v[236:239], v2 offset:42688
    s_cbranch_vccnz L_spin_86
L_go_87:
    v_mfma_f32_16x16x32_bf16 v[180:183], v[212:215], v[48:51], v[180:183]
    v_exp_f32 v152, v152
    v_mfma_f32_16x16x32_bf16 v[188:191], v[212:215], v[52:55], v[188:191]
    ds_read_b128 v[208:211], v253 offset:16896
    v_exp_f32 v153, v153
    v_mfma_f32_16x16x32_bf16 v[176:179], v[216:219], v[56:59], v[176:179]
    v_exp_f32 v154, v154
    v_mfma_f32_16x16x32_bf16 v[184:187], v[216:219], v[60:63], v[184:187]
    ds_read_b128 v[212:215], v253 offset:25344
    v_cvt_pk_bf16_f32 v100, v152, v153
    v_mfma_f32_16x16x32_bf16 v[180:183], v[220:223], v[56:59], v[180:183]
    v_exp_f32 v155, v155
    v_mfma_f32_16x16x32_bf16 v[188:191], v[220:223], v[60:63], v[188:191]
    ds_read_b128 v[216:219], v253 offset:16960
    s_waitcnt lgkmcnt(3)
    v_mfma_f32_16x16x32_bf16 v[176:179], v[224:227], v[64:67], v[176:179]
    v_exp_f32 v156, v156
    v_mfma_f32_16x16x32_bf16 v[184:187], v[224:227], v[68:71], v[184:187]
    ds_read_b128 v[220:223], v253 offset:25408
    v_cvt_pk_bf16_f32 v101, v154, v155
    v_mfma_f32_16x16x32_bf16 v[180:183], v[228:231], v[64:67], v[180:183]
    v_exp_f32 v157, v157
    v_mfma_f32_16x16x32_bf16 v[188:191], v[228:231], v[68:71], v[188:191]
    ds_read_b128 v[224:227], v253 offset:17024
    v_cvt_pk_bf16_f32 v102, v156, v157
    v_mfma_f32_16x16x32_bf16 v[176:179], v[232:235], v[72:75], v[176:179]
    v_exp_f32 v158, v158
    v_mfma_f32_16x16x32_bf16 v[184:187], v[232:235], v[76:79], v[184:187]
    ds_read_b128 v[228:231], v253 offset:25472
    v_exp_f32 v159, v159
    v_mfma_f32_16x16x32_bf16 v[180:183], v[236:239], v[72:75], v[180:183]
    v_cvt_pk_bf16_f32 v103, v158, v159
    v_mfma_f32_16x16x32_bf16 v[188:191], v[236:239], v[76:79], v[188:191]
    ds_read_b128 v[232:235], v253 offset:17088
    s_waitcnt lgkmcnt(3)
    v_mfma_f32_16x16x32_bf16 v[144:147], v[208:211], v[16:19], v[240:243]
    v_mfma_f32_16x16x32_bf16 v[152:155], v[208:211], v[20:23], v[244:247]
    ds_read_b128 v[236:239], v253 offset:25536
    v_mfma_f32_16x16x32_bf16 v[148:151], v[212:215], v[16:19], v[240:243]
    v_exp_f32 v176, v176
    v_mfma_f32_16x16x32_bf16 v[156:159], v[212:215], v[20:23], v[244:247]
    ds_read_b128 v[208:211], v253 offset:17152
    v_exp_f32 v177, v177
    v_mfma_f32_16x16x32_bf16 v[144:147], v[216:219], v[24:27], v[144:147]
    v_exp_f32 v178, v178
    v_mfma_f32_16x16x32_bf16 v[152:155], v[216:219], v[28:31], v[152:155]
    ds_read_b128 v[212:215], v253 offset:25600
    v_cvt_pk_bf16_f32 v104, v176, v177
    v_mfma_f32_16x16x32_bf16 v[148:151], v[220:223], v[24:27], v[148:151]
    v_exp_f32 v179, v179
    v_mfma_f32_16x16x32_bf16 v[156:159], v[220:223], v[28:31], v[156:159]
    ds_read_b128 v[216:219], v253 offset:17216
    s_waitcnt lgkmcnt(3)
    v_mfma_f32_16x16x32_bf16 v[144:147], v[224:227], v[32:35], v[144:147]
    v_exp_f32 v180, v180
    v_mfma_f32_16x16x32_bf16 v[152:155], v[224:227], v[36:39], v[152:155]
    ds_read_b128 v[220:223], v253 offset:25664
    v_cvt_pk_bf16_f32 v105, v178, v179
    v_mfma_f32_16x16x32_bf16 v[148:151], v[228:231], v[32:35], v[148:151]
    v_exp_f32 v181, v181
    v_mfma_f32_16x16x32_bf16 v[156:159], v[228:231], v[36:39], v[156:159]
    ds_read_b128 v[224:227], v253 offset:17280
    v_cvt_pk_bf16_f32 v106, v180, v181
    v_mfma_f32_16x16x32_bf16 v[144:147], v[232:235], v[40:43], v[144:147]
    v_exp_f32 v182, v182
    v_mfma_f32_16x16x32_bf16 v[152:155], v[232:235], v[44:47], v[152:155]
    ds_read_b128 v[228:231], v253 offset:25728
    v_mfma_f32_16x16x32_bf16 v[148:151], v[236:239], v[40:43], v[148:151]
    v_exp_f32 v183, v183
    v_mfma_f32_16x16x32_bf16 v[156:159], v[236:239], v[44:47], v[156:159]
    ds_read_b128 v[232:235], v253 offset:17344
    s_waitcnt lgkmcnt(3)
    v_mfma_f32_16x16x32_bf16 v[144:147], v[208:211], v[48:51], v[144:147]
    v_exp_f32 v184, v184
    v_mfma_f32_16x16x32_bf16 v[152:155], v[208:211], v[52:55], v[152:155]
    ds_read_b128 v[236:239], v253 offset:25792
    v_cvt_pk_bf16_f32 v107, v182, v183
    v_mfma_f32_16x16x32_bf16 v[148:151], v[212:215], v[48:51], v[148:151]
    v_exp_f32 v185, v185
    v_mfma_f32_16x16x32_bf16 v[156:159], v[212:215], v[52:55], v[156:159]
    ds_read_b128 v[208:211], v2 offset:16896
    v_cvt_pk_bf16_f32 v108, v184, v185
    v_mfma_f32_16x16x32_bf16 v[144:147], v[216:219], v[56:59], v[144:147]
    v_exp_f32 v186, v186
    v_mfma_f32_16x16x32_bf16 v[152:155], v[216:219], v[60:63], v[152:155]
    ds_read_b128 v[212:215], v2 offset:25344
    v_mov_b32 v254, 22
    v_mfma_f32_16x16x32_bf16 v[148:151], v[220:223], v[56:59], v[148:151]
    v_exp_f32 v187, v187
    v_mfma_f32_16x16x32_bf16 v[156:159], v[220:223], v[60:63], v[156:159]
    ds_read_b128 v[216:219], v2 offset:16960
    s_waitcnt lgkmcnt(3)
    v_mfma_f32_16x16x32_bf16 v[144:147], v[224:227], v[64:67], v[144:147]
    ds_write_b32 v0, v254 offset:32
    v_cvt_pk_bf16_f32 v109, v186, v187
    v_mfma_f32_16x16x32_bf16 v[152:155], v[224:227], v[68:71], v[152:155]
    ds_read_b128 v[220:223], v2 offset:25408
    v_exp_f32 v188, v188
    v_mfma_f32_16x16x32_bf16 v[148:151], v[228:231], v[64:67], v[148:151]
    v_exp_f32 v189, v189
    v_mfma_f32_16x16x32_bf16 v[156:159], v[228:231], v[68:71], v[156:159]
    ds_read_b128 v[224:227], v2 offset:17024
    v_cvt_pk_bf16_f32 v110, v188, v189
    v_mfma_f32_16x16x32_bf16 v[144:147], v[232:235], v[72:75], v[144:147]
    v_exp_f32 v190, v190
    v_mfma_f32_16x16x32_bf16 v[152:155], v[232:235], v[76:79], v[152:155]
    ds_read_b128 v[228:231], v2 offset:25472
    v_exp_f32 v191, v191
    v_mfma_f32_16x16x32_bf16 v[148:151], v[236:239], v[72:75], v[148:151]
    v_cvt_pk_bf16_f32 v111, v190, v191
    v_mfma_f32_16x16x32_bf16 v[156:159], v[236:239], v[76:79], v[156:159]
    ds_read_b128 v[232:235], v2 offset:17088
    s_waitcnt lgkmcnt(3)
    v_mfma_f32_16x16x32_bf16 v[176:179], v[208:211], v[16:19], v[240:243]
    v_mfma_f32_16x16x32_bf16 v[184:187], v[208:211], v[20:23], v[244:247]
    ds_read_b128 v[236:239], v2 offset:25536
    v_mfma_f32_16x16x32_bf16 v[180:183], v[212:215], v[16:19], v[240:243]
    v_exp_f32 v144, v144
    v_mfma_f32_16x16x32_bf16 v[188:191], v[212:215], v[20:23], v[244:247]
    ds_read_b128 v[208:211], v2 offset:17152
    v_exp_f32 v145, v145
    v_mfma_f32_16x16x32_bf16 v[176:179], v[216:219], v[24:27], v[176:179]
    v_exp_f32 v146, v146
    v_mfma_f32_16x16x32_bf16 v[184:187], v[216:219], v[28:31], v[184:187]
    ds_read_b128 v[212:215], v2 offset:25600
    ds_read_b32 v255, v0 offset:240
    v_mfma_f32_16x16x32_bf16 v[180:183], v[220:223], v[24:27], v[180:183]
    v_exp_f32 v147, v147
    v_mfma_f32_16x16x32_bf16 v[188:191], v[220:223], v[28:31], v[188:191]
    ds_read_b128 v[216:219], v2 offset:17216
    s_waitcnt lgkmcnt(4)
    v_mfma_f32_16x16x32_bf16 v[176:179], v[224:227], v[32:35], v[176:179]
    v_exp_f32 v148, v148
    v_mfma_f32_16x16x32_bf16 v[184:187], v[224:227], v[36:39], v[184:187]
    ds_read_b128 v[220:223], v2 offset:25664
    v_cvt_pk_bf16_f32 v112, v144, v145
    v_cvt_pk_bf16_f32 v113, v146, v147
    v_mfma_f32_16x16x32_bf16 v[180:183], v[228:231], v[32:35], v[180:183]
    v_exp_f32 v149, v149
    v_mfma_f32_16x16x32_bf16 v[188:191], v[228:231], v[36:39], v[188:191]
    ds_read_b128 v[224:227], v2 offset:17280
    v_cvt_pk_bf16_f32 v114, v148, v149
    v_mfma_f32_16x16x32_bf16 v[176:179], v[232:235], v[40:43], v[176:179]
    v_exp_f32 v150, v150
    v_mfma_f32_16x16x32_bf16 v[184:187], v[232:235], v[44:47], v[184:187]
    ds_read_b128 v[228:231], v2 offset:25728
    v_exp_f32 v151, v151
    v_mfma_f32_16x16x32_bf16 v[180:183], v[236:239], v[40:43], v[180:183]
    v_exp_f32 v152, v152
    v_mfma_f32_16x16x32_bf16 v[188:191], v[236:239], v[44:47], v[188:191]
    ds_read_b128 v[232:235], v2 offset:17344
    s_waitcnt lgkmcnt(3)
    v_mfma_f32_16x16x32_bf16 v[176:179], v[208:211], v[48:51], v[176:179]
    v_cmp_gt_u32 vcc, 1, v255
    v_cvt_pk_bf16_f32 v115, v150, v151
    v_mfma_f32_16x16x32_bf16 v[184:187], v[208:211], v[52:55], v[184:187]
    ds_read_b128 v[236:239], v2 offset:25792
    s_cbranch_vccnz L_spin_88
L_go_89:
    v_mfma_f32_16x16x32_bf16 v[180:183], v[212:215], v[48:51], v[180:183]
    v_exp_f32 v153, v153
    v_mfma_f32_16x16x32_bf16 v[188:191], v[212:215], v[52:55], v[188:191]
    ds_read_b128 v[208:211], v253 offset:33792
    v_cvt_pk_bf16_f32 v116, v152, v153
    v_mfma_f32_16x16x32_bf16 v[176:179], v[216:219], v[56:59], v[176:179]
    v_exp_f32 v154, v154
    v_mfma_f32_16x16x32_bf16 v[184:187], v[216:219], v[60:63], v[184:187]
    ds_read_b128 v[212:215], v253 offset:42240
    v_exp_f32 v155, v155
    v_mfma_f32_16x16x32_bf16 v[180:183], v[220:223], v[56:59], v[180:183]
    v_exp_f32 v156, v156
    v_mfma_f32_16x16x32_bf16 v[188:191], v[220:223], v[60:63], v[188:191]
    ds_read_b128 v[216:219], v253 offset:33856
    s_waitcnt lgkmcnt(3)
    v_mfma_f32_16x16x32_bf16 v[176:179], v[224:227], v[64:67], v[176:179]
    v_exp_f32 v157, v157
    v_mfma_f32_16x16x32_bf16 v[184:187], v[224:227], v[68:71], v[184:187]
    ds_read_b128 v[220:223], v253 offset:42304
    v_cvt_pk_bf16_f32 v117, v154, v155
    v_cvt_pk_bf16_f32 v118, v156, v157
    v_mfma_f32_16x16x32_bf16 v[180:183], v[228:231], v[64:67], v[180:183]
    v_exp_f32 v158, v158
    v_mfma_f32_16x16x32_bf16 v[188:191], v[228:231], v[68:71], v[188:191]
    ds_read_b128 v[224:227], v253 offset:33920
    v_mfma_f32_16x16x32_bf16 v[176:179], v[232:235], v[72:75], v[176:179]
    v_exp_f32 v159, v159
    v_mfma_f32_16x16x32_bf16 v[184:187], v[232:235], v[76:79], v[184:187]
    ds_read_b128 v[228:231], v253 offset:42368
    v_cvt_pk_bf16_f32 v119, v158, v159
    v_mfma_f32_16x16x32_bf16 v[180:183], v[236:239], v[72:75], v[180:183]
    v_mfma_f32_16x16x32_bf16 v[188:191], v[236:239], v[76:79], v[188:191]
    ds_read_b128 v[232:235], v253 offset:33984
    s_waitcnt lgkmcnt(3)
    v_mfma_f32_16x16x32_bf16 v[144:147], v[208:211], v[16:19], v[240:243]
    v_mfma_f32_16x16x32_bf16 v[152:155], v[208:211], v[20:23], v[244:247]
    ds_read_b128 v[236:239], v253 offset:42432
    v_mfma_f32_16x16x32_bf16 v[148:151], v[212:215], v[16:19], v[240:243]
    v_exp_f32 v176, v176
    v_mfma_f32_16x16x32_bf16 v[156:159], v[212:215], v[20:23], v[244:247]
    ds_read_b128 v[208:211], v253 offset:34048
    v_exp_f32 v177, v177
    v_mfma_f32_16x16x32_bf16 v[144:147], v[216:219], v[24:27], v[144:147]
    v_exp_f32 v178, v178
    v_mfma_f32_16x16x32_bf16 v[152:155], v[216:219], v[28:31], v[152:155]
    ds_read_b128 v[212:215], v253 offset:42496
    v_cvt_pk_bf16_f32 v120, v176, v177
    v_mfma_f32_16x16x32_bf16 v[148:151], v[220:223], v[24:27], v[148:151]
    v_exp_f32 v179, v179
    v_mfma_f32_16x16x32_bf16 v[156:159], v[220:223], v[28:31], v[156:159]
    ds_read_b128 v[216:219], v253 offset:34112
    s_waitcnt lgkmcnt(3)
    v_mfma_f32_16x16x32_bf16 v[144:147], v[224:227], v[32:35], v[144:147]
    v_exp_f32 v180, v180
    v_mfma_f32_16x16x32_bf16 v[152:155], v[224:227], v[36:39], v[152:155]
    ds_read_b128 v[220:223], v253 offset:42560
    v_cvt_pk_bf16_f32 v121, v178, v179
    v_mfma_f32_16x16x32_bf16 v[148:151], v[228:231], v[32:35], v[148:151]
    v_exp_f32 v181, v181
    v_mfma_f32_16x16x32_bf16 v[156:159], v[228:231], v[36:39], v[156:159]
    ds_read_b128 v[224:227], v253 offset:34176
    v_cvt_pk_bf16_f32 v122, v180, v181
    v_mfma_f32_16x16x32_bf16 v[144:147], v[232:235], v[40:43], v[144:147]
    v_exp_f32 v182, v182
    v_mfma_f32_16x16x32_bf16 v[152:155], v[232:235], v[44:47], v[152:155]
    ds_read_b128 v[228:231], v253 offset:42624
    v_mfma_f32_16x16x32_bf16 v[148:151], v[236:239], v[40:43], v[148:151]
    v_exp_f32 v183, v183
    v_mfma_f32_16x16x32_bf16 v[156:159], v[236:239], v[44:47], v[156:159]
    ds_read_b128 v[232:235], v253 offset:34240
    s_waitcnt lgkmcnt(3)
    v_mfma_f32_16x16x32_bf16 v[144:147], v[208:211], v[48:51], v[144:147]
    v_exp_f32 v184, v184
    v_mfma_f32_16x16x32_bf16 v[152:155], v[208:211], v[52:55], v[152:155]
    ds_read_b128 v[236:239], v253 offset:42688
    v_cvt_pk_bf16_f32 v123, v182, v183
    v_mfma_f32_16x16x32_bf16 v[148:151], v[212:215], v[48:51], v[148:151]
    v_exp_f32 v185, v185
    v_mfma_f32_16x16x32_bf16 v[156:159], v[212:215], v[52:55], v[156:159]
    ds_read_b128 v[208:211], v253 offset:0
    v_cvt_pk_bf16_f32 v124, v184, v185
    v_mfma_f32_16x16x32_bf16 v[144:147], v[216:219], v[56:59], v[144:147]
    v_exp_f32 v186, v186
    v_mfma_f32_16x16x32_bf16 v[152:155], v[216:219], v[60:63], v[152:155]
    ds_read_b128 v[212:215], v253 offset:8448
    v_mov_b32 v254, 24
    v_mfma_f32_16x16x32_bf16 v[148:151], v[220:223], v[56:59], v[148:151]
    v_exp_f32 v187, v187
    v_mfma_f32_16x16x32_bf16 v[156:159], v[220:223], v[60:63], v[156:159]
    ds_read_b128 v[216:219], v253 offset:64
    s_waitcnt lgkmcnt(3)
    v_mfma_f32_16x16x32_bf16 v[144:147], v[224:227], v[64:67], v[144:147]
    ds_write_b32 v0, v254 offset:32
    v_cvt_pk_bf16_f32 v125, v186, v187
    v_mfma_f32_16x16x32_bf16 v[152:155], v[224:227], v[68:71], v[152:155]
    ds_read_b128 v[220:223], v253 offset:8512
    v_exp_f32 v188, v188
    v_mfma_f32_16x16x32_bf16 v[148:151], v[228:231], v[64:67], v[148:151]
    v_exp_f32 v189, v189
    v_mfma_f32_16x16x32_bf16 v[156:159], v[228:231], v[68:71], v[156:159]
    ds_read_b128 v[224:227], v253 offset:128
    v_cvt_pk_bf16_f32 v126, v188, v189
    v_mfma_f32_16x16x32_bf16 v[144:147], v[232:235], v[72:75], v[144:147]
    v_exp_f32 v190, v190
    v_mfma_f32_16x16x32_bf16 v[152:155], v[232:235], v[76:79], v[152:155]
    ds_read_b128 v[228:231], v253 offset:8576
    v_exp_f32 v191, v191
    v_mfma_f32_16x16x32_bf16 v[148:151], v[236:239], v[72:75], v[148:151]
    v_cvt_pk_bf16_f32 v127, v190, v191
    v_mfma_f32_16x16x32_bf16 v[156:159], v[236:239], v[76:79], v[156:159]
    ds_read_b128 v[232:235], v253 offset:192
    s_waitcnt lgkmcnt(3)
    v_mfma_f32_16x16x32_bf16 v[176:179], v[208:211], v[16:19], v[240:243]
    v_mfma_f32_16x16x32_bf16 v[184:187], v[208:211], v[20:23], v[244:247]
    ds_read_b128 v[236:239], v253 offset:8640
    v_mfma_f32_16x16x32_bf16 v[180:183], v[212:215], v[16:19], v[240:243]
    v_exp_f32 v144, v144
    v_mfma_f32_16x16x32_bf16 v[188:191], v[212:215], v[20:23], v[244:247]
    ds_read_b128 v[208:211], v253 offset:256
    v_add_u32 v252, 0x18c00, v5
    v_mfma_f32_16x16x32_bf16 v[176:179], v[216:219], v[24:27], v[176:179]
    v_exp_f32 v145, v145
    v_mfma_f32_16x16x32_bf16 v[184:187], v[216:219], v[28:31], v[184:187]
    ds_read_b128 v[212:215], v253 offset:8704
    ds_read_b32 v255, v0 offset:128
    v_cvt_pk_bf16_f32 v128, v144, v145
    v_mfma_f32_16x16x32_bf16 v[180:183], v[220:223], v[24:27], v[180:183]
    v_exp_f32 v146, v146
    v_mfma_f32_16x16x32_bf16 v[188:191], v[220:223], v[28:31], v[188:191]
    ds_read_b128 v[216:219], v253 offset:320
    s_waitcnt lgkmcnt(4)
    v_mfma_f32_16x16x32_bf16 v[176:179], v[224:227], v[32:35], v[176:179]
    v_exp_f32 v147, v147
    v_mfma_f32_16x16x32_bf16 v[184:187], v[224:227], v[36:39], v[184:187]
    ds_read_b128 v[220:223], v253 offset:8768
    v_cvt_pk_bf16_f32 v129, v146, v147
    v_mfma_f32_16x16x32_bf16 v[180:183], v[228:231], v[32:35], v[180:183]
    v_exp_f32 v148, v148
    v_mfma_f32_16x16x32_bf16 v[188:191], v[228:231], v[36:39], v[188:191]
    ds_read_b128 v[224:227], v253 offset:384
    v_exp_f32 v149, v149
    v_mfma_f32_16x16x32_bf16 v[176:179], v[232:235], v[40:43], v[176:179]
    v_exp_f32 v150, v150
    v_cvt_pk_bf16_f32 v130, v148, v149
    v_mfma_f32_16x16x32_bf16 v[184:187], v[232:235], v[44:47], v[184:187]
    ds_read_b128 v[228:231], v253 offset:8832
    v_exp_f32 v151, v151
    v_mfma_f32_16x16x32_bf16 v[180:183], v[236:239], v[40:43], v[180:183]
    v_exp_f32 v152, v152
    v_mfma_f32_16x16x32_bf16 v[188:191], v[236:239], v[44:47], v[188:191]
    ds_read_b128 v[232:235], v253 offset:448
    s_waitcnt lgkmcnt(3)
    v_mfma_f32_16x16x32_bf16 v[176:179], v[208:211], v[48:51], v[176:179]
    v_cmp_gt_u32 vcc, 1, v255
    v_exp_f32 v153, v153
    v_mfma_f32_16x16x32_bf16 v[184:187], v[208:211], v[52:55], v[184:187]
    ds_read_b128 v[236:239], v253 offset:8896
    s_cbranch_vccnz L_spin_90
L_go_91:
    v_cvt_pk_bf16_f32 v131, v150, v151
    v_mfma_f32_16x16x32_bf16 v[180:183], v[212:215], v[48:51], v[180:183]
    v_exp_f32 v154, v154
    v_mfma_f32_16x16x32_bf16 v[188:191], v[212:215], v[52:55], v[188:191]
    ds_read_b128 v[208:211], v252 offset:16896
    v_cvt_pk_bf16_f32 v132, v152, v153
    ds_read_b128 v[16:19], v4 offset:1024
    v_mfma_f32_16x16x32_bf16 v[176:179], v[216:219], v[56:59], v[176:179]
    v_exp_f32 v155, v155
    v_mfma_f32_16x16x32_bf16 v[184:187], v[216:219], v[60:63], v[184:187]
    ds_read_b128 v[212:215], v252 offset:17920
    v_cvt_pk_bf16_f32 v133, v154, v155
    ds_read_b128 v[20:23], v4 offset:1088
    v_mfma_f32_16x16x32_bf16 v[180:183], v[220:223], v[56:59], v[180:183]
    v_exp_f32 v156, v156
    v_mfma_f32_16x16x32_bf16 v[188:191], v[220:223], v[60:63], v[188:191]
    ds_read_b128 v[216:219], v252 offset:18944
    s_waitcnt lgkmcnt(5)
    v_mfma_f32_16x16x32_bf16 v[176:179], v[224:227], v[64:67], v[176:179]
    v_exp_f32 v157, v157
    v_mfma_f32_16x16x32_bf16 v[184:187], v[224:227], v[68:71], v[184:187]
    ds_read_b128 v[220:223], v252 offset:19968
    v_cvt_pk_bf16_f32 v134, v156, v157
    ds_read_b128 v[24:27], v4 offset:1152
    v_mfma_f32_16x16x32_bf16 v[180:183], v[228:231], v[64:67], v[180:183]
    v_exp_f32 v158, v158
    v_mfma_f32_16x16x32_bf16 v[188:191], v[228:231], v[68:71], v[188:191]
    ds_read_b128 v[224:227], v252 offset:20992
    ds_read_b128 v[28:31], v4 offset:1216
    ds_read_b128 v[32:35], v4 offset:1280
    v_mfma_f32_16x16x32_bf16 v[176:179], v[232:235], v[72:75], v[176:179]
    v_exp_f32 v159, v159
    v_mfma_f32_16x16x32_bf16 v[184:187], v[232:235], v[76:79], v[184:187]
    ds_read_b128 v[228:231], v252 offset:22016
    v_cvt_pk_bf16_f32 v135, v158, v159
    ds_read_b128 v[36:39], v4 offset:1344
    v_mfma_f32_16x16x32_bf16 v[180:183], v[236:239], v[72:75], v[180:183]
    ds_read_b128 v[40:43], v4 offset:1408
    ds_read_b128 v[44:47], v4 offset:1472
    v_mfma_f32_16x16x32_bf16 v[188:191], v[236:239], v[76:79], v[188:191]
    ds_read_b128 v[232:235], v252 offset:23040
    s_waitcnt lgkmcnt(9)
    v_mfma_f32_16x16x32_bf16 v[144:147], v[80:83], v[208:211], 0
    v_mfma_f32_16x16x32_bf16 v[148:151], v[84:87], v[208:211], 0
    ds_read_b128 v[236:239], v252 offset:24064
    v_mfma_f32_16x16x32_bf16 v[152:155], v[80:83], v[212:215], 0
    v_exp_f32 v176, v176
    v_mfma_f32_16x16x32_bf16 v[156:159], v[84:87], v[212:215], 0
    ds_read_b128 v[208:211], v252 offset:25088
    v_mfma_f32_16x16x32_bf16 v[160:163], v[80:83], v[216:219], 0
    v_exp_f32 v177, v177
    v_mfma_f32_16x16x32_bf16 v[164:167], v[84:87], v[216:219], 0
    ds_read_b128 v[212:215], v252 offset:26112
    v_cvt_pk_bf16_f32 v136, v176, v177
    v_mfma_f32_16x16x32_bf16 v[168:171], v[80:83], v[220:223], 0
    v_exp_f32 v178, v178
    v_mfma_f32_16x16x32_bf16 v[172:175], v[84:87], v[220:223], 0
    ds_read_b128 v[216:219], v252 offset:27136
    s_waitcnt lgkmcnt(3)
    v_mfma_f32_16x16x32_bf16 v[144:147], v[88:91], v[224:227], v[144:147]
    v_exp_f32 v179, v179
    v_mfma_f32_16x16x32_bf16 v[148:151], v[92:95], v[224:227], v[148:151]
    ds_read_b128 v[220:223], v252 offset:28160
    v_cvt_pk_bf16_f32 v137, v178, v179
    v_mfma_f32_16x16x32_bf16 v[152:155], v[88:91], v[228:231], v[152:155]
    v_exp_f32 v180, v180
    v_mfma_f32_16x16x32_bf16 v[156:159], v[92:95], v[228:231], v[156:159]
    ds_read_b128 v[224:227], v252 offset:29184
    v_mfma_f32_16x16x32_bf16 v[160:163], v[88:91], v[232:235], v[160:163]
    v_exp_f32 v181, v181
    v_mfma_f32_16x16x32_bf16 v[164:167], v[92:95], v[232:235], v[164:167]
    ds_read_b128 v[228:231], v252 offset:30208
    v_cvt_pk_bf16_f32 v138, v180, v181
    v_mfma_f32_16x16x32_bf16 v[168:171], v[88:91], v[236:239], v[168:171]
    v_exp_f32 v182, v182
    v_mfma_f32_16x16x32_bf16 v[172:175], v[92:95], v[236:239], v[172:175]
    ds_read_b128 v[232:235], v252 offset:31232
    s_waitcnt lgkmcnt(3)
    v_mfma_f32_16x16x32_bf16 v[144:147], v[96:99], v[208:211], v[144:147]
    v_exp_f32 v183, v183
    v_mfma_f32_16x16x32_bf16 v[148:151], v[100:103], v[208:211], v[148:151]
    v_exp_f32 v184, v184
    v_mfma_f32_16x16x32_bf16 v[240:243], v[80:83], v[16:19], 0
    v_exp_f32 v185, v185
    v_mfma_f32_16x16x32_bf16 v[244:247], v[84:87], v[16:19], 0
    ds_read_b128 v[236:239], v252 offset:32256
    v_cvt_pk_bf16_f32 v139, v182, v183
    v_mfma_f32_16x16x32_bf16 v[152:155], v[96:99], v[212:215], v[152:155]
    v_exp_f32 v186, v186
    v_mfma_f32_16x16x32_bf16 v[156:159], v[100:103], v[212:215], v[156:159]
    ds_read_b128 v[208:211], v252 offset:0
    v_cvt_pk_bf16_f32 v140, v184, v185
    v_mfma_f32_16x16x32_bf16 v[160:163], v[96:99], v[216:219], v[160:163]
    v_exp_f32 v187, v187
    v_mfma_f32_16x16x32_bf16 v[164:167], v[100:103], v[216:219], v[164:167]
    v_exp_f32 v188, v188
    v_mfma_f32_16x16x32_bf16 v[240:243], v[88:91], v[20:23], v[240:243]
    v_exp_f32 v189, v189
    v_mfma_f32_16x16x32_bf16 v[244:247], v[92:95], v[20:23], v[244:247]
    ds_read_b128 v[212:215], v252 offset:1024
    v_cvt_pk_bf16_f32 v141, v186, v187
    v_mfma_f32_16x16x32_bf16 v[168:171], v[96:99], v[220:223], v[168:171]
    v_exp_f32 v190, v190
    v_mfma_f32_16x16x32_bf16 v[172:175], v[100:103], v[220:223], v[172:175]
    ds_read_b128 v[216:219], v252 offset:2048
    s_waitcnt lgkmcnt(3)
    v_mfma_f32_16x16x32_bf16 v[144:147], v[104:107], v[224:227], v[144:147]
    v_exp_f32 v191, v191
    v_mfma_f32_16x16x32_bf16 v[148:151], v[108:111], v[224:227], v[148:151]
    v_cvt_pk_bf16_f32 v142, v188, v189
    v_cvt_pk_bf16_f32 v143, v190, v191
    v_mfma_f32_16x16x32_bf16 v[240:243], v[96:99], v[24:27], v[240:243]
    v_mfma_f32_16x16x32_bf16 v[244:247], v[100:103], v[24:27], v[244:247]
    ds_read_b128 v[220:223], v252 offset:3072
    v_mfma_f32_16x16x32_bf16 v[152:155], v[104:107], v[228:231], v[152:155]
    v_mfma_f32_16x16x32_bf16 v[156:159], v[108:111], v[228:231], v[156:159]
    ds_read_b128 v[224:227], v252 offset:4096
    v_mfma_f32_16x16x32_bf16 v[160:163], v[104:107], v[232:235], v[160:163]
    v_mfma_f32_16x16x32_bf16 v[164:167], v[108:111], v[232:235], v[164:167]
    v_mfma_f32_16x16x32_bf16 v[240:243], v[104:107], v[28:31], v[240:243]
    v_mfma_f32_16x16x32_bf16 v[244:247], v[108:111], v[28:31], v[244:247]
    ds_read_b128 v[228:231], v252 offset:5120
    v_mfma_f32_16x16x32_bf16 v[168:171], v[104:107], v[236:239], v[168:171]
    v_mfma_f32_16x16x32_bf16 v[172:175], v[108:111], v[236:239], v[172:175]
    ds_read_b128 v[232:235], v252 offset:6144
    s_waitcnt lgkmcnt(3)
    v_mfma_f32_16x16x32_bf16 v[144:147], v[112:115], v[208:211], v[144:147]
    v_mfma_f32_16x16x32_bf16 v[148:151], v[116:119], v[208:211], v[148:151]
    v_mfma_f32_16x16x32_bf16 v[240:243], v[112:115], v[32:35], v[240:243]
    v_mfma_f32_16x16x32_bf16 v[244:247], v[116:119], v[32:35], v[244:247]
    ds_read_b128 v[236:239], v252 offset:7168
    v_mfma_f32_16x16x32_bf16 v[152:155], v[112:115], v[212:215], v[152:155]
    v_mfma_f32_16x16x32_bf16 v[156:159], v[116:119], v[212:215], v[156:159]
    ds_read_b128 v[208:211], v252 offset:8192
    v_mfma_f32_16x16x32_bf16 v[160:163], v[112:115], v[216:219], v[160:163]
    ds_read_b32 v255, v0 offset:144
    v_mfma_f32_16x16x32_bf16 v[164:167], v[116:119], v[216:219], v[164:167]
    v_mfma_f32_16x16x32_bf16 v[240:243], v[120:123], v[36:39], v[240:243]
    v_mfma_f32_16x16x32_bf16 v[244:247], v[124:127], v[36:39], v[244:247]
    ds_read_b128 v[212:215], v252 offset:9216
    v_mfma_f32_16x16x32_bf16 v[168:171], v[112:115], v[220:223], v[168:171]
    v_mfma_f32_16x16x32_bf16 v[172:175], v[116:119], v[220:223], v[172:175]
    ds_read_b128 v[216:219], v252 offset:10240
    s_waitcnt lgkmcnt(4)
    v_mfma_f32_16x16x32_bf16 v[144:147], v[120:123], v[224:227], v[144:147]
    v_mfma_f32_16x16x32_bf16 v[148:151], v[124:127], v[224:227], v[148:151]
    v_mfma_f32_16x16x32_bf16 v[240:243], v[128:131], v[40:43], v[240:243]
    v_mfma_f32_16x16x32_bf16 v[244:247], v[132:135], v[40:43], v[244:247]
    ds_read_b128 v[220:223], v252 offset:11264
    v_mfma_f32_16x16x32_bf16 v[152:155], v[120:123], v[228:231], v[152:155]
    v_mfma_f32_16x16x32_bf16 v[156:159], v[124:127], v[228:231], v[156:159]
    ds_read_b128 v[224:227], v252 offset:12288
    v_mfma_f32_16x16x32_bf16 v[160:163], v[120:123], v[232:235], v[160:163]
    v_mfma_f32_16x16x32_bf16 v[164:167], v[124:127], v[232:235], v[164:167]
    ds_read_b128 v[228:231], v252 offset:13312
    v_mfma_f32_16x16x32_bf16 v[168:171], v[120:123], v[236:239], v[168:171]
    v_mfma_f32_16x16x32_bf16 v[172:175], v[124:127], v[236:239], v[172:175]
    ds_read_b128 v[232:235], v252 offset:14336
    s_waitcnt lgkmcnt(3)
    v_mfma_f32_16x16x32_bf16 v[144:147], v[128:131], v[208:211], v[144:147]
    v_cmp_gt_u32 vcc, 1, v255
    v_mfma_f32_16x16x32_bf16 v[148:151], v[132:135], v[208:211], v[148:151]
    ds_read_b128 v[236:239], v252 offset:15360
    s_cbranch_vccnz L_spin_92
L_go_93:
    v_mfma_f32_16x16x32_bf16 v[152:155], v[128:131], v[212:215], v[152:155]
    v_mfma_f32_16x16x32_bf16 v[156:159], v[132:135], v[212:215], v[156:159]
    ds_read_b128 v[208:211], v5 offset:0
    v_mfma_f32_16x16x32_bf16 v[160:163], v[128:131], v[216:219], v[160:163]
    v_mfma_f32_16x16x32_bf16 v[164:167], v[132:135], v[216:219], v[164:167]
    ds_read_b128 v[212:215], v5 offset:1024
    v_mfma_f32_16x16x32_bf16 v[168:171], v[128:131], v[220:223], v[168:171]
    v_mfma_f32_16x16x32_bf16 v[172:175], v[132:135], v[220:223], v[172:175]
    ds_read_b128 v[216:219], v5 offset:2048
    s_waitcnt lgkmcnt(3)
    v_mfma_f32_16x16x32_bf16 v[144:147], v[136:139], v[224:227], v[144:147]
    v_mfma_f32_16x16x32_bf16 v[148:151], v[140:143], v[224:227], v[148:151]
    ds_read_b128 v[220:223], v5 offset:3072
    v_mfma_f32_16x16x32_bf16 v[152:155], v[136:139], v[228:231], v[152:155]
    v_mfma_f32_16x16x32_bf16 v[156:159], v[140:143], v[228:231], v[156:159]
    v_mfma_f32_16x16x32_bf16 v[240:243], v[136:139], v[44:47], v[240:243]
    v_mfma_f32_16x16x32_bf16 v[244:247], v[140:143], v[44:47], v[244:247]
    ds_read_b128 v[224:227], v5 offset:4096
    v_mfma_f32_16x16x32_bf16 v[160:163], v[136:139], v[232:235], v[160:163]
    v_mfma_f32_16x16x32_bf16 v[164:167], v[140:143], v[232:235], v[164:167]
    ds_read_b128 v[228:231], v5 offset:5120
    v_mfma_f32_16x16x32_bf16 v[168:171], v[136:139], v[236:239], v[168:171]
    v_mfma_f32_16x16x32_bf16 v[172:175], v[140:143], v[236:239], v[172:175]
    ds_read_b128 v[232:235], v5 offset:6144
    s_waitcnt lgkmcnt(3)
    v_mfma_f32_16x16x32_bf16 v[176:179], v[80:83], v[208:211], 0
    v_mfma_f32_16x16x32_bf16 v[180:183], v[84:87], v[208:211], 0
    ds_read_b128 v[236:239], v5 offset:7168
    v_mfma_f32_16x16x32_bf16 v[184:187], v[80:83], v[212:215], 0
    v_add_f32 v240, 0x358637bd, v240
    v_add_f32 v241, 0x358637bd, v241
    v_mfma_f32_16x16x32_bf16 v[188:191], v[84:87], v[212:215], 0
    ds_read_b128 v[208:211], v5 offset:8192
    v_add_f32 v242, 0x358637bd, v242
    v_add_f32 v243, 0x358637bd, v243
    v_mfma_f32_16x16x32_bf16 v[192:195], v[80:83], v[216:219], 0
    v_add_f32 v244, 0x358637bd, v244
    v_add_f32 v245, 0x358637bd, v245
    v_mfma_f32_16x16x32_bf16 v[196:199], v[84:87], v[216:219], 0
    ds_read_b128 v[212:215], v5 offset:9216
    v_add_f32 v246, 0x358637bd, v246
    v_mfma_f32_16x16x32_bf16 v[200:203], v[80:83], v[220:223], 0
    v_add_f32 v247, 0x358637bd, v247
    v_mfma_f32_16x16x32_bf16 v[204:207], v[84:87], v[220:223], 0
    ds_read_b128 v[216:219], v5 offset:10240
    s_waitcnt lgkmcnt(3)
    v_mfma_f32_16x16x32_bf16 v[176:179], v[88:91], v[224:227], v[176:179]
    v_rcp_f32 v240, v240
    v_mfma_f32_16x16x32_bf16 v[180:183], v[92:95], v[224:227], v[180:183]
    ds_read_b128 v[220:223], v5 offset:11264
    v_mfma_f32_16x16x32_bf16 v[184:187], v[88:91], v[228:231], v[184:187]
    v_rcp_f32 v241, v241
    v_mfma_f32_16x16x32_bf16 v[188:191], v[92:95], v[228:231], v[188:191]
    ds_read_b128 v[224:227], v5 offset:12288
    v_rcp_f32 v242, v242
    v_mfma_f32_16x16x32_bf16 v[192:195], v[88:91], v[232:235], v[192:195]
    v_rcp_f32 v243, v243
    v_mfma_f32_16x16x32_bf16 v[196:199], v[92:95], v[232:235], v[196:199]
    ds_read_b128 v[228:231], v5 offset:13312
    v_mfma_f32_16x16x32_bf16 v[200:203], v[88:91], v[236:239], v[200:203]
    v_rcp_f32 v244, v244
    v_mfma_f32_16x16x32_bf16 v[204:207], v[92:95], v[236:239], v[204:207]
    ds_read_b128 v[232:235], v5 offset:14336
    s_waitcnt lgkmcnt(3)
    v_mfma_f32_16x16x32_bf16 v[176:179], v[96:99], v[208:211], v[176:179]
    v_rcp_f32 v245, v245
    v_mfma_f32_16x16x32_bf16 v[180:183], v[100:103], v[208:211], v[180:183]
    ds_read_b128 v[236:239], v5 offset:15360
    v_mfma_f32_16x16x32_bf16 v[184:187], v[96:99], v[212:215], v[184:187]
    v_rcp_f32 v246, v246
    v_mfma_f32_16x16x32_bf16 v[188:191], v[100:103], v[212:215], v[188:191]
    ds_read_b128 v[208:211], v252 offset:33792
    v_rcp_f32 v247, v247
    v_mfma_f32_16x16x32_bf16 v[192:195], v[96:99], v[216:219], v[192:195]
    v_mul_f32 v144, v144, v240
    v_mul_f32 v152, v152, v240
    v_mfma_f32_16x16x32_bf16 v[196:199], v[100:103], v[216:219], v[196:199]
    ds_read_b128 v[212:215], v252 offset:34816
    v_mul_f32 v160, v160, v240
    v_mul_f32 v168, v168, v240
    v_mfma_f32_16x16x32_bf16 v[200:203], v[96:99], v[220:223], v[200:203]
    v_cvt_pk_bf16_f32 v12, v144, v152
    v_cvt_pk_bf16_f32 v13, v160, v168
    v_mfma_f32_16x16x32_bf16 v[204:207], v[100:103], v[220:223], v[204:207]
    ds_read_b128 v[216:219], v252 offset:35840
    s_waitcnt lgkmcnt(3)
    v_mfma_f32_16x16x32_bf16 v[176:179], v[104:107], v[224:227], v[176:179]
    buffer_store_dwordx2 v[12:13], v10, s[52:55], s10 offen offset:0 sc1
    v_mul_f32 v145, v145, v241
    v_mfma_f32_16x16x32_bf16 v[180:183], v[108:111], v[224:227], v[180:183]
    ds_read_b128 v[220:223], v252 offset:36864
    v_mul_f32 v153, v153, v241
    v_mfma_f32_16x16x32_bf16 v[184:187], v[104:107], v[228:231], v[184:187]
    v_mul_f32 v161, v161, v241
    v_mul_f32 v169, v169, v241
    v_mfma_f32_16x16x32_bf16 v[188:191], v[108:111], v[228:231], v[188:191]
    ds_read_b128 v[224:227], v252 offset:37888
    v_cvt_pk_bf16_f32 v14, v145, v153
    v_mfma_f32_16x16x32_bf16 v[192:195], v[104:107], v[232:235], v[192:195]
    v_cvt_pk_bf16_f32 v15, v161, v169
    v_mfma_f32_16x16x32_bf16 v[196:199], v[108:111], v[232:235], v[196:199]
    ds_read_b128 v[228:231], v252 offset:38912
    buffer_store_dwordx2 v[14:15], v10, s[52:55], s10 offen offset:512 sc1
    v_mul_f32 v146, v146, v242
    v_mfma_f32_16x16x32_bf16 v[200:203], v[104:107], v[236:239], v[200:203]
    v_mul_f32 v154, v154, v242
    v_mul_f32 v162, v162, v242
    v_mfma_f32_16x16x32_bf16 v[204:207], v[108:111], v[236:239], v[204:207]
    ds_read_b128 v[232:235], v252 offset:39936
    s_waitcnt lgkmcnt(3)
    v_mfma_f32_16x16x32_bf16 v[176:179], v[112:115], v[208:211], v[176:179]
    v_mul_f32 v170, v170, v242
    v_cvt_pk_bf16_f32 v12, v146, v154
    v_mfma_f32_16x16x32_bf16 v[180:183], v[116:119], v[208:211], v[180:183]
    ds_read_b128 v[236:239], v252 offset:40960
    v_cvt_pk_bf16_f32 v13, v162, v170
    v_mfma_f32_16x16x32_bf16 v[184:187], v[112:115], v[212:215], v[184:187]
    buffer_store_dwordx2 v[12:13], v10, s[52:55], s10 offen offset:1024 sc1
    v_mul_f32 v147, v147, v243
    v_mfma_f32_16x16x32_bf16 v[188:191], v[116:119], v[212:215], v[188:191]
    ds_read_b128 v[208:211], v252 offset:41984
    v_mul_f32 v155, v155, v243
    v_mfma_f32_16x16x32_bf16 v[192:195], v[112:115], v[216:219], v[192:195]
    ds_read_b32 v255, v0 offset:160
    v_mul_f32 v163, v163, v243
    v_mfma_f32_16x16x32_bf16 v[196:199], v[116:119], v[216:219], v[196:199]
    ds_read_b128 v[212:215], v252 offset:43008
    v_mul_f32 v171, v171, v243
    v_cvt_pk_bf16_f32 v14, v147, v155
    v_mfma_f32_16x16x32_bf16 v[200:203], v[112:115], v[220:223], v[200:203]
    v_cvt_pk_bf16_f32 v15, v163, v171
    v_mfma_f32_16x16x32_bf16 v[204:207], v[116:119], v[220:223], v[204:207]
    ds_read_b128 v[216:219], v252 offset:44032
    s_waitcnt lgkmcnt(4)
    v_mfma_f32_16x16x32_bf16 v[176:179], v[120:123], v[224:227], v[176:179]
    buffer_store_dwordx2 v[14:15], v10, s[52:55], s10 offen offset:1536 sc1
    v_mul_f32 v148, v148, v244
    v_mfma_f32_16x16x32_bf16 v[180:183], v[124:127], v[224:227], v[180:183]
    ds_read_b128 v[220:223], v252 offset:45056
    v_mul_f32 v156, v156, v244
    v_mfma_f32_16x16x32_bf16 v[184:187], v[120:123], v[228:231], v[184:187]
    v_mul_f32 v164, v164, v244
    v_mul_f32 v172, v172, v244
    v_mfma_f32_16x16x32_bf16 v[188:191], v[124:127], v[228:231], v[188:191]
    ds_read_b128 v[224:227], v252 offset:46080
    v_cvt_pk_bf16_f32 v12, v148, v156
    v_mfma_f32_16x16x32_bf16 v[192:195], v[120:123], v[232:235], v[192:195]
    v_cvt_pk_bf16_f32 v13, v164, v172
    v_mfma_f32_16x16x32_bf16 v[196:199], v[124:127], v[232:235], v[196:199]
    ds_read_b128 v[228:231], v252 offset:47104
    buffer_store_dwordx2 v[12:13], v10, s[52:55], s12 offen offset:0 sc1
    v_mul_f32 v149, v149, v245
    v_mfma_f32_16x16x32_bf16 v[200:203], v[120:123], v[236:239], v[200:203]
    v_mul_f32 v157, v157, v245
    v_mul_f32 v165, v165, v245
    v_mfma_f32_16x16x32_bf16 v[204:207], v[124:127], v[236:239], v[204:207]
    ds_read_b128 v[232:235], v252 offset:48128
    s_waitcnt lgkmcnt(3)
    v_mfma_f32_16x16x32_bf16 v[176:179], v[128:131], v[208:211], v[176:179]
    v_cmp_gt_u32 vcc, 1, v255
    v_mul_f32 v173, v173, v245
    v_mfma_f32_16x16x32_bf16 v[180:183], v[132:135], v[208:211], v[180:183]
    ds_read_b128 v[236:239], v252 offset:49152
    s_cbranch_vccnz L_spin_94
L_go_95:
    v_mfma_f32_16x16x32_bf16 v[184:187], v[128:131], v[212:215], v[184:187]
    v_cvt_pk_bf16_f32 v14, v149, v157
    v_cvt_pk_bf16_f32 v15, v165, v173
    v_mfma_f32_16x16x32_bf16 v[188:191], v[132:135], v[212:215], v[188:191]
    ds_read_b128 v[208:211], v5 offset:33792
    buffer_store_dwordx2 v[14:15], v10, s[52:55], s12 offen offset:512 sc1
    v_mfma_f32_16x16x32_bf16 v[192:195], v[128:131], v[216:219], v[192:195]
    v_mul_f32 v150, v150, v246
    v_mul_f32 v158, v158, v246
    v_mfma_f32_16x16x32_bf16 v[196:199], v[132:135], v[216:219], v[196:199]
    ds_read_b128 v[212:215], v5 offset:34816
    v_mul_f32 v166, v166, v246
    v_mfma_f32_16x16x32_bf16 v[200:203], v[128:131], v[220:223], v[200:203]
    v_mul_f32 v174, v174, v246
    v_cvt_pk_bf16_f32 v12, v150, v158
    v_mfma_f32_16x16x32_bf16 v[204:207], v[132:135], v[220:223], v[204:207]
    ds_read_b128 v[216:219], v5 offset:35840
    s_waitcnt lgkmcnt(3)
    v_mfma_f32_16x16x32_bf16 v[176:179], v[136:139], v[224:227], v[176:179]
    v_cvt_pk_bf16_f32 v13, v166, v174
    v_mfma_f32_16x16x32_bf16 v[180:183], v[140:143], v[224:227], v[180:183]
    ds_read_b128 v[220:223], v5 offset:36864
    buffer_store_dwordx2 v[12:13], v10, s[52:55], s12 offen offset:1024 sc1
    v_mfma_f32_16x16x32_bf16 v[184:187], v[136:139], v[228:231], v[184:187]
    v_mul_f32 v151, v151, v247
    v_mul_f32 v159, v159, v247
    v_mfma_f32_16x16x32_bf16 v[188:191], v[140:143], v[228:231], v[188:191]
    ds_read_b128 v[224:227], v5 offset:37888
    v_mul_f32 v167, v167, v247
    v_mfma_f32_16x16x32_bf16 v[192:195], v[136:139], v[232:235], v[192:195]
    v_mul_f32 v175, v175, v247
    v_cvt_pk_bf16_f32 v14, v151, v159
    v_mfma_f32_16x16x32_bf16 v[196:199], v[140:143], v[232:235], v[196:199]
    ds_read_b128 v[228:231], v5 offset:38912
    v_cvt_pk_bf16_f32 v15, v167, v175
    v_mfma_f32_16x16x32_bf16 v[200:203], v[136:139], v[236:239], v[200:203]
    buffer_store_dwordx2 v[14:15], v10, s[52:55], s12 offen offset:1536 sc1
    v_mfma_f32_16x16x32_bf16 v[204:207], v[140:143], v[236:239], v[204:207]
    ds_read_b128 v[232:235], v5 offset:39936
    s_waitcnt lgkmcnt(3)
    v_mfma_f32_16x16x32_bf16 v[144:147], v[80:83], v[208:211], 0
    v_mfma_f32_16x16x32_bf16 v[148:151], v[84:87], v[208:211], 0
    ds_read_b128 v[236:239], v5 offset:40960
    v_mfma_f32_16x16x32_bf16 v[152:155], v[80:83], v[212:215], 0
    v_add_u32 v253, 0xc600, v5
    v_mul_f32 v176, v176, v240
    v_mfma_f32_16x16x32_bf16 v[156:159], v[84:87], v[212:215], 0
    ds_read_b128 v[208:211], v5 offset:41984
    v_mul_f32 v184, v184, v240
    v_mfma_f32_16x16x32_bf16 v[160:163], v[80:83], v[216:219], 0
    v_mul_f32 v192, v192, v240
    v_mul_f32 v200, v200, v240
    v_mfma_f32_16x16x32_bf16 v[164:167], v[84:87], v[216:219], 0
    ds_read_b128 v[212:215], v5 offset:43008
    v_cvt_pk_bf16_f32 v12, v176, v184
    v_mfma_f32_16x16x32_bf16 v[168:171], v[80:83], v[220:223], 0
    v_cvt_pk_bf16_f32 v13, v192, v200
    v_mfma_f32_16x16x32_bf16 v[172:175], v[84:87], v[220:223], 0
    ds_read_b128 v[216:219], v5 offset:44032
    s_waitcnt lgkmcnt(3)
    v_mfma_f32_16x16x32_bf16 v[144:147], v[88:91], v[224:227], v[144:147]
    buffer_store_dwordx2 v[12:13], v10, s[52:55], s10 offen offset:128 sc1
    v_mul_f32 v177, v177, v241
    v_mfma_f32_16x16x32_bf16 v[148:151], v[92:95], v[224:227], v[148:151]
    ds_read_b128 v[220:223], v5 offset:45056
    v_mul_f32 v185, v185, v241
    v_mfma_f32_16x16x32_bf16 v[152:155], v[88:91], v[228:231], v[152:155]
    v_mul_f32 v193, v193, v241
    v_mul_f32 v201, v201, v241
    v_mfma_f32_16x16x32_bf16 v[156:159], v[92:95], v[228:231], v[156:159]
    ds_read_b128 v[224:227], v5 offset:46080
    v_cvt_pk_bf16_f32 v14, v177, v185
    v_mfma_f32_16x16x32_bf16 v[160:163], v[88:91], v[232:235], v[160:163]
    v_cvt_pk_bf16_f32 v15, v193, v201
    v_mfma_f32_16x16x32_bf16 v[164:167], v[92:95], v[232:235], v[164:167]
    ds_read_b128 v[228:231], v5 offset:47104
    buffer_store_dwordx2 v[14:15], v10, s[52:55], s10 offen offset:640 sc1
    v_mfma_f32_16x16x32_bf16 v[168:171], v[88:91], v[236:239], v[168:171]
    v_mul_f32 v178, v178, v242
    v_mul_f32 v186, v186, v242
    v_mfma_f32_16x16x32_bf16 v[172:175], v[92:95], v[236:239], v[172:175]
    ds_read_b128 v[232:235], v5 offset:48128
    s_waitcnt lgkmcnt(3)
    v_mfma_f32_16x16x32_bf16 v[144:147], v[96:99], v[208:211], v[144:147]
    v_mul_f32 v194, v194, v242
    v_mul_f32 v202, v202, v242
    v_mfma_f32_16x16x32_bf16 v[148:151], v[100:103], v[208:211], v[148:151]
    ds_read_b128 v[236:239], v5 offset:49152
    v_cvt_pk_bf16_f32 v12, v178, v186
    v_mfma_f32_16x16x32_bf16 v[152:155], v[96:99], v[212:215], v[152:155]
    v_cvt_pk_bf16_f32 v13, v194, v202
    v_mfma_f32_16x16x32_bf16 v[156:159], v[100:103], v[212:215], v[156:159]
    ds_read_b128 v[208:211], v253 offset:16896
    buffer_store_dwordx2 v[12:13], v10, s[52:55], s10 offen offset:1152 sc1
    v_mfma_f32_16x16x32_bf16 v[160:163], v[96:99], v[216:219], v[160:163]
    v_mul_f32 v179, v179, v243
    v_mul_f32 v187, v187, v243
    v_mfma_f32_16x16x32_bf16 v[164:167], v[100:103], v[216:219], v[164:167]
    ds_read_b128 v[212:215], v253 offset:17920
    v_mul_f32 v195, v195, v243
    v_mfma_f32_16x16x32_bf16 v[168:171], v[96:99], v[220:223], v[168:171]
    v_mul_f32 v203, v203, v243
    v_cvt_pk_bf16_f32 v14, v179, v187
    v_mfma_f32_16x16x32_bf16 v[172:175], v[100:103], v[220:223], v[172:175]
    ds_read_b128 v[216:219], v253 offset:18944
    s_waitcnt lgkmcnt(3)
    v_mfma_f32_16x16x32_bf16 v[144:147], v[104:107], v[224:227], v[144:147]
    v_cvt_pk_bf16_f32 v15, v195, v203
    v_mfma_f32_16x16x32_bf16 v[148:151], v[108:111], v[224:227], v[148:151]
    ds_read_b128 v[220:223], v253 offset:19968
    buffer_store_dwordx2 v[14:15], v10, s[52:55], s10 offen offset:1664 sc1
    v_mfma_f32_16x16x32_bf16 v[152:155], v[104:107], v[228:231], v[152:155]
    v_mul_f32 v180, v180, v244
    v_mul_f32 v188, v188, v244
    v_mfma_f32_16x16x32_bf16 v[156:159], v[108:111], v[228:231], v[156:159]
    ds_read_b128 v[224:227], v253 offset:20992
    v_mul_f32 v196, v196, v244
    v_mfma_f32_16x16x32_bf16 v[160:163], v[104:107], v[232:235], v[160:163]
    v_mul_f32 v204, v204, v244
    v_cvt_pk_bf16_f32 v12, v180, v188
    v_mfma_f32_16x16x32_bf16 v[164:167], v[108:111], v[232:235], v[164:167]
    ds_read_b128 v[228:231], v253 offset:22016
    v_cvt_pk_bf16_f32 v13, v196, v204
    v_mfma_f32_16x16x32_bf16 v[168:171], v[104:107], v[236:239], v[168:171]
    buffer_store_dwordx2 v[12:13], v10, s[52:55], s12 offen offset:128 sc1
    v_mul_f32 v181, v181, v245
    v_mfma_f32_16x16x32_bf16 v[172:175], v[108:111], v[236:239], v[172:175]
    ds_read_b128 v[232:235], v253 offset:23040
    s_waitcnt lgkmcnt(3)
    v_mfma_f32_16x16x32_bf16 v[144:147], v[112:115], v[208:211], v[144:147]
    v_mul_f32 v189, v189, v245
    v_mul_f32 v197, v197, v245
    v_mfma_f32_16x16x32_bf16 v[148:151], v[116:119], v[208:211], v[148:151]
    ds_read_b128 v[236:239], v253 offset:24064
    v_mul_f32 v205, v205, v245
    v_mfma_f32_16x16x32_bf16 v[152:155], v[112:115], v[212:215], v[152:155]
    v_cvt_pk_bf16_f32 v14, v181, v189
    v_cvt_pk_bf16_f32 v15, v197, v205
    v_mfma_f32_16x16x32_bf16 v[156:159], v[116:119], v[212:215], v[156:159]
    ds_read_b128 v[208:211], v253 offset:25088
    buffer_store_dwordx2 v[14:15], v10, s[52:55], s12 offen offset:640 sc1
    v_mfma_f32_16x16x32_bf16 v[160:163], v[112:115], v[216:219], v[160:163]
    ds_read_b32 v255, v0 offset:176
    v_mul_f32 v182, v182, v246
    v_mfma_f32_16x16x32_bf16 v[164:167], v[116:119], v[216:219], v[164:167]
    ds_read_b128 v[212:215], v253 offset:26112
    v_mul_f32 v190, v190, v246
    v_mfma_f32_16x16x32_bf16 v[168:171], v[112:115], v[220:223], v[168:171]
    v_mul_f32 v198, v198, v246
    v_mul_f32 v206, v206, v246
    v_mfma_f32_16x16x32_bf16 v[172:175], v[116:119], v[220:223], v[172:175]
    ds_read_b128 v[216:219], v253 offset:27136
    s_waitcnt lgkmcnt(4)
    v_mfma_f32_16x16x32_bf16 v[144:147], v[120:123], v[224:227], v[144:147]
    v_cvt_pk_bf16_f32 v12, v182, v190
    v_cvt_pk_bf16_f32 v13, v198, v206
    v_mfma_f32_16x16x32_bf16 v[148:151], v[124:127], v[224:227], v[148:151]
    ds_read_b128 v[220:223], v253 offset:28160
    buffer_store_dwordx2 v[12:13], v10, s[52:55], s12 offen offset:1152 sc1
    v_mfma_f32_16x16x32_bf16 v[152:155], v[120:123], v[228:231], v[152:155]
    v_mul_f32 v183, v183, v247
    v_mul_f32 v191, v191, v247
    v_mfma_f32_16x16x32_bf16 v[156:159], v[124:127], v[228:231], v[156:159]
    ds_read_b128 v[224:227], v253 offset:29184
    v_mul_f32 v199, v199, v247
    v_mfma_f32_16x16x32_bf16 v[160:163], v[120:123], v[232:235], v[160:163]
    v_mul_f32 v207, v207, v247
    v_cvt_pk_bf16_f32 v14, v183, v191
    v_mfma_f32_16x16x32_bf16 v[164:167], v[124:127], v[232:235], v[164:167]
    ds_read_b128 v[228:231], v253 offset:30208
    v_cvt_pk_bf16_f32 v15, v199, v207
    v_mfma_f32_16x16x32_bf16 v[168:171], v[120:123], v[236:239], v[168:171]
    buffer_store_dwordx2 v[14:15], v10, s[52:55], s12 offen offset:1664 sc1
    v_mfma_f32_16x16x32_bf16 v[172:175], v[124:127], v[236:239], v[172:175]
    ds_read_b128 v[232:235], v253 offset:31232
    s_waitcnt lgkmcnt(3)
    v_mfma_f32_16x16x32_bf16 v[144:147], v[128:131], v[208:211], v[144:147]
    v_cmp_gt_u32 vcc, 1, v255
    v_mfma_f32_16x16x32_bf16 v[148:151], v[132:135], v[208:211], v[148:151]
    ds_read_b128 v[236:239], v253 offset:32256
    s_cbranch_vccnz L_spin_96
L_go_97:
    v_mfma_f32_16x16x32_bf16 v[152:155], v[128:131], v[212:215], v[152:155]
    v_mfma_f32_16x16x32_bf16 v[156:159], v[132:135], v[212:215], v[156:159]
    ds_read_b128 v[208:211], v5 offset:16896
    v_mfma_f32_16x16x32_bf16 v[160:163], v[128:131], v[216:219], v[160:163]
    v_mfma_f32_16x16x32_bf16 v[164:167], v[132:135], v[216:219], v[164:167]
    ds_read_b128 v[212:215], v5 offset:17920
    v_mfma_f32_16x16x32_bf16 v[168:171], v[128:131], v[220:223], v[168:171]
    v_mfma_f32_16x16x32_bf16 v[172:175], v[132:135], v[220:223], v[172:175]
    ds_read_b128 v[216:219], v5 offset:18944
    s_waitcnt lgkmcnt(3)
    v_mfma_f32_16x16x32_bf16 v[144:147], v[136:139], v[224:227], v[144:147]
    v_mfma_f32_16x16x32_bf16 v[148:151], v[140:143], v[224:227], v[148:151]
    ds_read_b128 v[220:223], v5 offset:19968
    v_mfma_f32_16x16x32_bf16 v[152:155], v[136:139], v[228:231], v[152:155]
    v_mfma_f32_16x16x32_bf16 v[156:159], v[140:143], v[228:231], v[156:159]
    ds_read_b128 v[224:227], v5 offset:20992
    v_mfma_f32_16x16x32_bf16 v[160:163], v[136:139], v[232:235], v[160:163]
    v_mfma_f32_16x16x32_bf16 v[164:167], v[140:143], v[232:235], v[164:167]
    ds_read_b128 v[228:231], v5 offset:22016
    v_mfma_f32_16x16x32_bf16 v[168:171], v[136:139], v[236:239], v[168:171]
    v_mfma_f32_16x16x32_bf16 v[172:175], v[140:143], v[236:239], v[172:175]
    ds_read_b128 v[232:235], v5 offset:23040
    s_cmp_eq_u32 s45, 2
    s_cbranch_scc0 L_slow2
    s_waitcnt lgkmcnt(3)
    v_mfma_f32_16x16x32_bf16 v[176:179], v[80:83], v[208:211], 0
    v_mfma_f32_16x16x32_bf16 v[180:183], v[84:87], v[208:211], 0
    ds_read_b128 v[236:239], v5 offset:24064
    v_mfma_f32_16x16x32_bf16 v[184:187], v[80:83], v[212:215], 0
    v_mul_f32 v144, v144, v240
    v_mul_f32 v152, v152, v240
    v_mfma_f32_16x16x32_bf16 v[188:191], v[84:87], v[212:215], 0
    ds_read_b128 v[208:211], v5 offset:25088
    v_mul_f32 v160, v160, v240
    v_mfma_f32_16x16x32_bf16 v[192:195], v[80:83], v[216:219], 0
    v_mul_f32 v168, v168, v240
    v_cvt_pk_bf16_f32 v12, v144, v152
    v_mfma_f32_16x16x32_bf16 v[196:199], v[84:87], v[216:219], 0
    ds_read_b128 v[212:215], v5 offset:26112
    v_cvt_pk_bf16_f32 v13, v160, v168
    v_mfma_f32_16x16x32_bf16 v[200:203], v[80:83], v[220:223], 0
    buffer_store_dwordx2 v[12:13], v10, s[52:55], s10 offen offset:256
    v_mul_f32 v145, v145, v241
    v_mfma_f32_16x16x32_bf16 v[204:207], v[84:87], v[220:223], 0
    ds_read_b128 v[216:219], v5 offset:27136
    s_waitcnt lgkmcnt(3)
    v_mfma_f32_16x16x32_bf16 v[176:179], v[88:91], v[224:227], v[176:179]
    v_mul_f32 v153, v153, v241
    v_mul_f32 v161, v161, v241
    v_mfma_f32_16x16x32_bf16 v[180:183], v[92:95], v[224:227], v[180:183]
    ds_read_b128 v[220:223], v5 offset:28160
    v_mul_f32 v169, v169, v241
    v_mfma_f32_16x16x32_bf16 v[184:187], v[88:91], v[228:231], v[184:187]
    v_cvt_pk_bf16_f32 v14, v145, v153
    v_cvt_pk_bf16_f32 v15, v161, v169
    v_mfma_f32_16x16x32_bf16 v[188:191], v[92:95], v[228:231], v[188:191]
    ds_read_b128 v[224:227], v5 offset:29184
    buffer_store_dwordx2 v[14:15], v10, s[52:55], s10 offen offset:768
    v_mfma_f32_16x16x32_bf16 v[192:195], v[88:91], v[232:235], v[192:195]
    v_mul_f32 v146, v146, v242
    v_mul_f32 v154, v154, v242
    v_mfma_f32_16x16x32_bf16 v[196:199], v[92:95], v[232:235], v[196:199]
    ds_read_b128 v[228:231], v5 offset:30208
    v_mul_f32 v162, v162, v242
    v_mfma_f32_16x16x32_bf16 v[200:203], v[88:91], v[236:239], v[200:203]
    v_mul_f32 v170, v170, v242
    v_cvt_pk_bf16_f32 v12, v146, v154
    v_mfma_f32_16x16x32_bf16 v[204:207], v[92:95], v[236:239], v[204:207]
    ds_read_b128 v[232:235], v5 offset:31232
    s_waitcnt lgkmcnt(3)
    v_mfma_f32_16x16x32_bf16 v[176:179], v[96:99], v[208:211], v[176:179]
    v_cvt_pk_bf16_f32 v13, v162, v170
    v_mfma_f32_16x16x32_bf16 v[180:183], v[100:103], v[208:211], v[180:183]
    ds_read_b128 v[236:239], v5 offset:32256
    buffer_store_dwordx2 v[12:13], v10, s[52:55], s10 offen offset:1280
    v_mfma_f32_16x16x32_bf16 v[184:187], v[96:99], v[212:215], v[184:187]
    v_mul_f32 v147, v147, v243
    v_mul_f32 v155, v155, v243
    v_mfma_f32_16x16x32_bf16 v[188:191], v[100:103], v[212:215], v[188:191]
    ds_read_b128 v[208:211], v253 offset:33792
    v_mul_f32 v163, v163, v243
    v_mfma_f32_16x16x32_bf16 v[192:195], v[96:99], v[216:219], v[192:195]
    v_mul_f32 v171, v171, v243
    v_cvt_pk_bf16_f32 v14, v147, v155
    v_mfma_f32_16x16x32_bf16 v[196:199], v[100:103], v[216:219], v[196:199]
    ds_read_b128 v[212:215], v253 offset:34816
    v_cvt_pk_bf16_f32 v15, v163, v171
    v_mfma_f32_16x16x32_bf16 v[200:203], v[96:99], v[220:223], v[200:203]
    buffer_store_dwordx2 v[14:15], v10, s[52:55], s10 offen offset:1792
    v_mul_f32 v148, v148, v244
    v_mfma_f32_16x16x32_bf16 v[204:207], v[100:103], v[220:223], v[204:207]
    ds_read_b128 v[216:219], v253 offset:35840
    s_waitcnt lgkmcnt(3)
    v_mfma_f32_16x16x32_bf16 v[176:179], v[104:107], v[224:227], v[176:179]
    v_mul_f32 v156, v156, v244
    v_mul_f32 v164, v164, v244
    v_mfma_f32_16x16x32_bf16 v[180:183], v[108:111], v[224:227], v[180:183]
    ds_read_b128 v[220:223], v253 offset:36864
    v_mul_f32 v172, v172, v244
    v_mfma_f32_16x16x32_bf16 v[184:187], v[104:107], v[228:231], v[184:187]
    v_cvt_pk_bf16_f32 v12, v148, v156
    v_cvt_pk_bf16_f32 v13, v164, v172
    v_mfma_f32_16x16x32_bf16 v[188:191], v[108:111], v[228:231], v[188:191]
    ds_read_b128 v[224:227], v253 offset:37888
    buffer_store_dwordx2 v[12:13], v10, s[52:55], s12 offen offset:256
    v_mfma_f32_16x16x32_bf16 v[192:195], v[104:107], v[232:235], v[192:195]
    v_mul_f32 v149, v149, v245
    v_mul_f32 v157, v157, v245
    v_mfma_f32_16x16x32_bf16 v[196:199], v[108:111], v[232:235], v[196:199]
    ds_read_b128 v[228:231], v253 offset:38912
    v_mul_f32 v165, v165, v245
    v_mfma_f32_16x16x32_bf16 v[200:203], v[104:107], v[236:239], v[200:203]
    v_mul_f32 v173, v173, v245
    v_cvt_pk_bf16_f32 v14, v149, v157
    v_mfma_f32_16x16x32_bf16 v[204:207], v[108:111], v[236:239], v[204:207]
    ds_read_b128 v[232:235], v253 offset:39936
    s_waitcnt lgkmcnt(3)
    v_mfma_f32_16x16x32_bf16 v[176:179], v[112:115], v[208:211], v[176:179]
    v_cvt_pk_bf16_f32 v15, v165, v173
    v_mfma_f32_16x16x32_bf16 v[180:183], v[116:119], v[208:211], v[180:183]
    ds_read_b128 v[236:239], v253 offset:40960
    buffer_store_dwordx2 v[14:15], v10, s[52:55], s12 offen offset:768
    v_mfma_f32_16x16x32_bf16 v[184:187], v[112:115], v[212:215], v[184:187]
    v_mul_f32 v150, v150, v246
    v_mul_f32 v158, v158, v246
    v_mfma_f32_16x16x32_bf16 v[188:191], v[116:119], v[212:215], v[188:191]
    ds_read_b128 v[208:211], v253 offset:41984
    v_mul_f32 v166, v166, v246
    v_mfma_f32_16x16x32_bf16 v[192:195], v[112:115], v[216:219], v[192:195]
    v_mul_f32 v174, v174, v246
    v_cvt_pk_bf16_f32 v12, v150, v158
    v_mfma_f32_16x16x32_bf16 v[196:199], v[116:119], v[216:219], v[196:199]
    ds_read_b128 v[212:215], v253 offset:43008
    v_cvt_pk_bf16_f32 v13, v166, v174
    v_mfma_f32_16x16x32_bf16 v[200:203], v[112:115], v[220:223], v[200:203]
    buffer_store_dwordx2 v[12:13], v10, s[52:55], s12 offen offset:1280
    v_mul_f32 v151, v151, v247
    v_mfma_f32_16x16x32_bf16 v[204:207], v[116:119], v[220:223], v[204:207]
    ds_read_b128 v[216:219], v253 offset:44032
    s_waitcnt lgkmcnt(3)
    v_mfma_f32_16x16x32_bf16 v[176:179], v[120:123], v[224:227], v[176:179]
    v_mul_f32 v159, v159, v247
    v_mul_f32 v167, v167, v247
    v_mfma_f32_16x16x32_bf16 v[180:183], v[124:127], v[224:227], v[180:183]
    ds_read_b128 v[220:223], v253 offset:45056
    v_mul_f32 v175, v175, v247
    v_mfma_f32_16x16x32_bf16 v[184:187], v[120:123], v[228:231], v[184:187]
    v_cvt_pk_bf16_f32 v14, v151, v159
    v_cvt_pk_bf16_f32 v15, v167, v175
    v_mfma_f32_16x16x32_bf16 v[188:191], v[124:127], v[228:231], v[188:191]
    ds_read_b128 v[224:227], v253 offset:46080
    buffer_store_dwordx2 v[14:15], v10, s[52:55], s12 offen offset:1792
    v_mfma_f32_16x16x32_bf16 v[192:195], v[120:123], v[232:235], v[192:195]
    v_mfma_f32_16x16x32_bf16 v[196:199], v[124:127], v[232:235], v[196:199]
    ds_read_b128 v[228:231], v253 offset:47104
    v_mfma_f32_16x16x32_bf16 v[200:203], v[120:123], v[236:239], v[200:203]
    v_mfma_f32_16x16x32_bf16 v[204:207], v[124:127], v[236:239], v[204:207]
    ds_read_b128 v[232:235], v253 offset:48128
    s_waitcnt lgkmcnt(3)
    v_mfma_f32_16x16x32_bf16 v[176:179], v[128:131], v[208:211], v[176:179]
    v_mfma_f32_16x16x32_bf16 v[180:183], v[132:135], v[208:211], v[180:183]
    ds_read_b128 v[236:239], v253 offset:49152
    v_mfma_f32_16x16x32_bf16 v[184:187], v[128:131], v[212:215], v[184:187]
    v_mfma_f32_16x16x32_bf16 v[188:191], v[132:135], v[212:215], v[188:191]
    v_mfma_f32_16x16x32_bf16 v[192:195], v[128:131], v[216:219], v[192:195]
    v_mfma_f32_16x16x32_bf16 v[196:199], v[132:135], v[216:219], v[196:199]
    v_mfma_f32_16x16x32_bf16 v[200:203], v[128:131], v[220:223], v[200:203]
    v_mfma_f32_16x16x32_bf16 v[204:207], v[132:135], v[220:223], v[204:207]
    s_waitcnt lgkmcnt(0)
    v_mfma_f32_16x16x32_bf16 v[176:179], v[136:139], v[224:227], v[176:179]
    v_mfma_f32_16x16x32_bf16 v[180:183], v[140:143], v[224:227], v[180:183]
    v_mfma_f32_16x16x32_bf16 v[184:187], v[136:139], v[228:231], v[184:187]
    v_mfma_f32_16x16x32_bf16 v[188:191], v[140:143], v[228:231], v[188:191]
    v_mfma_f32_16x16x32_bf16 v[192:195], v[136:139], v[232:235], v[192:195]
    v_mfma_f32_16x16x32_bf16 v[196:199], v[140:143], v[232:235], v[196:199]
    v_mfma_f32_16x16x32_bf16 v[200:203], v[136:139], v[236:239], v[200:203]
    v_mfma_f32_16x16x32_bf16 v[204:207], v[140:143], v[236:239], v[204:207]
    s_nop 7
    v_mul_f32 v176, v176, v240
    v_mul_f32 v184, v184, v240
    v_mul_f32 v192, v192, v240
    v_mul_f32 v200, v200, v240
    v_cvt_pk_bf16_f32 v12, v176, v184
    v_cvt_pk_bf16_f32 v13, v192, v200
    v_mul_f32 v177, v177, v241
    v_mul_f32 v185, v185, v241
    buffer_store_dwordx2 v[12:13], v10, s[52:55], s10 offen offset:384
    v_mul_f32 v193, v193, v241
    v_mul_f32 v201, v201, v241
    v_cvt_pk_bf16_f32 v14, v177, v185
    v_cvt_pk_bf16_f32 v15, v193, v201
    v_mul_f32 v178, v178, v242
    v_mul_f32 v186, v186, v242
    buffer_store_dwordx2 v[14:15], v10, s[52:55], s10 offen offset:896
    v_mul_f32 v194, v194, v242
    v_mul_f32 v202, v202, v242
    v_cvt_pk_bf16_f32 v12, v178, v186
    v_cvt_pk_bf16_f32 v13, v194, v202
    v_mul_f32 v179, v179, v243
    v_mul_f32 v187, v187, v243
    buffer_store_dwordx2 v[12:13], v10, s[52:55], s10 offen offset:1408
    v_mul_f32 v195, v195, v243
    v_mul_f32 v203, v203, v243
    v_cvt_pk_bf16_f32 v14, v179, v187
    v_cvt_pk_bf16_f32 v15, v195, v203
    v_mul_f32 v180, v180, v244
    v_mul_f32 v188, v188, v244
    buffer_store_dwordx2 v[14:15], v10, s[52:55], s10 offen offset:1920
    v_mul_f32 v196, v196, v244
    v_mul_f32 v204, v204, v244
    v_cvt_pk_bf16_f32 v12, v180, v188
    v_cvt_pk_bf16_f32 v13, v196, v204
    v_mul_f32 v181, v181, v245
    v_mul_f32 v189, v189, v245
    buffer_store_dwordx2 v[12:13], v10, s[52:55], s12 offen offset:384
    v_mul_f32 v197, v197, v245
    v_mul_f32 v205, v205, v245
    v_cvt_pk_bf16_f32 v14, v181, v189
    v_cvt_pk_bf16_f32 v15, v197, v205
    v_mul_f32 v182, v182, v246
    v_mul_f32 v190, v190, v246
    buffer_store_dwordx2 v[14:15], v10, s[52:55], s12 offen offset:896
    v_mul_f32 v198, v198, v246
    v_mul_f32 v206, v206, v246
    v_cvt_pk_bf16_f32 v12, v182, v190
    v_cvt_pk_bf16_f32 v13, v198, v206
    v_mul_f32 v183, v183, v247
    v_mul_f32 v191, v191, v247
    buffer_store_dwordx2 v[12:13], v10, s[52:55], s12 offen offset:1408
    v_mul_f32 v199, v199, v247
    v_mul_f32 v207, v207, v247
    v_cvt_pk_bf16_f32 v14, v183, v191
    v_cvt_pk_bf16_f32 v15, v199, v207
    buffer_store_dwordx2 v[14:15], v10, s[52:55], s12 offen offset:1920
    s_endpgm
L_spin_84:
    s_mov_b32 s34, 1048576
L_spin_84b:
    ds_read_b32 v255, v8 offset:16
    s_waitcnt lgkmcnt(0)
    v_cmp_gt_u32 vcc, 22, v255
    s_cbranch_vccz L_go_85
    s_sub_u32 s34, s34, 1
    s_cbranch_scc0 L_spin_84b
    s_branch L_go_85
L_spin_86:
    s_mov_b32 s34, 1048576
L_spin_86b:
    ds_read_b32 v255, v0 offset:224
    s_waitcnt lgkmcnt(0)
    v_cmp_gt_u32 vcc, 1, v255
    s_cbranch_vccz L_go_87
    s_sub_u32 s34, s34, 1
    s_cbranch_scc0 L_spin_86b
    s_branch L_go_87
L_spin_88:
    s_mov_b32 s34, 1048576
L_spin_88b:
    ds_read_b32 v255, v0 offset:240
    s_waitcnt lgkmcnt(0)
    v_cmp_gt_u32 vcc, 1, v255
    s_cbranch_vccz L_go_89
    s_sub_u32 s34, s34, 1
    s_cbranch_scc0 L_spin_88b
    s_branch L_go_89
L_spin_90:
    s_mov_b32 s34, 1048576
L_spin_90b:
    ds_read_b32 v255, v0 offset:128
    s_waitcnt lgkmcnt(0)
    v_cmp_gt_u32 vcc, 1, v255
    s_cbranch_vccz L_go_91
    s_sub_u32 s34, s34, 1
    s_cbranch_scc0 L_spin_90b
    s_branch L_go_91
L_spin_92:
    s_mov_b32 s34, 1048576
L_spin_92b:
    ds_read_b32 v255, v0 offset:144
    s_waitcnt lgkmcnt(0)
    v_cmp_gt_u32 vcc, 1, v255
    s_cbranch_vccz L_go_93
    s_sub_u32 s34, s34, 1
    s_cbranch_scc0 L_spin_92b
    s_branch L_go_93
L_spin_94:
    s_mov_b32 s34, 1048576
L_spin_94b:
    ds_read_b32 v255, v0 offset:160
    s_waitcnt lgkmcnt(0)
    v_cmp_gt_u32 vcc, 1, v255
    s_cbranch_vccz L_go_95
    s_sub_u32 s34, s34, 1
    s_cbranch_scc0 L_spin_94b
    s_branch L_go_95
L_spin_96:
    s_mov_b32 s34, 1048576
L_spin_96b:
    ds_read_b32 v255, v0 offset:176
    s_waitcnt lgkmcnt(0)
    v_cmp_gt_u32 vcc, 1, v255
    s_cbranch_vccz L_go_97
    s_sub_u32 s34, s34, 1
    s_cbranch_scc0 L_spin_96b
    s_branch L_go_97
L_loader:
    s_and_b32 s32, s44, 1
    s_mul_i32 s18, s32, 8448
    s_lshl_b32 s19, s32, 13
    s_lshl_b32 s0, s32, 15
    s_lshl_b32 s32, s32, 2
    v_and_b32 v204, 0xfffffffb, v8
    v_add_u32 v204, s32, v204
    s_add_u32 m0, s18, 33792
    s_add_u32 s100, s19, 0x8000
    buffer_load_dwordx4 v1, s[20:23], s100 offen offset:0 nt lds
    s_add_u32 m0, m0, 32
    s_nop 0
    buffer_load_dwordx4 v1, s[20:23], s100 offen offset:1024 nt lds
    s_add_u32 m0, m0, 32
    s_nop 0
    buffer_load_dwordx4 v1, s[20:23], s100 offen offset:2048 nt lds
    s_add_u32 m0, m0, 32
    s_nop 0
    buffer_load_dwordx4 v1, s[20:23], s100 offen offset:3072 nt lds
    s_add_u32 m0, s18, 38016
    s_add_u32 s100, s19, 0x9000
    buffer_load_dwordx4 v1, s[20:23], s100 offen offset:0 nt lds
    s_add_u32 m0, m0, 32
    s_nop 0
    buffer_load_dwordx4 v1, s[20:23], s100 offen offset:1024 nt lds
    s_add_u32 m0, m0, 32
    s_nop 0
    buffer_load_dwordx4 v1, s[20:23], s100 offen offset:2048 nt lds
    s_add_u32 m0, m0, 32
    s_nop 0
    buffer_load_dwordx4 v1, s[20:23], s100 offen offset:3072 nt lds
    s_waitcnt vmcnt(12)
    ds_read_b128 v[172:175], v248 offset:0
    ds_read_b128 v[176:179], v249 offset:0
    ds_read_b128 v[180:183], v250 offset:0
    ds_read_b128 v[184:187], v251 offset:0
    s_waitcnt lgkmcnt(0)
    v_mfma_f32_16x16x32_bf16 v[12:15], v[172:175], v[172:175], 0
    v_mfma_f32_16x16x32_bf16 v[12:15], v[176:179], v[176:179], v[12:15]
    v_mfma_f32_16x16x32_bf16 v[12:15], v[180:183], v[180:183], v[12:15]
    v_mfma_f32_16x16x32_bf16 v[12:15], v[184:187], v[184:187], v[12:15]
    s_nop 7
    v_cndmask_b32 v12, v12, v13, s[4:5]
    v_cndmask_b32 v12, v12, v14, s[6:7]
    v_cndmask_b32 v12, v12, v15, s[8:9]
    s_nop 1
    v_add_f32_dpp v12, v12, v12 quad_perm:[1,0,3,2] row_mask:0xf bank_mask:0xf
    v_fma_f32 v12, v12, s37, -4.0
    ds_write_b32 v6, v12 offset:0
    s_add_u32 m0, s18, 50688
    s_add_u32 s100, s19, 0x8000
    buffer_load_dwordx4 v1, s[28:31], s100 offen offset:0 nt lds
    s_add_u32 m0, m0, 32
    s_nop 0
    buffer_load_dwordx4 v1, s[28:31], s100 offen offset:1024 nt lds
    s_add_u32 m0, m0, 32
    s_nop 0
    buffer_load_dwordx4 v1, s[28:31], s100 offen offset:2048 nt lds
    s_add_u32 m0, m0, 32
    s_nop 0
    buffer_load_dwordx4 v1, s[28:31], s100 offen offset:3072 nt lds
    s_add_u32 m0, s18, 54912
    s_add_u32 s100, s19, 0x9000
    buffer_load_dwordx4 v1, s[28:31], s100 offen offset:0 nt lds
    s_add_u32 m0, m0, 32
    s_nop 0
    buffer_load_dwordx4 v1, s[28:31], s100 offen offset:1024 nt lds
    s_add_u32 m0, m0, 32
    s_nop 0
    buffer_load_dwordx4 v1, s[28:31], s100 offen offset:2048 nt lds
    s_add_u32 m0, m0, 32
    s_nop 0
    buffer_load_dwordx4 v1, s[28:31], s100 offen offset:3072 nt lds
    s_waitcnt vmcnt(16)
    ds_read_b128 v[172:175], v248 offset:16896
    ds_read_b128 v[176:179], v249 offset:16896
    ds_read_b128 v[180:183], v250 offset:16896
    ds_read_b128 v[184:187], v251 offset:16896
    s_waitcnt lgkmcnt(0)
    v_mfma_f32_16x16x32_bf16 v[12:15], v[172:175], v[172:175], 0
    v_mfma_f32_16x16x32_bf16 v[12:15], v[176:179], v[176:179], v[12:15]
    v_mfma_f32_16x16x32_bf16 v[12:15], v[180:183], v[180:183], v[12:15]
    v_mfma_f32_16x16x32_bf16 v[12:15], v[184:187], v[184:187], v[12:15]
    s_nop 7
    v_cndmask_b32 v12, v12, v13, s[4:5]
    v_cndmask_b32 v12, v12, v14, s[6:7]
    v_cndmask_b32 v12, v12, v15, s[8:9]
    s_nop 1
    v_add_f32_dpp v12, v12, v12 quad_perm:[1,0,3,2] row_mask:0xf bank_mask:0xf
    v_fma_f32 v12, v12, s37, -4.0
    ds_write_b32 v6, v12 offset:128
    v_mov_b32 v254, 1
    ds_write_b32 v0, v254 offset:48
    s_add_u32 m0, s18, 67584
    s_add_u32 s100, s19, 0xc000
    buffer_load_dwordx4 v1, s[20:23], s100 offen offset:0 nt lds
    s_add_u32 m0, m0, 32
    s_nop 0
    buffer_load_dwordx4 v1, s[20:23], s100 offen offset:1024 nt lds
    s_add_u32 m0, m0, 32
    s_nop 0
    buffer_load_dwordx4 v1, s[20:23], s100 offen offset:2048 nt lds
    s_add_u32 m0, m0, 32
    s_nop 0
    buffer_load_dwordx4 v1, s[20:23], s100 offen offset:3072 nt lds
    s_waitcnt vmcnt(16)
    s_add_u32 m0, s18, 71808
    s_add_u32 s100, s19, 0xd000
    buffer_load_dwordx4 v1, s[20:23], s100 offen offset:0 nt lds
    s_add_u32 m0, m0, 32
    s_nop 0
    buffer_load_dwordx4 v1, s[20:23], s100 offen offset:1024 nt lds
    s_add_u32 m0, m0, 32
    s_nop 0
    buffer_load_dwordx4 v1, s[20:23], s100 offen offset:2048 nt lds
    s_add_u32 m0, m0, 32
    s_nop 0
    buffer_load_dwordx4 v1, s[20:23], s100 offen offset:3072 nt lds
    s_waitcnt vmcnt(16)
    v_mov_b32 v254, 1
    ds_write_b32 v204, v254 offset:16
    s_mov_b32 s34, 1048576
L_lw_98:
    ds_read_b32 v255, v8 offset:0
    s_waitcnt lgkmcnt(0)
    v_cmp_gt_u32 vcc, 1, v255
    s_cbranch_vccz L_lwd_99
    s_sleep 1
    s_sub_u32 s34, s34, 1
    s_cbranch_scc0 L_lw_98
L_lwd_99:
    s_add_u32 m0, s18, 84480
    s_add_u32 s100, s19, 0x10000
    buffer_load_dwordx4 v1, s[20:23], s100 offen offset:0 nt lds
    s_add_u32 m0, m0, 32
    s_nop 0
    buffer_load_dwordx4 v1, s[20:23], s100 offen offset:1024 nt lds
    s_add_u32 m0, m0, 32
    s_nop 0
    buffer_load_dwordx4 v1, s[20:23], s100 offen offset:2048 nt lds
    s_add_u32 m0, m0, 32
    s_nop 0
    buffer_load_dwordx4 v1, s[20:23], s100 offen offset:3072 nt lds
    s_waitcnt vmcnt(16)
    s_add_u32 m0, s18, 88704
    s_add_u32 s100, s19, 0x11000
    buffer_load_dwordx4 v1, s[20:23], s100 offen offset:0 nt lds
    s_add_u32 m0, m0, 32
    s_nop 0
    buffer_load_dwordx4 v1, s[20:23], s100 offen offset:1024 nt lds
    s_add_u32 m0, m0, 32
    s_nop 0
    buffer_load_dwordx4 v1, s[20:23], s100 offen offset:2048 nt lds
    s_add_u32 m0, m0, 32
    s_nop 0
    buffer_load_dwordx4 v1, s[20:23], s100 offen offset:3072 nt lds
    s_waitcnt vmcnt(16)
    v_mov_b32 v254, 2
    ds_write_b32 v204, v254 offset:16
    s_add_u32 m0, s18, 101376
    s_add_u32 s100, s19, 0xc000
    buffer_load_dwordx4 v1, s[28:31], s100 offen offset:0 nt lds
    s_add_u32 m0, m0, 32
    s_nop 0
    buffer_load_dwordx4 v1, s[28:31], s100 offen offset:1024 nt lds
    s_add_u32 m0, m0, 32
    s_nop 0
    buffer_load_dwordx4 v1, s[28:31], s100 offen offset:2048 nt lds
    s_add_u32 m0, m0, 32
    s_nop 0
    buffer_load_dwordx4 v1, s[28:31], s100 offen offset:3072 nt lds
    s_cmp_eq_u32 s44, 2
    s_cbranch_scc0 L_notq_100
    s_mov_b32 s34, 1048576
L_lw_101:
    ds_read_b32 v255, v8 offset:16
    s_waitcnt lgkmcnt(0)
    v_cmp_gt_u32 vcc, 2, v255
    s_cbranch_vccz L_lwd_102
    s_sub_u32 s34, s34, 1
    s_cbranch_scc0 L_lw_101
L_lwd_102:
    ds_read_b128 v[16:19], v7 offset:0
    ds_read_b128 v[24:27], v7 offset:64
    ds_read_b128 v[32:35], v7 offset:128
    ds_read_b128 v[40:43], v7 offset:192
    ds_read_b128 v[48:51], v7 offset:256
    ds_read_b128 v[56:59], v7 offset:320
    ds_read_b128 v[64:67], v7 offset:384
    ds_read_b128 v[72:75], v7 offset:448
    ds_read_b128 v[20:23], v7 offset:8448
    ds_read_b128 v[28:31], v7 offset:8512
    ds_read_b128 v[36:39], v7 offset:8576
    ds_read_b128 v[44:47], v7 offset:8640
    ds_read_b128 v[52:55], v7 offset:8704
    ds_read_b128 v[60:63], v7 offset:8768
    ds_read_b128 v[68:71], v7 offset:8832
    ds_read_b128 v[76:79], v7 offset:8896
    v_mov_b32 v254, 1
    ds_write_b32 v0, v254 offset:64
L_notq_100:
    s_waitcnt vmcnt(16)
    s_add_u32 m0, s18, 105600
    s_add_u32 s100, s19, 0xd000
    buffer_load_dwordx4 v1, s[28:31], s100 offen offset:0 nt lds
    s_add_u32 m0, m0, 32
    s_nop 0
    buffer_load_dwordx4 v1, s[28:31], s100 offen offset:1024 nt lds
    s_add_u32 m0, m0, 32
    s_nop 0
    buffer_load_dwordx4 v1, s[28:31], s100 offen offset:2048 nt lds
    s_add_u32 m0, m0, 32
    s_nop 0
    buffer_load_dwordx4 v1, s[28:31], s100 offen offset:3072 nt lds
    s_waitcnt vmcnt(16)
    v_mov_b32 v254, 3
    ds_write_b32 v204, v254 offset:16
    v_mov_b32 v144, 0x25808
    s_mov_b32 s34, 1048576
L_lw_103:
    ds_read_b32 v255, v144 offset:64
    s_waitcnt lgkmcnt(0)
    v_cmp_gt_u32 vcc, 1, v255
    s_cbranch_vccz L_lwd_104
    s_sleep 1
    s_sub_u32 s34, s34, 1
    s_cbranch_scc0 L_lw_103
L_lwd_104:
    s_add_u32 m0, s18, 50688
    s_add_u32 s100, s19, 0x14000
    buffer_load_dwordx4 v1, s[20:23], s100 offen offset:0 nt lds
    s_add_u32 m0, m0, 32
    s_nop 0
    buffer_load_dwordx4 v1, s[20:23], s100 offen offset:1024 nt lds
    s_add_u32 m0, m0, 32
    s_nop 0
    buffer_load_dwordx4 v1, s[20:23], s100 offen offset:2048 nt lds
    s_add_u32 m0, m0, 32
    s_nop 0
    buffer_load_dwordx4 v1, s[20:23], s100 offen offset:3072 nt lds
    s_waitcnt vmcnt(16)
    s_add_u32 m0, s18, 54912
    s_add_u32 s100, s19, 0x15000
    buffer_load_dwordx4 v1, s[20:23], s100 offen offset:0 nt lds
    s_add_u32 m0, m0, 32
    s_nop 0
    buffer_load_dwordx4 v1, s[20:23], s100 offen offset:1024 nt lds
    s_add_u32 m0, m0, 32
    s_nop 0
    buffer_load_dwordx4 v1, s[20:23], s100 offen offset:2048 nt lds
    s_add_u32 m0, m0, 32
    s_nop 0
    buffer_load_dwordx4 v1, s[20:23], s100 offen offset:3072 nt lds
    s_waitcnt vmcnt(16)
    v_mov_b32 v254, 4
    ds_write_b32 v204, v254 offset:16
    s_add_u32 m0, s18, 118272
    s_add_u32 s100, s19, 0x18000
    buffer_load_dwordx4 v1, s[20:23], s100 offen offset:0 nt lds
    s_add_u32 m0, m0, 32
    s_nop 0
    buffer_load_dwordx4 v1, s[20:23], s100 offen offset:1024 nt lds
    s_add_u32 m0, m0, 32
    s_nop 0
    buffer_load_dwordx4 v1, s[20:23], s100 offen offset:2048 nt lds
    s_add_u32 m0, m0, 32
    s_nop 0
    buffer_load_dwordx4 v1, s[20:23], s100 offen offset:3072 nt lds
    s_waitcnt vmcnt(16)
    s_add_u32 m0, s18, 122496
    s_add_u32 s100, s19, 0x19000
    buffer_load_dwordx4 v1, s[20:23], s100 offen offset:0 nt lds
    s_add_u32 m0, m0, 32
    s_nop 0
    buffer_load_dwordx4 v1, s[20:23], s100 offen offset:1024 nt lds
    s_add_u32 m0, m0, 32
    s_nop 0
    buffer_load_dwordx4 v1, s[20:23], s100 offen offset:2048 nt lds
    s_add_u32 m0, m0, 32
    s_nop 0
    buffer_load_dwordx4 v1, s[20:23], s100 offen offset:3072 nt lds
    s_waitcnt vmcnt(16)
    v_mov_b32 v254, 5
    ds_write_b32 v204, v254 offset:16
    s_add_u32 m0, s18, 135168
    s_add_u32 s100, s19, 0x0
    buffer_load_dwordx4 v1, s[28:31], s100 offen offset:0 nt lds
    s_add_u32 m0, m0, 32
    s_nop 0
    buffer_load_dwordx4 v1, s[28:31], s100 offen offset:1024 nt lds
    s_add_u32 m0, m0, 32
    s_nop 0
    buffer_load_dwordx4 v1, s[28:31], s100 offen offset:2048 nt lds
    s_add_u32 m0, m0, 32
    s_nop 0
    buffer_load_dwordx4 v1, s[28:31], s100 offen offset:3072 nt lds
    s_cmp_eq_u32 s44, 3
    s_cbranch_scc0 L_notq_105
    s_mov_b32 s34, 1048576
L_lw_106:
    ds_read_b32 v255, v8 offset:16
    s_waitcnt lgkmcnt(0)
    v_cmp_gt_u32 vcc, 5, v255
    s_cbranch_vccz L_lwd_107
    s_sub_u32 s34, s34, 1
    s_cbranch_scc0 L_lw_106
L_lwd_107:
    ds_read_b128 v[16:19], v7 offset:0
    ds_read_b128 v[24:27], v7 offset:64
    ds_read_b128 v[32:35], v7 offset:128
    ds_read_b128 v[40:43], v7 offset:192
    ds_read_b128 v[48:51], v7 offset:256
    ds_read_b128 v[56:59], v7 offset:320
    ds_read_b128 v[64:67], v7 offset:384
    ds_read_b128 v[72:75], v7 offset:448
    ds_read_b128 v[20:23], v7 offset:8448
    ds_read_b128 v[28:31], v7 offset:8512
    ds_read_b128 v[36:39], v7 offset:8576
    ds_read_b128 v[44:47], v7 offset:8640
    ds_read_b128 v[52:55], v7 offset:8704
    ds_read_b128 v[60:63], v7 offset:8768
    ds_read_b128 v[68:71], v7 offset:8832
    ds_read_b128 v[76:79], v7 offset:8896
    v_mov_b32 v254, 1
    ds_write_b32 v0, v254 offset:64
L_notq_105:
    s_waitcnt vmcnt(16)
    s_add_u32 m0, s18, 139392
    s_add_u32 s100, s19, 0x1000
    buffer_load_dwordx4 v1, s[28:31], s100 offen offset:0 nt lds
    s_add_u32 m0, m0, 32
    s_nop 0
    buffer_load_dwordx4 v1, s[28:31], s100 offen offset:1024 nt lds
    s_add_u32 m0, m0, 32
    s_nop 0
    buffer_load_dwordx4 v1, s[28:31], s100 offen offset:2048 nt lds
    s_add_u32 m0, m0, 32
    s_nop 0
    buffer_load_dwordx4 v1, s[28:31], s100 offen offset:3072 nt lds
    s_waitcnt vmcnt(16)
    v_mov_b32 v254, 6
    ds_write_b32 v204, v254 offset:16
    v_mov_b32 v144, 0x2580c
    s_mov_b32 s34, 1048576
L_lw_108:
    ds_read_b32 v255, v144 offset:64
    s_waitcnt lgkmcnt(0)
    v_cmp_gt_u32 vcc, 1, v255
    s_cbranch_vccz L_lwd_109
    s_sleep 1
    s_sub_u32 s34, s34, 1
    s_cbranch_scc0 L_lw_108
L_lwd_109:
    s_add_u32 m0, s18, 101376
    s_add_u32 s100, s19, 0x1c000
    buffer_load_dwordx4 v1, s[20:23], s100 offen offset:0 nt lds
    s_add_u32 m0, m0, 32
    s_nop 0
    buffer_load_dwordx4 v1, s[20:23], s100 offen offset:1024 nt lds
    s_add_u32 m0, m0, 32
    s_nop 0
    buffer_load_dwordx4 v1, s[20:23], s100 offen offset:2048 nt lds
    s_add_u32 m0, m0, 32
    s_nop 0
    buffer_load_dwordx4 v1, s[20:23], s100 offen offset:3072 nt lds
    s_waitcnt vmcnt(16)
    s_add_u32 m0, s18, 105600
    s_add_u32 s100, s19, 0x1d000
    buffer_load_dwordx4 v1, s[20:23], s100 offen offset:0 nt lds
    s_add_u32 m0, m0, 32
    s_nop 0
    buffer_load_dwordx4 v1, s[20:23], s100 offen offset:1024 nt lds
    s_add_u32 m0, m0, 32
    s_nop 0
    buffer_load_dwordx4 v1, s[20:23], s100 offen offset:2048 nt lds
    s_add_u32 m0, m0, 32
    s_nop 0
    buffer_load_dwordx4 v1, s[20:23], s100 offen offset:3072 nt lds
    s_waitcnt vmcnt(16)
    v_mov_b32 v254, 7
    ds_write_b32 v204, v254 offset:16
    s_mov_b32 s34, 1048576
L_lw_110:
    ds_read_b32 v255, v8 offset:0
    s_waitcnt lgkmcnt(0)
    v_cmp_gt_u32 vcc, 2, v255
    s_cbranch_vccz L_lwd_111
    s_sleep 1
    s_sub_u32 s34, s34, 1
    s_cbranch_scc0 L_lw_110
L_lwd_111:
    s_add_u32 m0, s19, 0
    s_add_u32 s100, s0, 0x0
    buffer_load_dwordx4 v200, s[24:27], s100 offen offset:0 nt lds
    buffer_load_dwordx4 v201, s[24:27], s100 offen offset:1024 nt lds
    buffer_load_dwordx4 v202, s[24:27], s100 offen offset:2048 nt lds
    buffer_load_dwordx4 v203, s[24:27], s100 offen offset:3072 nt lds
    s_waitcnt vmcnt(16)
    s_add_u32 m0, s19, 4096
    s_add_u32 s100, s0, 0x4000
    buffer_load_dwordx4 v200, s[24:27], s100 offen offset:0 nt lds
    buffer_load_dwordx4 v201, s[24:27], s100 offen offset:1024 nt lds
    buffer_load_dwordx4 v202, s[24:27], s100 offen offset:2048 nt lds
    buffer_load_dwordx4 v203, s[24:27], s100 offen offset:3072 nt lds
    s_waitcnt vmcnt(16)
    v_mov_b32 v254, 8
    ds_write_b32 v204, v254 offset:16
    s_mov_b32 s34, 1048576
L_lw_112:
    ds_read_b32 v255, v8 offset:0
    s_waitcnt lgkmcnt(0)
    v_cmp_gt_u32 vcc, 3, v255
    s_cbranch_vccz L_lwd_113
    s_sleep 1
    s_sub_u32 s34, s34, 1
    s_cbranch_scc0 L_lw_112
L_lwd_113:
    s_add_u32 m0, s18, 16896
    s_add_u32 s100, s19, 0x4000
    buffer_load_dwordx4 v1, s[28:31], s100 offen offset:0 nt lds
    s_add_u32 m0, m0, 32
    s_nop 0
    buffer_load_dwordx4 v1, s[28:31], s100 offen offset:1024 nt lds
    s_add_u32 m0, m0, 32
    s_nop 0
    buffer_load_dwordx4 v1, s[28:31], s100 offen offset:2048 nt lds
    s_add_u32 m0, m0, 32
    s_nop 0
    buffer_load_dwordx4 v1, s[28:31], s100 offen offset:3072 nt lds
    s_waitcnt vmcnt(16)
    s_add_u32 m0, s18, 21120
    s_add_u32 s100, s19, 0x5000
    buffer_load_dwordx4 v1, s[28:31], s100 offen offset:0 nt lds
    s_add_u32 m0, m0, 32
    s_nop 0
    buffer_load_dwordx4 v1, s[28:31], s100 offen offset:1024 nt lds
    s_add_u32 m0, m0, 32
    s_nop 0
    buffer_load_dwordx4 v1, s[28:31], s100 offen offset:2048 nt lds
    s_add_u32 m0, m0, 32
    s_nop 0
    buffer_load_dwordx4 v1, s[28:31], s100 offen offset:3072 nt lds
    s_waitcnt vmcnt(16)
    v_mov_b32 v254, 9
    ds_write_b32 v204, v254 offset:16
    v_mov_b32 v144, 0x25800
    s_mov_b32 s34, 1048576
L_lw_114:
    ds_read_b32 v255, v144 offset:64
    s_waitcnt lgkmcnt(0)
    v_cmp_gt_u32 vcc, 1, v255
    s_cbranch_vccz L_lwd_115
    s_sleep 1
    s_sub_u32 s34, s34, 1
    s_cbranch_scc0 L_lw_114
L_lwd_115:
    s_add_u32 m0, s19, 135168
    s_add_u32 s100, s0, 0x10000
    buffer_load_dwordx4 v200, s[24:27], s100 offen offset:0 nt lds
    buffer_load_dwordx4 v201, s[24:27], s100 offen offset:1024 nt lds
    buffer_load_dwordx4 v202, s[24:27], s100 offen offset:2048 nt lds
    buffer_load_dwordx4 v203, s[24:27], s100 offen offset:3072 nt lds
    s_waitcnt vmcnt(16)
    s_add_u32 m0, s19, 139264
    s_add_u32 s100, s0, 0x14000
    buffer_load_dwordx4 v200, s[24:27], s100 offen offset:0 nt lds
    buffer_load_dwordx4 v201, s[24:27], s100 offen offset:1024 nt lds
    buffer_load_dwordx4 v202, s[24:27], s100 offen offset:2048 nt lds
    buffer_load_dwordx4 v203, s[24:27], s100 offen offset:3072 nt lds
    s_waitcnt vmcnt(16)
    v_mov_b32 v254, 10
    ds_write_b32 v204, v254 offset:16
    s_mov_b32 s34, 1048576
L_lw_116:
    ds_read_b32 v255, v8 offset:0
    s_waitcnt lgkmcnt(0)
    v_cmp_gt_u32 vcc, 4, v255
    s_cbranch_vccz L_lwd_117
    s_sleep 1
    s_sub_u32 s34, s34, 1
    s_cbranch_scc0 L_lw_116
L_lwd_117:
    s_add_u32 m0, s19, 33792
    s_add_u32 s100, s0, 0x80
    buffer_load_dwordx4 v200, s[24:27], s100 offen offset:0 nt lds
    buffer_load_dwordx4 v201, s[24:27], s100 offen offset:1024 nt lds
    buffer_load_dwordx4 v202, s[24:27], s100 offen offset:2048 nt lds
    buffer_load_dwordx4 v203, s[24:27], s100 offen offset:3072 nt lds
    s_waitcnt vmcnt(16)
    s_add_u32 m0, s19, 37888
    s_add_u32 s100, s0, 0x4080
    buffer_load_dwordx4 v200, s[24:27], s100 offen offset:0 nt lds
    buffer_load_dwordx4 v201, s[24:27], s100 offen offset:1024 nt lds
    buffer_load_dwordx4 v202, s[24:27], s100 offen offset:2048 nt lds
    buffer_load_dwordx4 v203, s[24:27], s100 offen offset:3072 nt lds
    s_waitcnt vmcnt(16)
    v_mov_b32 v254, 11
    ds_write_b32 v204, v254 offset:16
    s_mov_b32 s34, 1048576
L_lw_118:
    ds_read_b32 v255, v8 offset:0
    s_waitcnt lgkmcnt(0)
    v_cmp_gt_u32 vcc, 5, v255
    s_cbranch_vccz L_lwd_119
    s_sleep 1
    s_sub_u32 s34, s34, 1
    s_cbranch_scc0 L_lw_118
L_lwd_119:
    s_add_u32 m0, s19, 67584
    s_add_u32 s100, s0, 0x10080
    buffer_load_dwordx4 v200, s[24:27], s100 offen offset:0 nt lds
    buffer_load_dwordx4 v201, s[24:27], s100 offen offset:1024 nt lds
    buffer_load_dwordx4 v202, s[24:27], s100 offen offset:2048 nt lds
    buffer_load_dwordx4 v203, s[24:27], s100 offen offset:3072 nt lds
    s_waitcnt vmcnt(16)
    s_add_u32 m0, s19, 71680
    s_add_u32 s100, s0, 0x14080
    buffer_load_dwordx4 v200, s[24:27], s100 offen offset:0 nt lds
    buffer_load_dwordx4 v201, s[24:27], s100 offen offset:1024 nt lds
    buffer_load_dwordx4 v202, s[24:27], s100 offen offset:2048 nt lds
    buffer_load_dwordx4 v203, s[24:27], s100 offen offset:3072 nt lds
    s_waitcnt vmcnt(16)
    v_mov_b32 v254, 12
    ds_write_b32 v204, v254 offset:16
    v_mov_b32 v144, 0x25804
    s_mov_b32 s34, 1048576
L_lw_120:
    ds_read_b32 v255, v144 offset:64
    s_waitcnt lgkmcnt(0)
    v_cmp_gt_u32 vcc, 1, v255
    s_cbranch_vccz L_lwd_121
    s_sleep 1
    s_sub_u32 s34, s34, 1
    s_cbranch_scc0 L_lw_120
L_lwd_121:
    s_add_u32 m0, s19, 16896
    s_add_u32 s100, s0, 0x100
    buffer_load_dwordx4 v200, s[24:27], s100 offen offset:0 nt lds
    buffer_load_dwordx4 v201, s[24:27], s100 offen offset:1024 nt lds
    buffer_load_dwordx4 v202, s[24:27], s100 offen offset:2048 nt lds
    buffer_load_dwordx4 v203, s[24:27], s100 offen offset:3072 nt lds
    s_waitcnt vmcnt(16)
    s_add_u32 m0, s19, 20992
    s_add_u32 s100, s0, 0x4100
    buffer_load_dwordx4 v200, s[24:27], s100 offen offset:0 nt lds
    buffer_load_dwordx4 v201, s[24:27], s100 offen offset:1024 nt lds
    buffer_load_dwordx4 v202, s[24:27], s100 offen offset:2048 nt lds
    buffer_load_dwordx4 v203, s[24:27], s100 offen offset:3072 nt lds
    s_waitcnt vmcnt(16)
    v_mov_b32 v254, 13
    ds_write_b32 v204, v254 offset:16
    s_waitcnt vmcnt(12)
    s_mov_b32 s34, 1048576
L_lw_122:
    ds_read_b32 v255, v8 offset:0
    s_waitcnt lgkmcnt(0)
    v_cmp_gt_u32 vcc, 6, v255
    s_cbranch_vccz L_lwd_123
    s_sleep 1
    s_sub_u32 s34, s34, 1
    s_cbranch_scc0 L_lw_122
L_lwd_123:
    s_add_u32 m0, s19, 84480
    s_add_u32 s100, s0, 0x10100
    buffer_load_dwordx4 v200, s[24:27], s100 offen offset:0 nt lds
    buffer_load_dwordx4 v201, s[24:27], s100 offen offset:1024 nt lds
    buffer_load_dwordx4 v202, s[24:27], s100 offen offset:2048 nt lds
    buffer_load_dwordx4 v203, s[24:27], s100 offen offset:3072 nt lds
    s_waitcnt vmcnt(12)
    v_mov_b32 v254, 14
    ds_write_b32 v204, v254 offset:16
    s_add_u32 m0, s19, 88576
    s_add_u32 s100, s0, 0x14100
    buffer_load_dwordx4 v200, s[24:27], s100 offen offset:0 nt lds
    buffer_load_dwordx4 v201, s[24:27], s100 offen offset:1024 nt lds
    buffer_load_dwordx4 v202, s[24:27], s100 offen offset:2048 nt lds
    buffer_load_dwordx4 v203, s[24:27], s100 offen offset:3072 nt lds
    s_waitcnt vmcnt(12)
    s_mov_b32 s34, 1048576
L_lw_124:
    ds_read_b32 v255, v8 offset:0
    s_waitcnt lgkmcnt(0)
    v_cmp_gt_u32 vcc, 7, v255
    s_cbranch_vccz L_lwd_125
    s_sleep 1
    s_sub_u32 s34, s34, 1
    s_cbranch_scc0 L_lw_124
L_lwd_125:
    s_add_u32 m0, s19, 50688
    s_add_u32 s100, s0, 0x180
    buffer_load_dwordx4 v200, s[24:27], s100 offen offset:0 nt lds
    buffer_load_dwordx4 v201, s[24:27], s100 offen offset:1024 nt lds
    buffer_load_dwordx4 v202, s[24:27], s100 offen offset:2048 nt lds
    buffer_load_dwordx4 v203, s[24:27], s100 offen offset:3072 nt lds
    s_waitcnt vmcnt(12)
    v_mov_b32 v254, 15
    ds_write_b32 v204, v254 offset:16
    s_add_u32 m0, s19, 54784
    s_add_u32 s100, s0, 0x4180
    buffer_load_dwordx4 v200, s[24:27], s100 offen offset:0 nt lds
    buffer_load_dwordx4 v201, s[24:27], s100 offen offset:1024 nt lds
    buffer_load_dwordx4 v202, s[24:27], s100 offen offset:2048 nt lds
    buffer_load_dwordx4 v203, s[24:27], s100 offen offset:3072 nt lds
    s_waitcnt vmcnt(12)
    s_mov_b32 s34, 1048576
L_lw_126:
    ds_read_b32 v255, v8 offset:0
    s_waitcnt lgkmcnt(0)
    v_cmp_gt_u32 vcc, 8, v255
    s_cbranch_vccz L_lwd_127
    s_sleep 1
    s_sub_u32 s34, s34, 1
    s_cbranch_scc0 L_lw_126
L_lwd_127:
    s_add_u32 m0, s19, 118272
    s_add_u32 s100, s0, 0x10180
    buffer_load_dwordx4 v200, s[24:27], s100 offen offset:0 nt lds
    buffer_load_dwordx4 v201, s[24:27], s100 offen offset:1024 nt lds
    buffer_load_dwordx4 v202, s[24:27], s100 offen offset:2048 nt lds
    buffer_load_dwordx4 v203, s[24:27], s100 offen offset:3072 nt lds
    s_waitcnt vmcnt(12)
    v_mov_b32 v254, 16
    ds_write_b32 v204, v254 offset:16
    s_add_u32 m0, s19, 122368
    s_add_u32 s100, s0, 0x14180
    buffer_load_dwordx4 v200, s[24:27], s100 offen offset:0 nt lds
    buffer_load_dwordx4 v201, s[24:27], s100 offen offset:1024 nt lds
    buffer_load_dwordx4 v202, s[24:27], s100 offen offset:2048 nt lds
    buffer_load_dwordx4 v203, s[24:27], s100 offen offset:3072 nt lds
    s_waitcnt vmcnt(12)
    s_mov_b32 s34, 1048576
L_lw_128:
    ds_read_b32 v255, v8 offset:0
    s_waitcnt lgkmcnt(0)
    v_cmp_gt_u32 vcc, 9, v255
    s_cbranch_vccz L_lwd_129
    s_sleep 1
    s_sub_u32 s34, s34, 1
    s_cbranch_scc0 L_lw_128
L_lwd_129:
    s_add_u32 m0, s18, 101376
    s_add_u32 s100, s19, 0x0
    buffer_load_dwordx4 v1, s[48:51], s100 offen offset:0 lds
    s_add_u32 m0, m0, 32
    s_nop 0
    buffer_load_dwordx4 v1, s[48:51], s100 offen offset:1024 lds
    s_add_u32 m0, m0, 32
    s_nop 0
    buffer_load_dwordx4 v1, s[48:51], s100 offen offset:2048 lds
    s_add_u32 m0, m0, 32
    s_nop 0
    buffer_load_dwordx4 v1, s[48:51], s100 offen offset:3072 lds
    s_waitcnt vmcnt(12)
    v_mov_b32 v254, 17
    ds_write_b32 v204, v254 offset:16
    s_add_u32 m0, s18, 105600
    s_add_u32 s100, s19, 0x1000
    buffer_load_dwordx4 v1, s[48:51], s100 offen offset:0 lds
    s_add_u32 m0, m0, 32
    s_nop 0
    buffer_load_dwordx4 v1, s[48:51], s100 offen offset:1024 lds
    s_add_u32 m0, m0, 32
    s_nop 0
    buffer_load_dwordx4 v1, s[48:51], s100 offen offset:2048 lds
    s_add_u32 m0, m0, 32
    s_nop 0
    buffer_load_dwordx4 v1, s[48:51], s100 offen offset:3072 lds
    s_waitcnt vmcnt(12)
    s_mov_b32 s34, 1048576
L_lw_130:
    ds_read_b32 v255, v8 offset:0
    s_waitcnt lgkmcnt(0)
    v_cmp_gt_u32 vcc, 10, v255
    s_cbranch_vccz L_lwd_131
    s_sleep 1
    s_sub_u32 s34, s34, 1
    s_cbranch_scc0 L_lw_130
L_lwd_131:
    s_add_u32 m0, s18, 0
    s_add_u32 s100, s19, 0x4000
    buffer_load_dwordx4 v1, s[48:51], s100 offen offset:0 lds
    s_add_u32 m0, m0, 32
    s_nop 0
    buffer_load_dwordx4 v1, s[48:51], s100 offen offset:1024 lds
    s_add_u32 m0, m0, 32
    s_nop 0
    buffer_load_dwordx4 v1, s[48:51], s100 offen offset:2048 lds
    s_add_u32 m0, m0, 32
    s_nop 0
    buffer_load_dwordx4 v1, s[48:51], s100 offen offset:3072 lds
    s_waitcnt vmcnt(12)
    v_mov_b32 v254, 18
    ds_write_b32 v204, v254 offset:16
    s_add_u32 m0, s18, 4224
    s_add_u32 s100, s19, 0x5000
    buffer_load_dwordx4 v1, s[48:51], s100 offen offset:0 lds
    s_add_u32 m0, m0, 32
    s_nop 0
    buffer_load_dwordx4 v1, s[48:51], s100 offen offset:1024 lds
    s_add_u32 m0, m0, 32
    s_nop 0
    buffer_load_dwordx4 v1, s[48:51], s100 offen offset:2048 lds
    s_add_u32 m0, m0, 32
    s_nop 0
    buffer_load_dwordx4 v1, s[48:51], s100 offen offset:3072 lds
    s_waitcnt vmcnt(12)
    s_mov_b32 s34, 1048576
L_lw_132:
    ds_read_b32 v255, v8 offset:0
    s_waitcnt lgkmcnt(0)
    v_cmp_gt_u32 vcc, 11, v255
    s_cbranch_vccz L_lwd_133
    s_sleep 1
    s_sub_u32 s34, s34, 1
    s_cbranch_scc0 L_lw_132
L_lwd_133:
    s_add_u32 m0, s18, 135168
    s_add_u32 s100, s19, 0x8000
    buffer_load_dwordx4 v1, s[48:51], s100 offen offset:0 lds
    s_add_u32 m0, m0, 32
    s_nop 0
    buffer_load_dwordx4 v1, s[48:51], s100 offen offset:1024 lds
    s_add_u32 m0, m0, 32
    s_nop 0
    buffer_load_dwordx4 v1, s[48:51], s100 offen offset:2048 lds
    s_add_u32 m0, m0, 32
    s_nop 0
    buffer_load_dwordx4 v1, s[48:51], s100 offen offset:3072 lds
    s_waitcnt vmcnt(12)
    v_mov_b32 v254, 19
    ds_write_b32 v204, v254 offset:16
    s_add_u32 m0, s18, 139392
    s_add_u32 s100, s19, 0x9000
    buffer_load_dwordx4 v1, s[48:51], s100 offen offset:0 lds
    s_add_u32 m0, m0, 32
    s_nop 0
    buffer_load_dwordx4 v1, s[48:51], s100 offen offset:1024 lds
    s_add_u32 m0, m0, 32
    s_nop 0
    buffer_load_dwordx4 v1, s[48:51], s100 offen offset:2048 lds
    s_add_u32 m0, m0, 32
    s_nop 0
    buffer_load_dwordx4 v1, s[48:51], s100 offen offset:3072 lds
    s_waitcnt vmcnt(12)
    s_mov_b32 s34, 1048576
L_lw_134:
    ds_read_b32 v255, v8 offset:0
    s_waitcnt lgkmcnt(0)
    v_cmp_gt_u32 vcc, 12, v255
    s_cbranch_vccz L_lwd_135
    s_sleep 1
    s_sub_u32 s34, s34, 1
    s_cbranch_scc0 L_lw_134
L_lwd_135:
    s_add_u32 m0, s18, 33792
    s_add_u32 s100, s19, 0xc000
    buffer_load_dwordx4 v1, s[48:51], s100 offen offset:0 lds
    s_add_u32 m0, m0, 32
    s_nop 0
    buffer_load_dwordx4 v1, s[48:51], s100 offen offset:1024 lds
    s_add_u32 m0, m0, 32
    s_nop 0
    buffer_load_dwordx4 v1, s[48:51], s100 offen offset:2048 lds
    s_add_u32 m0, m0, 32
    s_nop 0
    buffer_load_dwordx4 v1, s[48:51], s100 offen offset:3072 lds
    s_waitcnt vmcnt(12)
    v_mov_b32 v254, 20
    ds_write_b32 v204, v254 offset:16
    s_add_u32 m0, s18, 38016
    s_add_u32 s100, s19, 0xd000
    buffer_load_dwordx4 v1, s[48:51], s100 offen offset:0 lds
    s_add_u32 m0, m0, 32
    s_nop 0
    buffer_load_dwordx4 v1, s[48:51], s100 offen offset:1024 lds
    s_add_u32 m0, m0, 32
    s_nop 0
    buffer_load_dwordx4 v1, s[48:51], s100 offen offset:2048 lds
    s_add_u32 m0, m0, 32
    s_nop 0
    buffer_load_dwordx4 v1, s[48:51], s100 offen offset:3072 lds
    s_waitcnt vmcnt(8)
    v_mov_b32 v254, 21
    ds_write_b32 v204, v254 offset:16
    s_waitcnt vmcnt(0)
    v_mov_b32 v254, 22
    ds_write_b32 v204, v254 offset:16
    v_mov_b32 v216, 0
    v_mov_b32 v217, 0
    v_mov_b32 v218, 0
    v_mov_b32 v11, 0
    s_branch L_qfin
L_fastend:
L_slow1:
    s_nop 7
    s_waitcnt lgkmcnt(7)
    v_mfma_f32_16x16x32_bf16 v[144:147], v[120:123], v[224:227], v[144:147]
    ds_read_b64_tr_b16 v[220:221], v251 offset:41984
    v_mfma_f32_16x16x32_bf16 v[148:151], v[124:127], v[224:227], v[148:151]
    ds_read_b64_tr_b16 v[222:223], v251 offset:44032
    v_mfma_f32_16x16x32_bf16 v[16:19], v[128:131], v[24:27], v[16:19]
    v_mfma_f32_16x16x32_bf16 v[20:23], v[132:135], v[24:27], v[20:23]
    v_mfma_f32_16x16x32_bf16 v[152:155], v[120:123], v[228:231], v[152:155]
    ds_read_b64_tr_b16 v[224:225], v248 offset:46080
    ds_read_b64_tr_b16 v[226:227], v248 offset:48128
    v_mfma_f32_16x16x32_bf16 v[156:159], v[124:127], v[228:231], v[156:159]
    v_mfma_f32_16x16x32_bf16 v[160:163], v[120:123], v[232:235], v[160:163]
    ds_read_b64_tr_b16 v[228:229], v249 offset:46080
    ds_read_b64_tr_b16 v[230:231], v249 offset:48128
    v_mfma_f32_16x16x32_bf16 v[164:167], v[124:127], v[232:235], v[164:167]
    v_add_u32 v248, 0x0, v3
    v_mfma_f32_16x16x32_bf16 v[168:171], v[120:123], v[236:239], v[168:171]
    ds_read_b64_tr_b16 v[232:233], v250 offset:46080
    ds_read_b64_tr_b16 v[234:235], v250 offset:48128
    v_mfma_f32_16x16x32_bf16 v[172:175], v[124:127], v[236:239], v[172:175]
    s_waitcnt lgkmcnt(6)
    v_mfma_f32_16x16x32_bf16 v[144:147], v[128:131], v[208:211], v[144:147]
    ds_read_b64_tr_b16 v[236:237], v251 offset:46080
    v_cmp_gt_u32 vcc, 14, v255
    v_mfma_f32_16x16x32_bf16 v[148:151], v[132:135], v[208:211], v[148:151]
    ds_read_b64_tr_b16 v[238:239], v251 offset:48128
    s_cbranch_vccnz L_spin_136
L_go_137:
    v_mfma_f32_16x16x32_bf16 v[152:155], v[128:131], v[212:215], v[152:155]
    ds_read_b64_tr_b16 v[208:209], v248 offset:33792
    ds_read_b64_tr_b16 v[210:211], v248 offset:35840
    v_mfma_f32_16x16x32_bf16 v[156:159], v[132:135], v[212:215], v[156:159]
    v_xor_b32 v249, 32, v248
    v_xor_b32 v250, 64, v248
    v_mfma_f32_16x16x32_bf16 v[160:163], v[128:131], v[216:219], v[160:163]
    ds_read_b64_tr_b16 v[212:213], v249 offset:33792
    v_xor_b32 v251, 96, v248
    v_mfma_f32_16x16x32_bf16 v[164:167], v[132:135], v[216:219], v[164:167]
    ds_read_b64_tr_b16 v[214:215], v249 offset:35840
    v_mov_b32 v254, 11
    v_mfma_f32_16x16x32_bf16 v[168:171], v[128:131], v[220:223], v[168:171]
    ds_read_b64_tr_b16 v[216:217], v250 offset:33792
    ds_write_b32 v0, v254 offset:0
    v_mfma_f32_16x16x32_bf16 v[172:175], v[132:135], v[220:223], v[172:175]
    ds_read_b64_tr_b16 v[218:219], v250 offset:35840
    s_waitcnt lgkmcnt(7)
    v_mfma_f32_16x16x32_bf16 v[144:147], v[136:139], v[224:227], v[144:147]
    ds_read_b64_tr_b16 v[220:221], v251 offset:33792
    v_mfma_f32_16x16x32_bf16 v[148:151], v[140:143], v[224:227], v[148:151]
    ds_read_b64_tr_b16 v[222:223], v251 offset:35840
    v_mfma_f32_16x16x32_bf16 v[152:155], v[136:139], v[228:231], v[152:155]
    ds_read_b64_tr_b16 v[224:225], v248 offset:37888
    v_mfma_f32_16x16x32_bf16 v[156:159], v[140:143], v[228:231], v[156:159]
    ds_read_b64_tr_b16 v[226:227], v248 offset:39936
    v_mfma_f32_16x16x32_bf16 v[16:19], v[136:139], v[24:27], v[16:19]
    v_mfma_f32_16x16x32_bf16 v[20:23], v[140:143], v[24:27], v[20:23]
    v_mfma_f32_16x16x32_bf16 v[160:163], v[136:139], v[232:235], v[160:163]
    ds_read_b64_tr_b16 v[228:229], v249 offset:37888
    v_mfma_f32_16x16x32_bf16 v[164:167], v[140:143], v[232:235], v[164:167]
    ds_read_b64_tr_b16 v[230:231], v249 offset:39936
    v_mfma_f32_16x16x32_bf16 v[168:171], v[136:139], v[236:239], v[168:171]
    ds_read_b64_tr_b16 v[232:233], v250 offset:37888
    v_mfma_f32_16x16x32_bf16 v[172:175], v[140:143], v[236:239], v[172:175]
    ds_read_b64_tr_b16 v[234:235], v250 offset:39936
    s_waitcnt lgkmcnt(6)
    v_mfma_f32_16x16x32_bf16 v[176:179], v[80:83], v[208:211], 0
    ds_read_b64_tr_b16 v[236:237], v251 offset:37888
    buffer_store_dwordx4 v[16:19], v4, s[60:63], s14 offen offset:0 sc1
    v_mfma_f32_16x16x32_bf16 v[180:183], v[84:87], v[208:211], 0
    ds_read_b64_tr_b16 v[238:239], v251 offset:39936
    buffer_store_dwordx4 v[20:23], v4, s[60:63], s14 offen offset:64 sc1
    v_mfma_f32_16x16x32_bf16 v[184:187], v[80:83], v[212:215], 0
    ds_read_b64_tr_b16 v[208:209], v248 offset:41984
    v_mfma_f32_16x16x32_bf16 v[188:191], v[84:87], v[212:215], 0
    ds_read_b64_tr_b16 v[210:211], v248 offset:44032
    v_mfma_f32_16x16x32_bf16 v[192:195], v[80:83], v[216:219], 0
    ds_read_b64_tr_b16 v[212:213], v249 offset:41984
    v_cvt_pk_bf16_f32 v144, v144, v145
    v_cvt_pk_bf16_f32 v145, v146, v147
    v_mfma_f32_16x16x32_bf16 v[196:199], v[84:87], v[216:219], 0
    ds_read_b64_tr_b16 v[214:215], v249 offset:44032
    v_cvt_pk_bf16_f32 v146, v148, v149
    v_mfma_f32_16x16x32_bf16 v[200:203], v[80:83], v[220:223], 0
    ds_read_b64_tr_b16 v[216:217], v250 offset:41984
    v_cvt_pk_bf16_f32 v147, v150, v151
    v_mfma_f32_16x16x32_bf16 v[204:207], v[84:87], v[220:223], 0
    ds_read_b64_tr_b16 v[218:219], v250 offset:44032
    s_waitcnt lgkmcnt(6)
    v_mfma_f32_16x16x32_bf16 v[176:179], v[88:91], v[224:227], v[176:179]
    ds_read_b64_tr_b16 v[220:221], v251 offset:41984
    buffer_store_dwordx4 v[144:147], v9, s[52:55], s10 offen offset:0 sc1
    v_cvt_pk_bf16_f32 v148, v152, v153
    v_mfma_f32_16x16x32_bf16 v[180:183], v[92:95], v[224:227], v[180:183]
    ds_read_b64_tr_b16 v[222:223], v251 offset:44032
    v_cvt_pk_bf16_f32 v149, v154, v155
    v_mfma_f32_16x16x32_bf16 v[184:187], v[88:91], v[228:231], v[184:187]
    ds_read_b64_tr_b16 v[224:225], v248 offset:46080
    v_cvt_pk_bf16_f32 v150, v156, v157
    v_mfma_f32_16x16x32_bf16 v[188:191], v[92:95], v[228:231], v[188:191]
    ds_read_b64_tr_b16 v[226:227], v248 offset:48128
    v_cvt_pk_bf16_f32 v151, v158, v159
    v_mfma_f32_16x16x32_bf16 v[192:195], v[88:91], v[232:235], v[192:195]
    ds_read_b64_tr_b16 v[228:229], v249 offset:46080
    v_add_u32 v248, 0xc600, v3
    v_mfma_f32_16x16x32_bf16 v[196:199], v[92:95], v[232:235], v[196:199]
    ds_read_b64_tr_b16 v[230:231], v249 offset:48128
    buffer_store_dwordx4 v[148:151], v9, s[52:55], s11 offen offset:0 sc1
    v_mfma_f32_16x16x32_bf16 v[200:203], v[88:91], v[236:239], v[200:203]
    ds_read_b64_tr_b16 v[232:233], v250 offset:46080
    v_cvt_pk_bf16_f32 v152, v160, v161
    v_mfma_f32_16x16x32_bf16 v[204:207], v[92:95], v[236:239], v[204:207]
    ds_read_b64_tr_b16 v[234:235], v250 offset:48128
    s_waitcnt lgkmcnt(6)
    v_mfma_f32_16x16x32_bf16 v[176:179], v[96:99], v[208:211], v[176:179]
    ds_read_b64_tr_b16 v[236:237], v251 offset:46080
    v_cvt_pk_bf16_f32 v153, v162, v163
    v_mfma_f32_16x16x32_bf16 v[180:183], v[100:103], v[208:211], v[180:183]
    ds_read_b64_tr_b16 v[238:239], v251 offset:48128
    v_cvt_pk_bf16_f32 v154, v164, v165
    v_mfma_f32_16x16x32_bf16 v[184:187], v[96:99], v[212:215], v[184:187]
    ds_read_b64_tr_b16 v[208:209], v248 offset:16896
    v_xor_b32 v249, 32, v248
    v_mfma_f32_16x16x32_bf16 v[188:191], v[100:103], v[212:215], v[188:191]
    ds_read_b64_tr_b16 v[210:211], v248 offset:18944
    v_xor_b32 v250, 64, v248
    v_xor_b32 v251, 96, v248
    v_mfma_f32_16x16x32_bf16 v[192:195], v[96:99], v[216:219], v[192:195]
    ds_read_b64_tr_b16 v[212:213], v249 offset:16896
    v_mov_b32 v254, 12
    v_mfma_f32_16x16x32_bf16 v[196:199], v[100:103], v[216:219], v[196:199]
    ds_read_b64_tr_b16 v[214:215], v249 offset:18944
    ds_write_b32 v0, v254 offset:0
    v_mfma_f32_16x16x32_bf16 v[200:203], v[96:99], v[220:223], v[200:203]
    ds_read_b64_tr_b16 v[216:217], v250 offset:16896
    v_cvt_pk_bf16_f32 v155, v166, v167
    v_mfma_f32_16x16x32_bf16 v[204:207], v[100:103], v[220:223], v[204:207]
    ds_read_b64_tr_b16 v[218:219], v250 offset:18944
    s_waitcnt lgkmcnt(7)
    v_mfma_f32_16x16x32_bf16 v[176:179], v[104:107], v[224:227], v[176:179]
    ds_read_b64_tr_b16 v[220:221], v251 offset:16896
    buffer_store_dwordx4 v[152:155], v9, s[52:55], s12 offen offset:0 sc1
    v_mfma_f32_16x16x32_bf16 v[180:183], v[108:111], v[224:227], v[180:183]
    ds_read_b64_tr_b16 v[222:223], v251 offset:18944
    v_cvt_pk_bf16_f32 v156, v168, v169
    v_mfma_f32_16x16x32_bf16 v[184:187], v[104:107], v[228:231], v[184:187]
    ds_read_b64_tr_b16 v[224:225], v248 offset:20992
    v_cvt_pk_bf16_f32 v157, v170, v171
    v_mfma_f32_16x16x32_bf16 v[188:191], v[108:111], v[228:231], v[188:191]
    ds_read_b64_tr_b16 v[226:227], v248 offset:23040
    v_cvt_pk_bf16_f32 v158, v172, v173
    v_mfma_f32_16x16x32_bf16 v[192:195], v[104:107], v[232:235], v[192:195]
    ds_read_b64_tr_b16 v[228:229], v249 offset:20992
    v_cvt_pk_bf16_f32 v159, v174, v175
    v_mfma_f32_16x16x32_bf16 v[196:199], v[108:111], v[232:235], v[196:199]
    ds_read_b64_tr_b16 v[230:231], v249 offset:23040
    buffer_store_dwordx4 v[156:159], v9, s[52:55], s13 offen offset:0 sc1
    v_mfma_f32_16x16x32_bf16 v[200:203], v[104:107], v[236:239], v[200:203]
    ds_read_b64_tr_b16 v[232:233], v250 offset:20992
    v_mfma_f32_16x16x32_bf16 v[204:207], v[108:111], v[236:239], v[204:207]
    ds_read_b64_tr_b16 v[234:235], v250 offset:23040
    s_waitcnt lgkmcnt(6)
    v_mfma_f32_16x16x32_bf16 v[176:179], v[112:115], v[208:211], v[176:179]
    ds_read_b64_tr_b16 v[236:237], v251 offset:20992
    v_mfma_f32_16x16x32_bf16 v[180:183], v[116:119], v[208:211], v[180:183]
    ds_read_b64_tr_b16 v[238:239], v251 offset:23040
    v_mfma_f32_16x16x32_bf16 v[184:187], v[112:115], v[212:215], v[184:187]
    ds_read_b64_tr_b16 v[208:209], v248 offset:25088
    v_mfma_f32_16x16x32_bf16 v[188:191], v[116:119], v[212:215], v[188:191]
    ds_read_b64_tr_b16 v[210:211], v248 offset:27136
    v_mfma_f32_16x16x32_bf16 v[192:195], v[112:115], v[216:219], v[192:195]
    ds_read_b64_tr_b16 v[212:213], v249 offset:25088
    ds_read_b32 v255, v8 offset:16
    v_mfma_f32_16x16x32_bf16 v[196:199], v[116:119], v[216:219], v[196:199]
    ds_read_b64_tr_b16 v[214:215], v249 offset:27136
    v_mfma_f32_16x16x32_bf16 v[200:203], v[112:115], v[220:223], v[200:203]
    ds_read_b64_tr_b16 v[216:217], v250 offset:25088
    v_mfma_f32_16x16x32_bf16 v[204:207], v[116:119], v[220:223], v[204:207]
    ds_read_b64_tr_b16 v[218:219], v250 offset:27136
    s_waitcnt lgkmcnt(7)
    v_mfma_f32_16x16x32_bf16 v[176:179], v[120:123], v[224:227], v[176:179]
    ds_read_b64_tr_b16 v[220:221], v251 offset:25088
    v_mfma_f32_16x16x32_bf16 v[180:183], v[124:127], v[224:227], v[180:183]
    ds_read_b64_tr_b16 v[222:223], v251 offset:27136
    v_mfma_f32_16x16x32_bf16 v[184:187], v[120:123], v[228:231], v[184:187]
    ds_read_b64_tr_b16 v[224:225], v248 offset:29184
    v_mfma_f32_16x16x32_bf16 v[188:191], v[124:127], v[228:231], v[188:191]
    ds_read_b64_tr_b16 v[226:227], v248 offset:31232
    v_mfma_f32_16x16x32_bf16 v[192:195], v[120:123], v[232:235], v[192:195]
    ds_read_b64_tr_b16 v[228:229], v249 offset:29184
    v_add_u32 v248, 0x0, v3
    v_mfma_f32_16x16x32_bf16 v[196:199], v[124:127], v[232:235], v[196:199]
    ds_read_b64_tr_b16 v[230:231], v249 offset:31232
    v_mfma_f32_16x16x32_bf16 v[200:203], v[120:123], v[236:239], v[200:203]
    ds_read_b64_tr_b16 v[232:233], v250 offset:29184
    v_mfma_f32_16x16x32_bf16 v[204:207], v[124:127], v[236:239], v[204:207]
    ds_read_b64_tr_b16 v[234:235], v250 offset:31232
    s_waitcnt lgkmcnt(6)
    v_mfma_f32_16x16x32_bf16 v[176:179], v[128:131], v[208:211], v[176:179]
    ds_read_b64_tr_b16 v[236:237], v251 offset:29184
    v_cmp_gt_u32 vcc, 16, v255
    v_mfma_f32_16x16x32_bf16 v[180:183], v[132:135], v[208:211], v[180:183]
    ds_read_b64_tr_b16 v[238:239], v251 offset:31232
    s_cbranch_vccnz L_spin_138
L_go_139:
    v_mfma_f32_16x16x32_bf16 v[184:187], v[128:131], v[212:215], v[184:187]
    ds_read_b64_tr_b16 v[208:209], v248 offset:16896
    v_xor_b32 v249, 32, v248
    v_mfma_f32_16x16x32_bf16 v[188:191], v[132:135], v[212:215], v[188:191]
    ds_read_b64_tr_b16 v[210:211], v248 offset:18944
    v_mov_b32 v6, 1
    v_mfma_f32_16x16x32_bf16 v[192:195], v[128:131], v[216:219], v[192:195]
    ds_read_b64_tr_b16 v[212:213], v249 offset:16896
    v_xor_b32 v250, 64, v248
    v_mfma_f32_16x16x32_bf16 v[196:199], v[132:135], v[216:219], v[196:199]
    ds_read_b64_tr_b16 v[214:215], v249 offset:18944
    s_waitcnt vmcnt(0)
    s_mov_b32 exec_hi, 0
    buffer_store_dword v6, v11, s[60:63], s39 offen sc1
    s_mov_b64 exec, -1
    v_mfma_f32_16x16x32_bf16 v[200:203], v[128:131], v[220:223], v[200:203]
    ds_read_b64_tr_b16 v[216:217], v250 offset:16896
    v_xor_b32 v251, 96, v248
    v_mfma_f32_16x16x32_bf16 v[204:207], v[132:135], v[220:223], v[204:207]
    ds_read_b64_tr_b16 v[218:219], v250 offset:18944
    s_waitcnt lgkmcnt(6)
    v_mfma_f32_16x16x32_bf16 v[176:179], v[136:139], v[224:227], v[176:179]
    ds_read_b64_tr_b16 v[220:221], v251 offset:16896
    v_mov_b32 v254, 13
    v_mfma_f32_16x16x32_bf16 v[180:183], v[140:143], v[224:227], v[180:183]
    ds_read_b64_tr_b16 v[222:223], v251 offset:18944
    ds_write_b32 v0, v254 offset:0
    v_mfma_f32_16x16x32_bf16 v[184:187], v[136:139], v[228:231], v[184:187]
    ds_read_b64_tr_b16 v[224:225], v248 offset:20992
    v_mfma_f32_16x16x32_bf16 v[188:191], v[140:143], v[228:231], v[188:191]
    ds_read_b64_tr_b16 v[226:227], v248 offset:23040
    v_mfma_f32_16x16x32_bf16 v[192:195], v[136:139], v[232:235], v[192:195]
    ds_read_b64_tr_b16 v[228:229], v249 offset:20992
    v_mfma_f32_16x16x32_bf16 v[196:199], v[140:143], v[232:235], v[196:199]
    ds_read_b64_tr_b16 v[230:231], v249 offset:23040
    v_mfma_f32_16x16x32_bf16 v[200:203], v[136:139], v[236:239], v[200:203]
    ds_read_b64_tr_b16 v[232:233], v250 offset:20992
    v_mfma_f32_16x16x32_bf16 v[204:207], v[140:143], v[236:239], v[204:207]
    ds_read_b64_tr_b16 v[234:235], v250 offset:23040
    s_waitcnt lgkmcnt(7)
    v_mfma_f32_16x16x32_bf16 v[144:147], v[80:83], v[208:211], 0
    ds_read_b64_tr_b16 v[236:237], v251 offset:20992
    v_mfma_f32_16x16x32_bf16 v[148:151], v[84:87], v[208:211], 0
    ds_read_b64_tr_b16 v[238:239], v251 offset:23040
    v_mfma_f32_16x16x32_bf16 v[152:155], v[80:83], v[212:215], 0
    ds_read_b64_tr_b16 v[208:209], v248 offset:25088
    v_mfma_f32_16x16x32_bf16 v[156:159], v[84:87], v[212:215], 0
    ds_read_b64_tr_b16 v[210:211], v248 offset:27136
    v_mfma_f32_16x16x32_bf16 v[160:163], v[80:83], v[216:219], 0
    ds_read_b64_tr_b16 v[212:213], v249 offset:25088
    v_cvt_pk_bf16_f32 v176, v176, v177
    v_mfma_f32_16x16x32_bf16 v[164:167], v[84:87], v[216:219], 0
    ds_read_b64_tr_b16 v[214:215], v249 offset:27136
    v_cvt_pk_bf16_f32 v177, v178, v179
    v_mfma_f32_16x16x32_bf16 v[168:171], v[80:83], v[220:223], 0
    ds_read_b64_tr_b16 v[216:217], v250 offset:25088
    v_cvt_pk_bf16_f32 v178, v180, v181
    v_mfma_f32_16x16x32_bf16 v[172:175], v[84:87], v[220:223], 0
    ds_read_b64_tr_b16 v[218:219], v250 offset:27136
    s_waitcnt lgkmcnt(6)
    v_mfma_f32_16x16x32_bf16 v[144:147], v[88:91], v[224:227], v[144:147]
    ds_read_b64_tr_b16 v[220:221], v251 offset:25088
    v_cvt_pk_bf16_f32 v179, v182, v183
    v_mfma_f32_16x16x32_bf16 v[148:151], v[92:95], v[224:227], v[148:151]
    ds_read_b64_tr_b16 v[222:223], v251 offset:27136
    buffer_store_dwordx4 v[176:179], v9, s[52:55], s10 offen offset:128 sc1
    v_mfma_f32_16x16x32_bf16 v[152:155], v[88:91], v[228:231], v[152:155]
    ds_read_b64_tr_b16 v[224:225], v248 offset:29184
    v_cvt_pk_bf16_f32 v180, v184, v185
    v_mfma_f32_16x16x32_bf16 v[156:159], v[92:95], v[228:231], v[156:159]
    ds_read_b64_tr_b16 v[226:227], v248 offset:31232
    v_cvt_pk_bf16_f32 v181, v186, v187
    v_cvt_pk_bf16_f32 v182, v188, v189
    v_mfma_f32_16x16x32_bf16 v[160:163], v[88:91], v[232:235], v[160:163]
    ds_read_b64_tr_b16 v[228:229], v249 offset:29184
    v_add_u32 v248, 0xc600, v3
    v_mfma_f32_16x16x32_bf16 v[164:167], v[92:95], v[232:235], v[164:167]
    ds_read_b64_tr_b16 v[230:231], v249 offset:31232
    v_cvt_pk_bf16_f32 v183, v190, v191
    v_mfma_f32_16x16x32_bf16 v[168:171], v[88:91], v[236:239], v[168:171]
    ds_read_b64_tr_b16 v[232:233], v250 offset:29184
    buffer_store_dwordx4 v[180:183], v9, s[52:55], s11 offen offset:128 sc1
    v_mfma_f32_16x16x32_bf16 v[172:175], v[92:95], v[236:239], v[172:175]
    ds_read_b64_tr_b16 v[234:235], v250 offset:31232
    s_waitcnt lgkmcnt(6)
    v_mfma_f32_16x16x32_bf16 v[144:147], v[96:99], v[208:211], v[144:147]
    ds_read_b64_tr_b16 v[236:237], v251 offset:29184
    v_cvt_pk_bf16_f32 v184, v192, v193
    v_mfma_f32_16x16x32_bf16 v[148:151], v[100:103], v[208:211], v[148:151]
    ds_read_b64_tr_b16 v[238:239], v251 offset:31232
    v_cvt_pk_bf16_f32 v185, v194, v195
    v_mfma_f32_16x16x32_bf16 v[152:155], v[96:99], v[212:215], v[152:155]
    ds_read_b64_tr_b16 v[208:209], v248 offset:33792
    v_xor_b32 v249, 32, v248
    v_xor_b32 v250, 64, v248
    v_mfma_f32_16x16x32_bf16 v[156:159], v[100:103], v[212:215], v[156:159]
    ds_read_b64_tr_b16 v[210:211], v248 offset:35840
    v_xor_b32 v251, 96, v248
    v_mfma_f32_16x16x32_bf16 v[160:163], v[96:99], v[216:219], v[160:163]
    ds_read_b64_tr_b16 v[212:213], v249 offset:33792
    v_mov_b32 v254, 14
    v_mfma_f32_16x16x32_bf16 v[164:167], v[100:103], v[216:219], v[164:167]
    ds_read_b64_tr_b16 v[214:215], v249 offset:35840
    ds_write_b32 v0, v254 offset:0
    v_mfma_f32_16x16x32_bf16 v[168:171], v[96:99], v[220:223], v[168:171]
    ds_read_b64_tr_b16 v[216:217], v250 offset:33792
    v_cvt_pk_bf16_f32 v186, v196, v197
    v_cvt_pk_bf16_f32 v187, v198, v199
    v_mfma_f32_16x16x32_bf16 v[172:175], v[100:103], v[220:223], v[172:175]
    ds_read_b64_tr_b16 v[218:219], v250 offset:35840
    s_waitcnt lgkmcnt(7)
    v_mfma_f32_16x16x32_bf16 v[144:147], v[104:107], v[224:227], v[144:147]
    ds_read_b64_tr_b16 v[220:221], v251 offset:33792
    buffer_store_dwordx4 v[184:187], v9, s[52:55], s12 offen offset:128 sc1
    v_mfma_f32_16x16x32_bf16 v[148:151], v[108:111], v[224:227], v[148:151]
    ds_read_b64_tr_b16 v[222:223], v251 offset:35840
    v_cvt_pk_bf16_f32 v188, v200, v201
    v_mfma_f32_16x16x32_bf16 v[152:155], v[104:107], v[228:231], v[152:155]
    ds_read_b64_tr_b16 v[224:225], v248 offset:37888
    v_cvt_pk_bf16_f32 v189, v202, v203
    v_mfma_f32_16x16x32_bf16 v[156:159], v[108:111], v[228:231], v[156:159]
    ds_read_b64_tr_b16 v[226:227], v248 offset:39936
    v_cvt_pk_bf16_f32 v190, v204, v205
    v_mfma_f32_16x16x32_bf16 v[160:163], v[104:107], v[232:235], v[160:163]
    ds_read_b64_tr_b16 v[228:229], v249 offset:37888
    v_cvt_pk_bf16_f32 v191, v206, v207
    v_mfma_f32_16x16x32_bf16 v[164:167], v[108:111], v[232:235], v[164:167]
    ds_read_b64_tr_b16 v[230:231], v249 offset:39936
    buffer_store_dwordx4 v[188:191], v9, s[52:55], s13 offen offset:128 sc1
    v_mfma_f32_16x16x32_bf16 v[168:171], v[104:107], v[236:239], v[168:171]
    ds_read_b64_tr_b16 v[232:233], v250 offset:37888
    v_mfma_f32_16x16x32_bf16 v[172:175], v[108:111], v[236:239], v[172:175]
    ds_read_b64_tr_b16 v[234:235], v250 offset:39936
    s_waitcnt lgkmcnt(6)
    v_mfma_f32_16x16x32_bf16 v[144:147], v[112:115], v[208:211], v[144:147]
    ds_read_b64_tr_b16 v[236:237], v251 offset:37888
    v_mfma_f32_16x16x32_bf16 v[148:151], v[116:119], v[208:211], v[148:151]
    ds_read_b64_tr_b16 v[238:239], v251 offset:39936
    v_mfma_f32_16x16x32_bf16 v[152:155], v[112:115], v[212:215], v[152:155]
    ds_read_b64_tr_b16 v[208:209], v248 offset:41984
    v_mfma_f32_16x16x32_bf16 v[156:159], v[116:119], v[212:215], v[156:159]
    ds_read_b64_tr_b16 v[210:211], v248 offset:44032
    v_mfma_f32_16x16x32_bf16 v[160:163], v[112:115], v[216:219], v[160:163]
    ds_read_b64_tr_b16 v[212:213], v249 offset:41984
    ds_read_b32 v255, v8 offset:16
    v_mfma_f32_16x16x32_bf16 v[164:167], v[116:119], v[216:219], v[164:167]
    ds_read_b64_tr_b16 v[214:215], v249 offset:44032
    v_mfma_f32_16x16x32_bf16 v[168:171], v[112:115], v[220:223], v[168:171]
    ds_read_b64_tr_b16 v[216:217], v250 offset:41984
    v_mfma_f32_16x16x32_bf16 v[172:175], v[116:119], v[220:223], v[172:175]
    ds_read_b64_tr_b16 v[218:219], v250 offset:44032
    s_waitcnt lgkmcnt(7)
    v_mfma_f32_16x16x32_bf16 v[144:147], v[120:123], v[224:227], v[144:147]
    ds_read_b64_tr_b16 v[220:221], v251 offset:41984
    v_mfma_f32_16x16x32_bf16 v[148:151], v[124:127], v[224:227], v[148:151]
    ds_read_b64_tr_b16 v[222:223], v251 offset:44032
    v_mfma_f32_16x16x32_bf16 v[152:155], v[120:123], v[228:231], v[152:155]
    ds_read_b64_tr_b16 v[224:225], v248 offset:46080
    v_mfma_f32_16x16x32_bf16 v[156:159], v[124:127], v[228:231], v[156:159]
    ds_read_b64_tr_b16 v[226:227], v248 offset:48128
    v_mfma_f32_16x16x32_bf16 v[160:163], v[120:123], v[232:235], v[160:163]
    ds_read_b64_tr_b16 v[228:229], v249 offset:46080
    v_mfma_f32_16x16x32_bf16 v[164:167], v[124:127], v[232:235], v[164:167]
    ds_read_b64_tr_b16 v[230:231], v249 offset:48128
    v_mfma_f32_16x16x32_bf16 v[168:171], v[120:123], v[236:239], v[168:171]
    ds_read_b64_tr_b16 v[232:233], v250 offset:46080
    v_mfma_f32_16x16x32_bf16 v[172:175], v[124:127], v[236:239], v[172:175]
    ds_read_b64_tr_b16 v[234:235], v250 offset:48128
    s_waitcnt lgkmcnt(6)
    v_mfma_f32_16x16x32_bf16 v[144:147], v[128:131], v[208:211], v[144:147]
    ds_read_b64_tr_b16 v[236:237], v251 offset:46080
    v_cmp_gt_u32 vcc, 18, v255
    v_mfma_f32_16x16x32_bf16 v[148:151], v[132:135], v[208:211], v[148:151]
    ds_read_b64_tr_b16 v[238:239], v251 offset:48128
    s_cbranch_vccnz L_spin_140
L_go_141:
    v_mfma_f32_16x16x32_bf16 v[152:155], v[128:131], v[212:215], v[152:155]
    ds_read_b64_tr_b16 v[208:209], v248 offset:0
    v_mov_b32 v6, 2
    v_mfma_f32_16x16x32_bf16 v[156:159], v[132:135], v[212:215], v[156:159]
    ds_read_b64_tr_b16 v[210:211], v248 offset:2048
    v_mfma_f32_16x16x32_bf16 v[160:163], v[128:131], v[216:219], v[160:163]
    ds_read_b64_tr_b16 v[212:213], v249 offset:0
    v_mov_b32 v254, 15
    v_mfma_f32_16x16x32_bf16 v[164:167], v[132:135], v[216:219], v[164:167]
    ds_read_b64_tr_b16 v[214:215], v249 offset:2048
    s_waitcnt vmcnt(0)
    s_mov_b32 exec_hi, 0
    buffer_store_dword v6, v11, s[60:63], s39 offen sc1
    s_mov_b64 exec, -1
    v_mfma_f32_16x16x32_bf16 v[168:171], v[128:131], v[220:223], v[168:171]
    ds_read_b64_tr_b16 v[216:217], v250 offset:0
    ds_write_b32 v0, v254 offset:0
    v_mfma_f32_16x16x32_bf16 v[172:175], v[132:135], v[220:223], v[172:175]
    ds_read_b64_tr_b16 v[218:219], v250 offset:2048
    s_waitcnt lgkmcnt(7)
    v_mfma_f32_16x16x32_bf16 v[144:147], v[136:139], v[224:227], v[144:147]
    ds_read_b64_tr_b16 v[220:221], v251 offset:0
    v_mfma_f32_16x16x32_bf16 v[148:151], v[140:143], v[224:227], v[148:151]
    ds_read_b64_tr_b16 v[222:223], v251 offset:2048
    v_mfma_f32_16x16x32_bf16 v[152:155], v[136:139], v[228:231], v[152:155]
    ds_read_b64_tr_b16 v[224:225], v248 offset:4096
    v_mfma_f32_16x16x32_bf16 v[156:159], v[140:143], v[228:231], v[156:159]
    ds_read_b64_tr_b16 v[226:227], v248 offset:6144
    v_mfma_f32_16x16x32_bf16 v[160:163], v[136:139], v[232:235], v[160:163]
    ds_read_b64_tr_b16 v[228:229], v249 offset:4096
    v_mfma_f32_16x16x32_bf16 v[164:167], v[140:143], v[232:235], v[164:167]
    ds_read_b64_tr_b16 v[230:231], v249 offset:6144
    v_mfma_f32_16x16x32_bf16 v[168:171], v[136:139], v[236:239], v[168:171]
    ds_read_b64_tr_b16 v[232:233], v250 offset:4096
    v_mfma_f32_16x16x32_bf16 v[172:175], v[140:143], v[236:239], v[172:175]
    ds_read_b64_tr_b16 v[234:235], v250 offset:6144
    s_waitcnt lgkmcnt(6)
    v_mfma_f32_16x16x32_bf16 v[176:179], v[80:83], v[208:211], 0
    ds_read_b64_tr_b16 v[236:237], v251 offset:4096
    v_mfma_f32_16x16x32_bf16 v[180:183], v[84:87], v[208:211], 0
    ds_read_b64_tr_b16 v[238:239], v251 offset:6144
    v_mfma_f32_16x16x32_bf16 v[184:187], v[80:83], v[212:215], 0
    ds_read_b64_tr_b16 v[208:209], v248 offset:8192
    v_cvt_pk_bf16_f32 v144, v144, v145
    v_mfma_f32_16x16x32_bf16 v[188:191], v[84:87], v[212:215], 0
    ds_read_b64_tr_b16 v[210:211], v248 offset:10240
    v_cvt_pk_bf16_f32 v145, v146, v147
    v_mfma_f32_16x16x32_bf16 v[192:195], v[80:83], v[216:219], 0
    ds_read_b64_tr_b16 v[212:213], v249 offset:8192
    v_cvt_pk_bf16_f32 v146, v148, v149
    v_mfma_f32_16x16x32_bf16 v[196:199], v[84:87], v[216:219], 0
    ds_read_b64_tr_b16 v[214:215], v249 offset:10240
    v_cvt_pk_bf16_f32 v147, v150, v151
    v_mfma_f32_16x16x32_bf16 v[200:203], v[80:83], v[220:223], 0
    ds_read_b64_tr_b16 v[216:217], v250 offset:8192
    v_cvt_pk_bf16_f32 v148, v152, v153
    v_mfma_f32_16x16x32_bf16 v[204:207], v[84:87], v[220:223], 0
    ds_read_b64_tr_b16 v[218:219], v250 offset:10240
    s_waitcnt lgkmcnt(6)
    v_mfma_f32_16x16x32_bf16 v[176:179], v[88:91], v[224:227], v[176:179]
    ds_read_b64_tr_b16 v[220:221], v251 offset:8192
    v_cvt_pk_bf16_f32 v149, v154, v155
    v_mfma_f32_16x16x32_bf16 v[180:183], v[92:95], v[224:227], v[180:183]
    ds_read_b64_tr_b16 v[222:223], v251 offset:10240
    v_cvt_pk_bf16_f32 v150, v156, v157
    v_mfma_f32_16x16x32_bf16 v[184:187], v[88:91], v[228:231], v[184:187]
    ds_read_b64_tr_b16 v[224:225], v248 offset:12288
    v_cvt_pk_bf16_f32 v151, v158, v159
    v_mfma_f32_16x16x32_bf16 v[188:191], v[92:95], v[228:231], v[188:191]
    ds_read_b64_tr_b16 v[226:227], v248 offset:14336
    v_cvt_pk_bf16_f32 v152, v160, v161
    v_mfma_f32_16x16x32_bf16 v[192:195], v[88:91], v[232:235], v[192:195]
    ds_read_b64_tr_b16 v[228:229], v249 offset:12288
    v_add_u32 v248, 0x18c00, v3
    v_mfma_f32_16x16x32_bf16 v[196:199], v[92:95], v[232:235], v[196:199]
    ds_read_b64_tr_b16 v[230:231], v249 offset:14336
    v_cvt_pk_bf16_f32 v153, v162, v163
    v_mfma_f32_16x16x32_bf16 v[200:203], v[88:91], v[236:239], v[200:203]
    ds_read_b64_tr_b16 v[232:233], v250 offset:12288
    v_cvt_pk_bf16_f32 v154, v164, v165
    v_mfma_f32_16x16x32_bf16 v[204:207], v[92:95], v[236:239], v[204:207]
    ds_read_b64_tr_b16 v[234:235], v250 offset:14336
    s_waitcnt lgkmcnt(6)
    v_mfma_f32_16x16x32_bf16 v[176:179], v[96:99], v[208:211], v[176:179]
    ds_read_b64_tr_b16 v[236:237], v251 offset:12288
    v_cvt_pk_bf16_f32 v155, v166, v167
    v_mfma_f32_16x16x32_bf16 v[180:183], v[100:103], v[208:211], v[180:183]
    ds_read_b64_tr_b16 v[238:239], v251 offset:14336
    v_cvt_pk_bf16_f32 v156, v168, v169
    v_mfma_f32_16x16x32_bf16 v[184:187], v[96:99], v[212:215], v[184:187]
    ds_read_b64_tr_b16 v[208:209], v248 offset:16896
    v_xor_b32 v249, 32, v248
    v_mfma_f32_16x16x32_bf16 v[188:191], v[100:103], v[212:215], v[188:191]
    ds_read_b64_tr_b16 v[210:211], v248 offset:18944
    v_xor_b32 v250, 64, v248
    v_mfma_f32_16x16x32_bf16 v[192:195], v[96:99], v[216:219], v[192:195]
    ds_read_b64_tr_b16 v[212:213], v249 offset:16896
    v_xor_b32 v251, 96, v248
    v_mfma_f32_16x16x32_bf16 v[196:199], v[100:103], v[216:219], v[196:199]
    ds_read_b64_tr_b16 v[214:215], v249 offset:18944
    v_mov_b32 v254, 16
    v_mfma_f32_16x16x32_bf16 v[200:203], v[96:99], v[220:223], v[200:203]
    ds_read_b64_tr_b16 v[216:217], v250 offset:16896
    ds_write_b32 v0, v254 offset:0
    v_mfma_f32_16x16x32_bf16 v[204:207], v[100:103], v[220:223], v[204:207]
    ds_read_b64_tr_b16 v[218:219], v250 offset:18944
    s_waitcnt lgkmcnt(7)
    v_mfma_f32_16x16x32_bf16 v[176:179], v[104:107], v[224:227], v[176:179]
    ds_read_b64_tr_b16 v[220:221], v251 offset:16896
    v_cvt_pk_bf16_f32 v157, v170, v171
    v_mfma_f32_16x16x32_bf16 v[180:183], v[108:111], v[224:227], v[180:183]
    ds_read_b64_tr_b16 v[222:223], v251 offset:18944
    v_cvt_pk_bf16_f32 v158, v172, v173
    v_mfma_f32_16x16x32_bf16 v[184:187], v[104:107], v[228:231], v[184:187]
    ds_read_b64_tr_b16 v[224:225], v248 offset:20992
    v_cvt_pk_bf16_f32 v159, v174, v175
    v_mfma_f32_16x16x32_bf16 v[188:191], v[108:111], v[228:231], v[188:191]
    ds_read_b64_tr_b16 v[226:227], v248 offset:23040
    v_mfma_f32_16x16x32_bf16 v[192:195], v[104:107], v[232:235], v[192:195]
    ds_read_b64_tr_b16 v[228:229], v249 offset:20992
    v_mfma_f32_16x16x32_bf16 v[196:199], v[108:111], v[232:235], v[196:199]
    ds_read_b64_tr_b16 v[230:231], v249 offset:23040
    v_mfma_f32_16x16x32_bf16 v[200:203], v[104:107], v[236:239], v[200:203]
    ds_read_b64_tr_b16 v[232:233], v250 offset:20992
    v_mfma_f32_16x16x32_bf16 v[204:207], v[108:111], v[236:239], v[204:207]
    ds_read_b64_tr_b16 v[234:235], v250 offset:23040
    s_waitcnt lgkmcnt(6)
    v_mfma_f32_16x16x32_bf16 v[176:179], v[112:115], v[208:211], v[176:179]
    ds_read_b64_tr_b16 v[236:237], v251 offset:20992
    v_mfma_f32_16x16x32_bf16 v[180:183], v[116:119], v[208:211], v[180:183]
    ds_read_b64_tr_b16 v[238:239], v251 offset:23040
    v_mfma_f32_16x16x32_bf16 v[184:187], v[112:115], v[212:215], v[184:187]
    ds_read_b64_tr_b16 v[208:209], v248 offset:25088
    v_mfma_f32_16x16x32_bf16 v[188:191], v[116:119], v[212:215], v[188:191]
    ds_read_b64_tr_b16 v[210:211], v248 offset:27136
    v_mfma_f32_16x16x32_bf16 v[192:195], v[112:115], v[216:219], v[192:195]
    ds_read_b64_tr_b16 v[212:213], v249 offset:25088
    v_mfma_f32_16x16x32_bf16 v[196:199], v[116:119], v[216:219], v[196:199]
    ds_read_b64_tr_b16 v[214:215], v249 offset:27136
    v_mfma_f32_16x16x32_bf16 v[200:203], v[112:115], v[220:223], v[200:203]
    ds_read_b64_tr_b16 v[216:217], v250 offset:25088
    v_mfma_f32_16x16x32_bf16 v[204:207], v[116:119], v[220:223], v[204:207]
    ds_read_b64_tr_b16 v[218:219], v250 offset:27136
    s_waitcnt lgkmcnt(6)
    v_mfma_f32_16x16x32_bf16 v[176:179], v[120:123], v[224:227], v[176:179]
    ds_read_b64_tr_b16 v[220:221], v251 offset:25088
    v_mfma_f32_16x16x32_bf16 v[180:183], v[124:127], v[224:227], v[180:183]
    ds_read_b64_tr_b16 v[222:223], v251 offset:27136
    v_mfma_f32_16x16x32_bf16 v[184:187], v[120:123], v[228:231], v[184:187]
    ds_read_b64_tr_b16 v[224:225], v248 offset:29184
    v_mfma_f32_16x16x32_bf16 v[188:191], v[124:127], v[228:231], v[188:191]
    ds_read_b64_tr_b16 v[226:227], v248 offset:31232
    v_mfma_f32_16x16x32_bf16 v[192:195], v[120:123], v[232:235], v[192:195]
    ds_read_b64_tr_b16 v[228:229], v249 offset:29184
    v_mfma_f32_16x16x32_bf16 v[196:199], v[124:127], v[232:235], v[196:199]
    ds_read_b64_tr_b16 v[230:231], v249 offset:31232
    v_mfma_f32_16x16x32_bf16 v[200:203], v[120:123], v[236:239], v[200:203]
    ds_read_b64_tr_b16 v[232:233], v250 offset:29184
    v_mfma_f32_16x16x32_bf16 v[204:207], v[124:127], v[236:239], v[204:207]
    ds_read_b64_tr_b16 v[234:235], v250 offset:31232
    s_waitcnt lgkmcnt(6)
    v_mfma_f32_16x16x32_bf16 v[176:179], v[128:131], v[208:211], v[176:179]
    ds_read_b64_tr_b16 v[236:237], v251 offset:29184
    v_mfma_f32_16x16x32_bf16 v[180:183], v[132:135], v[208:211], v[180:183]
    ds_read_b64_tr_b16 v[238:239], v251 offset:31232
    v_mfma_f32_16x16x32_bf16 v[184:187], v[128:131], v[212:215], v[184:187]
    v_mfma_f32_16x16x32_bf16 v[188:191], v[132:135], v[212:215], v[188:191]
    v_mfma_f32_16x16x32_bf16 v[192:195], v[128:131], v[216:219], v[192:195]
    v_mov_b32 v254, 17
    v_mfma_f32_16x16x32_bf16 v[196:199], v[132:135], v[216:219], v[196:199]
    ds_write_b32 v0, v254 offset:0
    v_mfma_f32_16x16x32_bf16 v[200:203], v[128:131], v[220:223], v[200:203]
    v_mfma_f32_16x16x32_bf16 v[204:207], v[132:135], v[220:223], v[204:207]
    s_waitcnt lgkmcnt(1)
    v_mfma_f32_16x16x32_bf16 v[176:179], v[136:139], v[224:227], v[176:179]
    v_mfma_f32_16x16x32_bf16 v[180:183], v[140:143], v[224:227], v[180:183]
    v_mfma_f32_16x16x32_bf16 v[184:187], v[136:139], v[228:231], v[184:187]
    v_mfma_f32_16x16x32_bf16 v[188:191], v[140:143], v[228:231], v[188:191]
    v_mfma_f32_16x16x32_bf16 v[192:195], v[136:139], v[232:235], v[192:195]
    v_mfma_f32_16x16x32_bf16 v[196:199], v[140:143], v[232:235], v[196:199]
    v_mfma_f32_16x16x32_bf16 v[200:203], v[136:139], v[236:239], v[200:203]
    v_mfma_f32_16x16x32_bf16 v[204:207], v[140:143], v[236:239], v[204:207]
    s_lshl_b32 s32, s44, 4
    v_add_u32 v3, s32, v8
    s_cmp_eq_u32 s44, 0
    s_cbranch_scc0 L_skip_142
    s_mov_b32 s34, 262144
L_poll_143:
    buffer_load_dword v255, v1, s[60:63], s39 offen sc1
    s_waitcnt vmcnt(0)
    v_cmp_gt_u32 vcc, 1, v255
    s_cbranch_vccz L_polled_144
    s_sleep 1
    s_sub_u32 s34, s34, 1
    s_cbranch_scc0 L_poll_143
L_polled_144:
    v_mov_b32 v254, 1
    ds_write_b32 v3, v254 offset:96
L_skip_142:
    s_cmp_ge_u32 s44, 2
    s_cbranch_scc0 L_skip_145
    v_lshrrev_b32 v12, 9, v5
    v_lshlrev_b32 v12, 4, v12
    v_xor_b32 v12, v12, v5
    s_cmp_eq_u32 s44, 2
    s_cselect_b32 s4, 4, 5
    s_cselect_b32 s5, 1, 3
    s_mul_i32 s4, s4, 16896
    s_mul_i32 s5, s5, 16896
    s_lshl_b32 s35, s44, 15
    s_mov_b32 s34, 1048576
L_lw_146:
    ds_read_b32 v255, v8 offset:0
    s_waitcnt lgkmcnt(0)
    v_cmp_gt_u32 vcc, 16, v255
    s_cbranch_vccz L_lwd_147
    s_sleep 1
    s_sub_u32 s34, s34, 1
    s_cbranch_scc0 L_lw_146
L_lwd_147:
    s_add_u32 m0, s4, 0
    s_add_u32 s100, s35, 0x0
    buffer_load_dwordx4 v12, s[48:51], s100 offen offset:0 lds
    s_add_u32 m0, m0, 32
    s_nop 0
    buffer_load_dwordx4 v12, s[48:51], s100 offen offset:1024 lds
    s_add_u32 m0, m0, 32
    s_nop 0
    buffer_load_dwordx4 v12, s[48:51], s100 offen offset:2048 lds
    s_add_u32 m0, m0, 32
    s_nop 0
    buffer_load_dwordx4 v12, s[48:51], s100 offen offset:3072 lds
    s_add_u32 m0, s4, 4224
    s_add_u32 s100, s35, 0x1000
    buffer_load_dwordx4 v12, s[48:51], s100 offen offset:0 lds
    s_add_u32 m0, m0, 32
    s_nop 0
    buffer_load_dwordx4 v12, s[48:51], s100 offen offset:1024 lds
    s_add_u32 m0, m0, 32
    s_nop 0
    buffer_load_dwordx4 v12, s[48:51], s100 offen offset:2048 lds
    s_add_u32 m0, m0, 32
    s_nop 0
    buffer_load_dwordx4 v12, s[48:51], s100 offen offset:3072 lds
    s_add_u32 m0, s4, 8448
    s_add_u32 s100, s35, 0x2000
    buffer_load_dwordx4 v12, s[48:51], s100 offen offset:0 lds
    s_add_u32 m0, m0, 32
    s_nop 0
    buffer_load_dwordx4 v12, s[48:51], s100 offen offset:1024 lds
    s_add_u32 m0, m0, 32
    s_nop 0
    buffer_load_dwordx4 v12, s[48:51], s100 offen offset:2048 lds
    s_add_u32 m0, m0, 32
    s_nop 0
    buffer_load_dwordx4 v12, s[48:51], s100 offen offset:3072 lds
    s_add_u32 m0, s4, 12672
    s_add_u32 s100, s35, 0x3000
    buffer_load_dwordx4 v12, s[48:51], s100 offen offset:0 lds
    s_add_u32 m0, m0, 32
    s_nop 0
    buffer_load_dwordx4 v12, s[48:51], s100 offen offset:1024 lds
    s_add_u32 m0, m0, 32
    s_nop 0
    buffer_load_dwordx4 v12, s[48:51], s100 offen offset:2048 lds
    s_add_u32 m0, m0, 32
    s_nop 0
    buffer_load_dwordx4 v12, s[48:51], s100 offen offset:3072 lds
    s_add_u32 m0, s5, 0
    s_add_u32 s100, s35, 0x4000
    buffer_load_dwordx4 v12, s[48:51], s100 offen offset:0 lds
    s_add_u32 m0, m0, 32
    s_nop 0
    buffer_load_dwordx4 v12, s[48:51], s100 offen offset:1024 lds
    s_add_u32 m0, m0, 32
    s_nop 0
    buffer_load_dwordx4 v12, s[48:51], s100 offen offset:2048 lds
    s_add_u32 m0, m0, 32
    s_nop 0
    buffer_load_dwordx4 v12, s[48:51], s100 offen offset:3072 lds
    s_add_u32 m0, s5, 4224
    s_add_u32 s100, s35, 0x5000
    buffer_load_dwordx4 v12, s[48:51], s100 offen offset:0 lds
    s_add_u32 m0, m0, 32
    s_nop 0
    buffer_load_dwordx4 v12, s[48:51], s100 offen offset:1024 lds
    s_add_u32 m0, m0, 32
    s_nop 0
    buffer_load_dwordx4 v12, s[48:51], s100 offen offset:2048 lds
    s_add_u32 m0, m0, 32
    s_nop 0
    buffer_load_dwordx4 v12, s[48:51], s100 offen offset:3072 lds
    s_add_u32 m0, s5, 8448
    s_add_u32 s100, s35, 0x6000
    buffer_load_dwordx4 v12, s[48:51], s100 offen offset:0 lds
    s_add_u32 m0, m0, 32
    s_nop 0
    buffer_load_dwordx4 v12, s[48:51], s100 offen offset:1024 lds
    s_add_u32 m0, m0, 32
    s_nop 0
    buffer_load_dwordx4 v12, s[48:51], s100 offen offset:2048 lds
    s_add_u32 m0, m0, 32
    s_nop 0
    buffer_load_dwordx4 v12, s[48:51], s100 offen offset:3072 lds
    s_add_u32 m0, s5, 12672
    s_add_u32 s100, s35, 0x7000
    buffer_load_dwordx4 v12, s[48:51], s100 offen offset:0 lds
    s_add_u32 m0, m0, 32
    s_nop 0
    buffer_load_dwordx4 v12, s[48:51], s100 offen offset:1024 lds
    s_add_u32 m0, m0, 32
    s_nop 0
    buffer_load_dwordx4 v12, s[48:51], s100 offen offset:2048 lds
    s_add_u32 m0, m0, 32
    s_nop 0
    buffer_load_dwordx4 v12, s[48:51], s100 offen offset:3072 lds
L_skip_145:
    s_nop 3
    v_cvt_pk_bf16_f32 v176, v176, v177
    v_cvt_pk_bf16_f32 v177, v178, v179
    v_cvt_pk_bf16_f32 v178, v180, v181
    v_cvt_pk_bf16_f32 v179, v182, v183
    v_cvt_pk_bf16_f32 v180, v184, v185
    v_cvt_pk_bf16_f32 v181, v186, v187
    v_cvt_pk_bf16_f32 v182, v188, v189
    v_cvt_pk_bf16_f32 v183, v190, v191
    v_cvt_pk_bf16_f32 v184, v192, v193
    v_cvt_pk_bf16_f32 v185, v194, v195
    v_cvt_pk_bf16_f32 v186, v196, v197
    v_cvt_pk_bf16_f32 v187, v198, v199
    v_cvt_pk_bf16_f32 v188, v200, v201
    v_cvt_pk_bf16_f32 v189, v202, v203
    v_cvt_pk_bf16_f32 v190, v204, v205
    v_cvt_pk_bf16_f32 v191, v206, v207
    s_lshl_b32 s33, s44, 7
    s_add_u32 s19, s19, s33
    s_lshl_b32 s35, s44, 3
    s_lshr_b32 s4, 0x18161412, s35
    s_and_b32 s4, s4, 0xff
    s_lshr_b32 s5, 0x1020007, s35
    s_and_b32 s5, s5, 0xff
    s_lshr_b32 s6, 0x5040806, s35
    s_and_b32 s6, s6, 0xff
    s_mul_i32 s5, s5, 16896
    s_mul_i32 s6, s6, 16896
    s_cmp_ge_u32 s44, 2
    s_cbranch_scc0 L_skip_148
    s_waitcnt vmcnt(0)
    v_mov_b32 v254, 1
    ds_write_b32 v3, v254 offset:192
L_skip_148:
    s_mov_b32 s34, 1048576
L_lw_149:
    ds_read_b32 v255, v0 offset:96
    s_waitcnt lgkmcnt(0)
    v_cmp_gt_u32 vcc, 1, v255
    s_cbranch_vccz L_lwd_150
    s_sleep 1
    s_sub_u32 s34, s34, 1
    s_cbranch_scc0 L_lw_149
L_lwd_150:
    buffer_store_dwordx4 v[144:147], v9, s[52:55], s10 offen offset:256 sc1
    buffer_store_dwordx4 v[148:151], v9, s[52:55], s11 offen offset:256 sc1
    buffer_store_dwordx4 v[152:155], v9, s[52:55], s12 offen offset:256 sc1
    buffer_store_dwordx4 v[156:159], v9, s[52:55], s13 offen offset:256 sc1
    v_mov_b32 v6, 3
    s_waitcnt vmcnt(0)
    s_mov_b32 exec_hi, 0
    buffer_store_dword v6, v11, s[60:63], s39 offen sc1
    s_mov_b64 exec, -1
    s_cmp_eq_u32 s44, 1
    s_cbranch_scc0 L_skip_151
    s_mov_b32 s34, 262144
L_poll_152:
    buffer_load_dword v255, v1, s[60:63], s39 offen sc1
    s_waitcnt vmcnt(0)
    v_cmp_gt_u32 vcc, 1, v255
    s_cbranch_vccz L_polled_153
    s_sleep 1
    s_sub_u32 s34, s34, 1
    s_cbranch_scc0 L_poll_152
L_polled_153:
    v_mov_b32 v254, 1
    ds_write_b32 v3, v254 offset:96
L_skip_151:
    s_mov_b32 s34, 1048576
L_lw_154:
    ds_read_b32 v255, v0 offset:112
    s_waitcnt lgkmcnt(0)
    v_cmp_gt_u32 vcc, 1, v255
    s_cbranch_vccz L_lwd_155
    s_sleep 1
    s_sub_u32 s34, s34, 1
    s_cbranch_scc0 L_lw_154
L_lwd_155:
    buffer_store_dwordx4 v[176:179], v9, s[52:55], s10 offen offset:384 sc1
    buffer_store_dwordx4 v[180:183], v9, s[52:55], s11 offen offset:384 sc1
    buffer_store_dwordx4 v[184:187], v9, s[52:55], s12 offen offset:384 sc1
    buffer_store_dwordx4 v[188:191], v9, s[52:55], s13 offen offset:384 sc1
    v_mov_b32 v6, 4
    s_waitcnt vmcnt(0)
    s_mov_b32 exec_hi, 0
    buffer_store_dword v6, v11, s[60:63], s39 offen sc1
    s_mov_b64 exec, -1
    s_cmp_ge_u32 s44, 2
    s_cbranch_scc0 L_skip_156
    v_bfe_u32 v12, v5, 4, 3
    s_lshl_b32 s34, s42, 10
    v_lshl_add_u32 v2, v12, 7, s34
    s_add_u32 s32, s44, 1
    s_mov_b32 s34, 262144
L_poll_157:
    buffer_load_dword v255, v2, s[60:63], s39 offen sc1
    s_waitcnt vmcnt(0)
    v_cmp_gt_u32 vcc, s32, v255
    s_cbranch_vccz L_polled_158
    s_sleep 1
    s_sub_u32 s34, s34, 1
    s_cbranch_scc0 L_poll_157
L_polled_158:
    s_add_u32 s33, s19, 0x0
    buffer_load_dwordx4 v[16:19], v7, s[56:59], s33 offen offset:0 sc1
    buffer_load_dwordx4 v[20:23], v7, s[56:59], s33 offen offset:1024 sc1
    s_add_u32 s33, s19, 0x80000
    buffer_load_dwordx4 v[24:27], v7, s[56:59], s33 offen offset:0 sc1
    buffer_load_dwordx4 v[28:31], v7, s[56:59], s33 offen offset:1024 sc1
    s_add_u32 s33, s19, 0x1000
    buffer_load_dwordx4 v[32:35], v7, s[56:59], s33 offen offset:0 sc1
    buffer_load_dwordx4 v[36:39], v7, s[56:59], s33 offen offset:1024 sc1
    s_add_u32 s33, s19, 0x81000
    buffer_load_dwordx4 v[40:43], v7, s[56:59], s33 offen offset:0 sc1
    buffer_load_dwordx4 v[44:47], v7, s[56:59], s33 offen offset:1024 sc1
    s_add_u32 s33, s19, 0x2000
    buffer_load_dwordx4 v[48:51], v7, s[56:59], s33 offen offset:0 sc1
    buffer_load_dwordx4 v[52:55], v7, s[56:59], s33 offen offset:1024 sc1
    s_add_u32 s33, s19, 0x82000
    buffer_load_dwordx4 v[56:59], v7, s[56:59], s33 offen offset:0 sc1
    buffer_load_dwordx4 v[60:63], v7, s[56:59], s33 offen offset:1024 sc1
    s_add_u32 s33, s19, 0x3000
    buffer_load_dwordx4 v[64:67], v7, s[56:59], s33 offen offset:0 sc1
    buffer_load_dwordx4 v[68:71], v7, s[56:59], s33 offen offset:1024 sc1
    s_add_u32 s33, s19, 0x83000
    buffer_load_dwordx4 v[72:75], v7, s[56:59], s33 offen offset:0 sc1
    buffer_load_dwordx4 v[76:79], v7, s[56:59], s33 offen offset:1024 sc1
    s_waitcnt vmcnt(8)
    v_mfma_f32_16x16x32_bf16 v[80:83], v[240:243], v[16:19], 0
    v_mfma_f32_16x16x32_bf16 v[84:87], v[240:243], v[20:23], 0
    v_mfma_f32_16x16x32_bf16 v[80:83], v[240:243], v[24:27], v[80:83]
    v_mfma_f32_16x16x32_bf16 v[84:87], v[240:243], v[28:31], v[84:87]
    v_mfma_f32_16x16x32_bf16 v[80:83], v[244:247], v[32:35], v[80:83]
    v_mfma_f32_16x16x32_bf16 v[84:87], v[244:247], v[36:39], v[84:87]
    v_mfma_f32_16x16x32_bf16 v[80:83], v[244:247], v[40:43], v[80:83]
    v_mfma_f32_16x16x32_bf16 v[84:87], v[244:247], v[44:47], v[84:87]
    s_waitcnt vmcnt(0)
    v_mfma_f32_16x16x32_bf16 v[88:91], v[240:243], v[48:51], 0
    v_mfma_f32_16x16x32_bf16 v[92:95], v[240:243], v[52:55], 0
    v_mfma_f32_16x16x32_bf16 v[88:91], v[240:243], v[56:59], v[88:91]
    v_mfma_f32_16x16x32_bf16 v[92:95], v[240:243], v[60:63], v[92:95]
    v_mfma_f32_16x16x32_bf16 v[88:91], v[244:247], v[64:67], v[88:91]
    v_mfma_f32_16x16x32_bf16 v[92:95], v[244:247], v[68:71], v[92:95]
    v_mfma_f32_16x16x32_bf16 v[88:91], v[244:247], v[72:75], v[88:91]
    v_mfma_f32_16x16x32_bf16 v[92:95], v[244:247], v[76:79], v[92:95]
    s_nop 7
    v_cvt_pk_bf16_f32 v80, v80, v81
    v_cvt_pk_bf16_f32 v81, v82, v83
    v_cvt_pk_bf16_f32 v84, v84, v85
    v_cvt_pk_bf16_f32 v85, v86, v87
    v_cvt_pk_bf16_f32 v88, v88, v89
    v_cvt_pk_bf16_f32 v89, v90, v91
    v_cvt_pk_bf16_f32 v92, v92, v93
    v_cvt_pk_bf16_f32 v93, v94, v95
    buffer_store_dwordx2 v[80:81], v10, s[60:63], s18 offen offset:0 sc1
    buffer_store_dwordx2 v[84:85], v10, s[60:63], s18 offen offset:256 sc1
    buffer_store_dwordx2 v[88:89], v10, s[60:63], s18 offen offset:128 sc1
    buffer_store_dwordx2 v[92:93], v10, s[60:63], s18 offen offset:384 sc1
    v_mov_b32 v6, 1
    s_waitcnt vmcnt(0)
    s_mov_b32 exec_hi, 0
    buffer_store_dword v6, v11, s[60:63], s101 offen sc1
    s_mov_b64 exec, -1
    s_mov_b32 s34, 262144
L_poll_159:
    buffer_load_dword v255, v1, s[60:63], s39 offen sc1
    s_waitcnt vmcnt(0)
    v_cmp_gt_u32 vcc, 1, v255
    s_cbranch_vccz L_polled_160
    s_sleep 1
    s_sub_u32 s34, s34, 1
    s_cbranch_scc0 L_poll_159
L_polled_160:
L_skip_156:
    s_mov_b32 s34, 1048576
L_lw_161:
    ds_read_b32 v255, v8 offset:0
    s_waitcnt lgkmcnt(0)
    v_cmp_gt_u32 vcc, 17, v255
    s_cbranch_vccz L_lwd_162
    s_sleep 1
    s_sub_u32 s34, s34, 1
    s_cbranch_scc0 L_lw_161
L_lwd_162:
    s_mov_b32 s34, 1048576
L_lw_163:
    ds_read_b32 v255, v8 offset:32
    s_waitcnt lgkmcnt(0)
    v_cmp_gt_u32 vcc, s4, v255
    s_cbranch_vccz L_lwd_164
    s_sleep 1
    s_sub_u32 s34, s34, 1
    s_cbranch_scc0 L_lw_163
L_lwd_164:
    s_add_u32 m0, s5, 0
    s_add_u32 s100, s15, 0x0
    buffer_load_dwordx4 v5, s[60:63], s100 offen offset:0 sc1 lds
    buffer_load_dwordx4 v5, s[60:63], s100 offen offset:1024 sc1 lds
    buffer_load_dwordx4 v5, s[60:63], s100 offen offset:2048 sc1 lds
    buffer_load_dwordx4 v5, s[60:63], s100 offen offset:3072 sc1 lds
    s_add_u32 m0, s5, 4096
    s_add_u32 s100, s15, 0x1000
    buffer_load_dwordx4 v5, s[60:63], s100 offen offset:0 sc1 lds
    buffer_load_dwordx4 v5, s[60:63], s100 offen offset:1024 sc1 lds
    buffer_load_dwordx4 v5, s[60:63], s100 offen offset:2048 sc1 lds
    buffer_load_dwordx4 v5, s[60:63], s100 offen offset:3072 sc1 lds
    s_add_u32 m0, s5, 8192
    s_add_u32 s100, s15, 0x2000
    buffer_load_dwordx4 v5, s[60:63], s100 offen offset:0 sc1 lds
    buffer_load_dwordx4 v5, s[60:63], s100 offen offset:1024 sc1 lds
    buffer_load_dwordx4 v5, s[60:63], s100 offen offset:2048 sc1 lds
    buffer_load_dwordx4 v5, s[60:63], s100 offen offset:3072 sc1 lds
    s_add_u32 m0, s5, 12288
    s_add_u32 s100, s15, 0x3000
    buffer_load_dwordx4 v5, s[60:63], s100 offen offset:0 sc1 lds
    buffer_load_dwordx4 v5, s[60:63], s100 offen offset:1024 sc1 lds
    buffer_load_dwordx4 v5, s[60:63], s100 offen offset:2048 sc1 lds
    buffer_load_dwordx4 v5, s[60:63], s100 offen offset:3072 sc1 lds
    s_add_u32 m0, s6, 0
    s_add_u32 s100, s15, 0x4000
    buffer_load_dwordx4 v5, s[60:63], s100 offen offset:0 sc1 lds
    buffer_load_dwordx4 v5, s[60:63], s100 offen offset:1024 sc1 lds
    buffer_load_dwordx4 v5, s[60:63], s100 offen offset:2048 sc1 lds
    buffer_load_dwordx4 v5, s[60:63], s100 offen offset:3072 sc1 lds
    s_add_u32 m0, s6, 4096
    s_add_u32 s100, s15, 0x5000
    buffer_load_dwordx4 v5, s[60:63], s100 offen offset:0 sc1 lds
    buffer_load_dwordx4 v5, s[60:63], s100 offen offset:1024 sc1 lds
    buffer_load_dwordx4 v5, s[60:63], s100 offen offset:2048 sc1 lds
    buffer_load_dwordx4 v5, s[60:63], s100 offen offset:3072 sc1 lds
    s_add_u32 m0, s6, 8192
    s_add_u32 s100, s15, 0x6000
    buffer_load_dwordx4 v5, s[60:63], s100 offen offset:0 sc1 lds
    buffer_load_dwordx4 v5, s[60:63], s100 offen offset:1024 sc1 lds
    buffer_load_dwordx4 v5, s[60:63], s100 offen offset:2048 sc1 lds
    buffer_load_dwordx4 v5, s[60:63], s100 offen offset:3072 sc1 lds
    s_add_u32 m0, s6, 12288
    s_add_u32 s100, s15, 0x7000
    buffer_load_dwordx4 v5, s[60:63], s100 offen offset:0 sc1 lds
    buffer_load_dwordx4 v5, s[60:63], s100 offen offset:1024 sc1 lds
    buffer_load_dwordx4 v5, s[60:63], s100 offen offset:2048 sc1 lds
    buffer_load_dwordx4 v5, s[60:63], s100 offen offset:3072 sc1 lds
    s_cmp_eq_u32 s44, 0
    s_cbranch_scc0 L_skip_165
    s_lshl_b32 s32, s40, 13
    s_add_u32 s32, s32, 0x200000
    buffer_load_dwordx4 v[16:19], v5, s[60:63], s32 offen offset:0 sc1
    buffer_load_dwordx4 v[20:23], v5, s[60:63], s32 offen offset:1024 sc1
    buffer_load_dwordx4 v[24:27], v5, s[60:63], s32 offen offset:2048 sc1
    buffer_load_dwordx4 v[28:31], v5, s[60:63], s32 offen offset:3072 sc1
    s_add_u32 s32, s32, 4096
    buffer_load_dwordx4 v[32:35], v5, s[60:63], s32 offen offset:0 sc1
    buffer_load_dwordx4 v[36:39], v5, s[60:63], s32 offen offset:1024 sc1
    buffer_load_dwordx4 v[40:43], v5, s[60:63], s32 offen offset:2048 sc1
    buffer_load_dwordx4 v[44:47], v5, s[60:63], s32 offen offset:3072 sc1
    v_lshrrev_b32 v12, 7, v5
    v_lshlrev_b32 v12, 6, v12
    v_and_b32 v13, 48, v5
    v_add_u32 v12, v12, v13
    v_bfe_u32 v13, v5, 6, 1
    v_lshl_add_u32 v12, v13, 3, v12
    v_add_u32 v12, 0x25600, v12
    s_waitcnt vmcnt(0)
    v_add_f32 v16, v16, v20
    v_add_f32 v17, v17, v21
    v_add_f32 v18, v18, v22
    v_add_f32 v19, v19, v23
    v_add_f32 v16, v16, v24
    v_add_f32 v17, v17, v25
    v_add_f32 v18, v18, v26
    v_add_f32 v19, v19, v27
    v_add_f32 v16, v16, v28
    v_add_f32 v17, v17, v29
    v_add_f32 v18, v18, v30
    v_add_f32 v19, v19, v31
    v_add_f32 v16, v16, v32
    v_add_f32 v17, v17, v33
    v_add_f32 v18, v18, v34
    v_add_f32 v19, v19, v35
    v_add_f32 v16, v16, v36
    v_add_f32 v17, v17, v37
    v_add_f32 v18, v18, v38
    v_add_f32 v19, v19, v39
    v_add_f32 v16, v16, v40
    v_add_f32 v17, v17, v41
    v_add_f32 v18, v18, v42
    v_add_f32 v19, v19, v43
    v_add_f32 v16, v16, v44
    v_add_f32 v17, v17, v45
    v_add_f32 v18, v18, v46
    v_add_f32 v19, v19, v47
    v_cvt_pk_bf16_f32 v16, v16, v17
    v_cvt_pk_bf16_f32 v17, v18, v19
    ds_write_b64 v12, v[16:17]
L_skip_165:
    s_waitcnt vmcnt(0)
    v_mov_b32 v254, 1
    ds_write_b32 v3, v254 offset:128
    s_waitcnt lgkmcnt(0)
    s_endpgm
L_spin_136:
    s_mov_b32 s34, 1048576
L_spin_136b:
    ds_read_b32 v255, v8 offset:16
    s_waitcnt lgkmcnt(0)
    v_cmp_gt_u32 vcc, 14, v255
    s_cbranch_vccz L_go_137
    s_sub_u32 s34, s34, 1
    s_cbranch_scc0 L_spin_136b
    s_branch L_go_137
L_spin_138:
    s_mov_b32 s34, 1048576
L_spin_138b:
    ds_read_b32 v255, v8 offset:16
    s_waitcnt lgkmcnt(0)
    v_cmp_gt_u32 vcc, 16, v255
    s_cbranch_vccz L_go_139
    s_sub_u32 s34, s34, 1
    s_cbranch_scc0 L_spin_138b
    s_branch L_go_139
L_spin_140:
    s_mov_b32 s34, 1048576
L_spin_140b:
    ds_read_b32 v255, v8 offset:16
    s_waitcnt lgkmcnt(0)
    v_cmp_gt_u32 vcc, 18, v255
    s_cbranch_vccz L_go_141
    s_sub_u32 s34, s34, 1
    s_cbranch_scc0 L_spin_140b
    s_branch L_go_141
L_slow2:
    s_nop 7
    s_waitcnt lgkmcnt(3)
    v_mfma_f32_16x16x32_bf16 v[176:179], v[80:83], v[208:211], 0
    v_mfma_f32_16x16x32_bf16 v[180:183], v[84:87], v[208:211], 0
    ds_read_b128 v[236:239], v5 offset:24064
    v_mfma_f32_16x16x32_bf16 v[184:187], v[80:83], v[212:215], 0
    v_mul_f32 v144, v144, v240
    v_mul_f32 v152, v152, v240
    v_mfma_f32_16x16x32_bf16 v[188:191], v[84:87], v[212:215], 0
    ds_read_b128 v[208:211], v5 offset:25088
    v_mul_f32 v160, v160, v240
    v_mfma_f32_16x16x32_bf16 v[192:195], v[80:83], v[216:219], 0
    v_mul_f32 v168, v168, v240
    v_cvt_pk_bf16_f32 v12, v144, v152
    v_mfma_f32_16x16x32_bf16 v[196:199], v[84:87], v[216:219], 0
    ds_read_b128 v[212:215], v5 offset:26112
    v_cvt_pk_bf16_f32 v13, v160, v168
    v_mfma_f32_16x16x32_bf16 v[200:203], v[80:83], v[220:223], 0
    buffer_store_dwordx2 v[12:13], v10, s[52:55], s10 offen offset:256 sc1
    v_mul_f32 v145, v145, v241
    v_mfma_f32_16x16x32_bf16 v[204:207], v[84:87], v[220:223], 0
    ds_read_b128 v[216:219], v5 offset:27136
    s_waitcnt lgkmcnt(3)
    v_mfma_f32_16x16x32_bf16 v[176:179], v[88:91], v[224:227], v[176:179]
    v_mul_f32 v153, v153, v241
    v_mul_f32 v161, v161, v241
    v_mfma_f32_16x16x32_bf16 v[180:183], v[92:95], v[224:227], v[180:183]
    ds_read_b128 v[220:223], v5 offset:28160
    v_mul_f32 v169, v169, v241
    v_mfma_f32_16x16x32_bf16 v[184:187], v[88:91], v[228:231], v[184:187]
    v_cvt_pk_bf16_f32 v14, v145, v153
    v_cvt_pk_bf16_f32 v15, v161, v169
    v_mfma_f32_16x16x32_bf16 v[188:191], v[92:95], v[228:231], v[188:191]
    ds_read_b128 v[224:227], v5 offset:29184
    buffer_store_dwordx2 v[14:15], v10, s[52:55], s10 offen offset:768 sc1
    v_mfma_f32_16x16x32_bf16 v[192:195], v[88:91], v[232:235], v[192:195]
    v_mul_f32 v146, v146, v242
    v_mul_f32 v154, v154, v242
    v_mfma_f32_16x16x32_bf16 v[196:199], v[92:95], v[232:235], v[196:199]
    ds_read_b128 v[228:231], v5 offset:30208
    v_mul_f32 v162, v162, v242
    v_mfma_f32_16x16x32_bf16 v[200:203], v[88:91], v[236:239], v[200:203]
    v_mul_f32 v170, v170, v242
    v_cvt_pk_bf16_f32 v12, v146, v154
    v_mfma_f32_16x16x32_bf16 v[204:207], v[92:95], v[236:239], v[204:207]
    ds_read_b128 v[232:235], v5 offset:31232
    s_waitcnt lgkmcnt(3)
    v_mfma_f32_16x16x32_bf16 v[176:179], v[96:99], v[208:211], v[176:179]
    v_cvt_pk_bf16_f32 v13, v162, v170
    v_mfma_f32_16x16x32_bf16 v[180:183], v[100:103], v[208:211], v[180:183]
    ds_read_b128 v[236:239], v5 offset:32256
    buffer_store_dwordx2 v[12:13], v10, s[52:55], s10 offen offset:1280 sc1
    v_mfma_f32_16x16x32_bf16 v[184:187], v[96:99], v[212:215], v[184:187]
    v_mul_f32 v147, v147, v243
    v_mul_f32 v155, v155, v243
    v_mfma_f32_16x16x32_bf16 v[188:191], v[100:103], v[212:215], v[188:191]
    ds_read_b128 v[208:211], v253 offset:33792
    v_mul_f32 v163, v163, v243
    v_mfma_f32_16x16x32_bf16 v[192:195], v[96:99], v[216:219], v[192:195]
    v_mul_f32 v171, v171, v243
    v_cvt_pk_bf16_f32 v14, v147, v155
    v_mfma_f32_16x16x32_bf16 v[196:199], v[100:103], v[216:219], v[196:199]
    ds_read_b128 v[212:215], v253 offset:34816
    v_cvt_pk_bf16_f32 v15, v163, v171
    v_mfma_f32_16x16x32_bf16 v[200:203], v[96:99], v[220:223], v[200:203]
    buffer_store_dwordx2 v[14:15], v10, s[52:55], s10 offen offset:1792 sc1
    v_mul_f32 v148, v148, v244
    v_mfma_f32_16x16x32_bf16 v[204:207], v[100:103], v[220:223], v[204:207]
    ds_read_b128 v[216:219], v253 offset:35840
    s_waitcnt lgkmcnt(3)
    v_mfma_f32_16x16x32_bf16 v[176:179], v[104:107], v[224:227], v[176:179]
    v_mul_f32 v156, v156, v244
    v_mul_f32 v164, v164, v244
    v_mfma_f32_16x16x32_bf16 v[180:183], v[108:111], v[224:227], v[180:183]
    ds_read_b128 v[220:223], v253 offset:36864
    v_mul_f32 v172, v172, v244
    v_mfma_f32_16x16x32_bf16 v[184:187], v[104:107], v[228:231], v[184:187]
    v_cvt_pk_bf16_f32 v12, v148, v156
    v_cvt_pk_bf16_f32 v13, v164, v172
    v_mfma_f32_16x16x32_bf16 v[188:191], v[108:111], v[228:231], v[188:191]
    ds_read_b128 v[224:227], v253 offset:37888
    buffer_store_dwordx2 v[12:13], v10, s[52:55], s12 offen offset:256 sc1
    v_mfma_f32_16x16x32_bf16 v[192:195], v[104:107], v[232:235], v[192:195]
    v_mul_f32 v149, v149, v245
    v_mul_f32 v157, v157, v245
    v_mfma_f32_16x16x32_bf16 v[196:199], v[108:111], v[232:235], v[196:199]
    ds_read_b128 v[228:231], v253 offset:38912
    v_mul_f32 v165, v165, v245
    v_mfma_f32_16x16x32_bf16 v[200:203], v[104:107], v[236:239], v[200:203]
    v_mul_f32 v173, v173, v245
    v_cvt_pk_bf16_f32 v14, v149, v157
    v_mfma_f32_16x16x32_bf16 v[204:207], v[108:111], v[236:239], v[204:207]
    ds_read_b128 v[232:235], v253 offset:39936
    s_waitcnt lgkmcnt(3)
    v_mfma_f32_16x16x32_bf16 v[176:179], v[112:115], v[208:211], v[176:179]
    v_cvt_pk_bf16_f32 v15, v165, v173
    v_mfma_f32_16x16x32_bf16 v[180:183], v[116:119], v[208:211], v[180:183]
    ds_read_b128 v[236:239], v253 offset:40960
    buffer_store_dwordx2 v[14:15], v10, s[52:55], s12 offen offset:768 sc1
    v_mfma_f32_16x16x32_bf16 v[184:187], v[112:115], v[212:215], v[184:187]
    v_mul_f32 v150, v150, v246
    v_mul_f32 v158, v158, v246
    v_mfma_f32_16x16x32_bf16 v[188:191], v[116:119], v[212:215], v[188:191]
    ds_read_b128 v[208:211], v253 offset:41984
    v_mul_f32 v166, v166, v246
    v_mfma_f32_16x16x32_bf16 v[192:195], v[112:115], v[216:219], v[192:195]
    v_mul_f32 v174, v174, v246
    v_cvt_pk_bf16_f32 v12, v150, v158
    v_mfma_f32_16x16x32_bf16 v[196:199], v[116:119], v[216:219], v[196:199]
    ds_read_b128 v[212:215], v253 offset:43008
    v_cvt_pk_bf16_f32 v13, v166, v174
    v_mfma_f32_16x16x32_bf16 v[200:203], v[112:115], v[220:223], v[200:203]
    buffer_store_dwordx2 v[12:13], v10, s[52:55], s12 offen offset:1280 sc1
    v_mul_f32 v151, v151, v247
    v_mfma_f32_16x16x32_bf16 v[204:207], v[116:119], v[220:223], v[204:207]
    ds_read_b128 v[216:219], v253 offset:44032
    s_waitcnt lgkmcnt(3)
    v_mfma_f32_16x16x32_bf16 v[176:179], v[120:123], v[224:227], v[176:179]
    v_mul_f32 v159, v159, v247
    v_mul_f32 v167, v167, v247
    v_mfma_f32_16x16x32_bf16 v[180:183], v[124:127], v[224:227], v[180:183]
    ds_read_b128 v[220:223], v253 offset:45056
    v_mul_f32 v175, v175, v247
    v_mfma_f32_16x16x32_bf16 v[184:187], v[120:123], v[228:231], v[184:187]
    v_cvt_pk_bf16_f32 v14, v151, v159
    v_cvt_pk_bf16_f32 v15, v167, v175
    v_mfma_f32_16x16x32_bf16 v[188:191], v[124:127], v[228:231], v[188:191]
    ds_read_b128 v[224:227], v253 offset:46080
    buffer_store_dwordx2 v[14:15], v10, s[52:55], s12 offen offset:1792 sc1
    v_mfma_f32_16x16x32_bf16 v[192:195], v[120:123], v[232:235], v[192:195]
    v_mfma_f32_16x16x32_bf16 v[196:199], v[124:127], v[232:235], v[196:199]
    ds_read_b128 v[228:231], v253 offset:47104
    v_mfma_f32_16x16x32_bf16 v[200:203], v[120:123], v[236:239], v[200:203]
    v_mfma_f32_16x16x32_bf16 v[204:207], v[124:127], v[236:239], v[204:207]
    ds_read_b128 v[232:235], v253 offset:48128
    s_waitcnt lgkmcnt(3)
    v_mfma_f32_16x16x32_bf16 v[176:179], v[128:131], v[208:211], v[176:179]
    v_mfma_f32_16x16x32_bf16 v[180:183], v[132:135], v[208:211], v[180:183]
    ds_read_b128 v[236:239], v253 offset:49152
    v_mfma_f32_16x16x32_bf16 v[184:187], v[128:131], v[212:215], v[184:187]
    v_mfma_f32_16x16x32_bf16 v[188:191], v[132:135], v[212:215], v[188:191]
    v_mfma_f32_16x16x32_bf16 v[192:195], v[128:131], v[216:219], v[192:195]
    v_mfma_f32_16x16x32_bf16 v[196:199], v[132:135], v[216:219], v[196:199]
    v_mfma_f32_16x16x32_bf16 v[200:203], v[128:131], v[220:223], v[200:203]
    v_mfma_f32_16x16x32_bf16 v[204:207], v[132:135], v[220:223], v[204:207]
    s_waitcnt lgkmcnt(0)
    v_mfma_f32_16x16x32_bf16 v[176:179], v[136:139], v[224:227], v[176:179]
    v_mfma_f32_16x16x32_bf16 v[180:183], v[140:143], v[224:227], v[180:183]
    v_mfma_f32_16x16x32_bf16 v[184:187], v[136:139], v[228:231], v[184:187]
    v_mfma_f32_16x16x32_bf16 v[188:191], v[140:143], v[228:231], v[188:191]
    v_mfma_f32_16x16x32_bf16 v[192:195], v[136:139], v[232:235], v[192:195]
    v_mfma_f32_16x16x32_bf16 v[196:199], v[140:143], v[232:235], v[196:199]
    v_mfma_f32_16x16x32_bf16 v[200:203], v[136:139], v[236:239], v[200:203]
    v_mfma_f32_16x16x32_bf16 v[204:207], v[140:143], v[236:239], v[204:207]
    s_nop 7
    v_mul_f32 v176, v176, v240
    v_mul_f32 v184, v184, v240
    v_mul_f32 v192, v192, v240
    v_mul_f32 v200, v200, v240
    v_cvt_pk_bf16_f32 v12, v176, v184
    v_cvt_pk_bf16_f32 v13, v192, v200
    v_mul_f32 v177, v177, v241
    v_mul_f32 v185, v185, v241
    buffer_store_dwordx2 v[12:13], v10, s[52:55], s10 offen offset:384 sc1
    v_mul_f32 v193, v193, v241
    v_mul_f32 v201, v201, v241
    v_cvt_pk_bf16_f32 v14, v177, v185
    v_cvt_pk_bf16_f32 v15, v193, v201
    v_mul_f32 v178, v178, v242
    v_mul_f32 v186, v186, v242
    buffer_store_dwordx2 v[14:15], v10, s[52:55], s10 offen offset:896 sc1
    v_mul_f32 v194, v194, v242
    v_mul_f32 v202, v202, v242
    v_cvt_pk_bf16_f32 v12, v178, v186
    v_cvt_pk_bf16_f32 v13, v194, v202
    v_mul_f32 v179, v179, v243
    v_mul_f32 v187, v187, v243
    buffer_store_dwordx2 v[12:13], v10, s[52:55], s10 offen offset:1408 sc1
    v_mul_f32 v195, v195, v243
    v_mul_f32 v203, v203, v243
    v_cvt_pk_bf16_f32 v14, v179, v187
    v_cvt_pk_bf16_f32 v15, v195, v203
    v_mul_f32 v180, v180, v244
    v_mul_f32 v188, v188, v244
    buffer_store_dwordx2 v[14:15], v10, s[52:55], s10 offen offset:1920 sc1
    v_mul_f32 v196, v196, v244
    v_mul_f32 v204, v204, v244
    v_cvt_pk_bf16_f32 v12, v180, v188
    v_cvt_pk_bf16_f32 v13, v196, v204
    v_mul_f32 v181, v181, v245
    v_mul_f32 v189, v189, v245
    buffer_store_dwordx2 v[12:13], v10, s[52:55], s12 offen offset:384 sc1
    v_mul_f32 v197, v197, v245
    v_mul_f32 v205, v205, v245
    v_cvt_pk_bf16_f32 v14, v181, v189
    v_cvt_pk_bf16_f32 v15, v197, v205
    v_mul_f32 v182, v182, v246
    v_mul_f32 v190, v190, v246
    buffer_store_dwordx2 v[14:15], v10, s[52:55], s12 offen offset:896 sc1
    v_mul_f32 v198, v198, v246
    v_mul_f32 v206, v206, v246
    v_cvt_pk_bf16_f32 v12, v182, v190
    v_cvt_pk_bf16_f32 v13, v198, v206
    v_mul_f32 v183, v183, v247
    v_mul_f32 v191, v191, v247
    buffer_store_dwordx2 v[12:13], v10, s[52:55], s12 offen offset:1408 sc1
    v_mul_f32 v199, v199, v247
    v_mul_f32 v207, v207, v247
    v_cvt_pk_bf16_f32 v14, v183, v191
    v_cvt_pk_bf16_f32 v15, v199, v207
    buffer_store_dwordx2 v[14:15], v10, s[52:55], s12 offen offset:1920 sc1
    s_endpgm
L_end:
    s_endpgm
.section .rodata,"a"
.p2align 6
.amdhsa_kernel standalone__linear_kernel_performer__prompt_kernel
  .amdhsa_next_free_vgpr 256
  .amdhsa_next_free_sgpr 102
  .amdhsa_accum_offset 256
  .amdhsa_group_segment_fixed_size 0
  .amdhsa_kernarg_size 56
  .amdhsa_user_sgpr_count 2
  .amdhsa_user_sgpr_kernarg_segment_ptr 1
  .amdhsa_system_sgpr_workgroup_id_x 1
  .amdhsa_float_denorm_mode_32 3
  .amdhsa_float_denorm_mode_16_64 3
.end_amdhsa_kernel
```
